```python
import torch

def _softmax(x, axis=-1):
    return torch.softmax(x, dim=axis)
def _gelu(x):
    return torch.nn.functional.gelu(x, approximate="tanh")
def _silu(x):
    return torch.nn.functional.silu(x)
def _sigmoid(x):
    return torch.sigmoid(x)
def _layernorm(x, axis=-1, eps=1e-5):
    m = x.mean(dim=axis, keepdim=True)
    v = x.var(dim=axis, keepdim=True, unbiased=False)
    return (x - m) / torch.sqrt(v + eps)
def _scatter_add(tgt, idx, src, axis=0):
    return tgt.clone().index_add_(axis, idx, src)
def _segment_sum(src, seg, n):
    out = torch.zeros((n,) + src.shape[1:], dtype=src.dtype)
    return out.index_add_(0, seg, src)
def _pad(x, pw):
    flat = tuple(v for pair in reversed(pw) for v in pair)
    return torch.nn.functional.pad(x, flat)

kernel_name = 'concat_heads__ssm_conv_s4__linear_attn_block__prompt'

def setup_inputs():

    _w = (lambda a: (lambda t: t.to(torch.bfloat16) if t.is_floating_point() else t)(torch.as_tensor(a)))
    def _A_setup():
        B, L, D, N = 1, 2048, 576, 128
        A_re = -(lambda _x: torch.exp(torch.as_tensor(_x)))((lambda *s: torch.randn(*s, dtype=torch.bfloat16) * 6.4)(D, N))
        A_im = torch.pi * (lambda *s: torch.randn(*s, dtype=torch.bfloat16) * 0.05)(D, N)
        B_re = (lambda *s: torch.randn(*s, dtype=torch.bfloat16) * 0.1)(D, N)
        B_im = (lambda *s: torch.randn(*s, dtype=torch.bfloat16) * 0.1)(D, N)
        C_re = (lambda *s: torch.randn(*s, dtype=torch.bfloat16) * 0.1)(D, N)
        C_im = (lambda *s: torch.randn(*s, dtype=torch.bfloat16) * 0.1)(D, N)
        log_dt = (lambda *s: torch.randn(*s, dtype=torch.bfloat16) * 0.05)(D) * 0.5 - 4.0
        Dskip = (lambda *s: torch.randn(*s, dtype=torch.bfloat16) * 0.05)(D)
        return {
            "u": _w((lambda *s: torch.randn(*s, dtype=torch.bfloat16) * 0.05)(B, L, D)),
            "A_re": _w(A_re),
            "A_im": _w(A_im),
            "B_re": _w(B_re),
            "B_im": _w(B_im),
            "C_re": _w(C_re),
            "C_im": _w(C_im),
            "log_dt": _w(log_dt),
            "Dskip": _w(Dskip),
        }
    _A_in = _A_setup()

    def _B_setup():
        B, S, D = 1, 2048, 576
        return {
            "x": _w((lambda *s: torch.randn(*s, dtype=torch.bfloat16) * 0.05)(B, S, D)),
            "wqkv": _w((lambda *s: torch.randn(*s, dtype=torch.bfloat16) * 0.4)(D, 3 * D)),
            "wo": _w((lambda *s: torch.randn(*s, dtype=torch.bfloat16) * 0.05)(D, D)),
        }
    _B_in = _B_setup()

    return {
        "A_u": _A_in["u"],
        "A_A_re": _A_in["A_re"],
        "A_A_im": _A_in["A_im"],
        "A_B_re": _A_in["B_re"],
        "A_B_im": _A_in["B_im"],
        "A_C_re": _A_in["C_re"],
        "A_C_im": _A_in["C_im"],
        "A_log_dt": _A_in["log_dt"],
        "A_Dskip": _A_in["Dskip"],
        "B_x": _B_in["x"],
        "B_wqkv": _B_in["wqkv"],
        "B_wo": _B_in["wo"],
    }

def reference(A_u, A_A_re, A_A_im, A_B_re, A_B_im, A_C_re, A_C_im, A_log_dt, A_Dskip, B_x, B_wqkv, B_wo):
    def _A_ref(u, A_re, A_im, B_re, B_im, C_re, C_im, log_dt, Dskip):
        Bsz, L, D = u.shape
        dt = torch.exp(log_dt)[:, None]
        A = A_re + 1j * A_im
        Bc = B_re + 1j * B_im
        Cc = C_re + 1j * C_im
        logdA = dt * A
        dB = dt * Bc
        l = (lambda x, dt: x.to(dt))(torch.arange(L), A_re.dtype)
        P = torch.exp(logdA[:, :, None] * l[None, None, :])
        K = torch.einsum("dn,dnl,dn->dl", Cc, P, dB).real
        L2 = 2 * L
        Kp = _pad(K, ((0, 0), (0, L)))
        up = (lambda x, *d: x.permute(*d))(u, 0, 2, 1)
        up = _pad(up, ((0, 0), (0, 0), (0, L)))
        Kf = (lambda x, axes=(-2,-1): torch.fft.rfft2(x.float(), dim=axes))(Kp[:, None, :], axes=(-2, -1))
        Uf = (lambda x, axes=(-2,-1): torch.fft.rfft2(x.float(), dim=axes))(up[:, :, None, :], axes=(-2, -1))
        Yf = Uf * Kf[None, :, :, :]
        y = (lambda x, s, axes=(-2,-1): torch.fft.irfft2(x, s=s, dim=axes).to(torch.bfloat16))(Yf, (1, L2), axes=(-2, -1))[:, :, 0, :L]
        y = (lambda x, *d: x.permute(*d))(y, 0, 2, 1) + u * Dskip[None, None, :]
        return y

    def _B_ref(x, wqkv, wo):
        B, S, D = x.shape
        H = 32; Dh = D // H
        qkv = (lambda x, *d: x.permute(*d))((x @ wqkv).reshape(B, S, 3, H, Dh), 2, 0, 3, 1, 4)
        q, k, v = qkv[0], qkv[1], qkv[2]
        phi = lambda t: torch.where(t > 0, t + 1, torch.exp(t)) + 1e-6
        pq, pk = phi(q), phi(k)
        kv = torch.einsum("bhsd,bhse->bhde", pk, v)
        z = torch.einsum("bhsd->bhd", pk)
        num = torch.einsum("bhqd,bhde->bhqe", pq, kv)
        den = torch.einsum("bhqd,bhd->bhq", pq, z)[..., None] + 1e-6
        o = num / den
        return (lambda x, *d: x.permute(*d))(o, 0, 2, 1, 3).reshape(B, S, D) @ wo

    a = _A_ref(A_u, A_A_re, A_A_im, A_B_re, A_B_im, A_C_re, A_C_im, A_log_dt, A_Dskip)
    b = _B_ref(B_x, B_wqkv, B_wo)
    return torch.concatenate([a, b], axis=-1)
```

```asm
; @launch grid=(256,1,1) block=(256,1,1) lds=163840
.amdgcn_target "amdgcn-amd-amdhsa--gfx950"
.text
.globl concat_heads__ssm_conv_s4__linear_attn_block__prompt_kernel
.p2align 12
.p2align 8
.type concat_heads__ssm_conv_s4__linear_attn_block__prompt_kernel,@function
concat_heads__ssm_conv_s4__linear_attn_block__prompt_kernel:
s_load_dwordx16 s[36:51], s[0:1], 56
s_cmp_ge_u32 s2, 256
s_cbranch_scc1 L_END
s_getpc_b64 s[4:5]
L_PC:
s_lshr_b32 s33, s2, 3
s_and_b32 s3, s2, 7
s_cmp_ge_u32 s33, 2
s_cbranch_scc1 L_NOPF
s_lshl_b32 s6, s33, 15
v_lshl_add_u32 v1, v0, 7, s6
v_min_u32 v1, L_LAST-L_PC, v1
global_load_dword v253, v1, s[4:5]
L_NOPF:
s_and_b32 s6, s3, 3
s_cmp_eq_u32 s6, 3
s_cselect_b32 s32, 16, 8
s_cmp_ge_u32 s33, s32
s_cbranch_scc1 L_B
s_load_dwordx16 s[52:67], s[0:1], 0
v_lshrrev_b32 v25, 6, v0
v_and_b32 v1, 63, v0
s_lshr_b32 s74, s3, 2
v_readfirstlane_b32 s68, v25
s_sub_u32 s69, s3, s74
s_lshl_b32 s69, s69, 3
s_mul_i32 s75, s74, 12
s_add_u32 s75, s75, 48
s_cmp_eq_u32 s32, 16
s_cselect_b32 s69, s75, s69
s_add_u32 s69, s69, s33
s_lshl_b32 s75, s69, 2
s_add_u32 s75, s75, s68
s_lshl_b32 s76, s75, 2
s_lshl_b32 s75, s75, 9
v_lshl_add_u32 v26, v1, 2, s75
v_lshlrev_b32 v27, 4, v1
s_cmp_ge_u32 s33, 12
s_waitcnt lgkmcnt(0)
s_cbranch_scc1 L_SPARE
s_nop 0
s_load_dword s72, s[36:37], s76
s_load_dword s73, s[38:39], s76
global_load_dword v2, v26, s[54:55]
global_load_dword v3, v26, s[56:57]
global_load_dword v4, v26, s[58:59]
global_load_dword v5, v26, s[60:61]
global_load_dword v6, v26, s[62:63]
global_load_dword v7, v26, s[64:65]
s_branch L_A
L_B:
s_sub_u32 s33, s33, s32
s_load_dwordx2 s[8:9], s[0:1], 72
s_load_dwordx2 s[12:13], s[0:1], 80
s_mov_b32 s10, 2359296
s_mov_b32 s11, 0x20000
s_mov_b32 s14, 1990656
s_mov_b32 s15, 0x20000
s_mul_i32 s53, s6, 3
s_lshr_b32 s58, s33, 3
s_add_u32 s53, s53, s58
s_and_b32 s58, s33, 7
s_lshr_b32 s54, s3, 2
s_lshl_b32 s54, s54, 3
s_add_u32 s54, s54, s58
v_lshrrev_b32 v36, 6, v0
v_bfe_u32 v12, v0, 4, 2
v_bfe_u32 v37, v0, 3, 3
v_readfirstlane_b32 s52, v36
s_mul_i32 s58, s53, 192
v_lshl_add_u32 v37, v36, 4, v37
v_add_u32 v37, s58, v37
v_mul_u32_u24 v37, 1152, v37
v_and_b32 v38, 7, v0
v_xor_b32 v38, v38, v12
v_lshl_add_u32 v176, v38, 4, v37
v_xor_b32_e64 v38, 4, v38
v_lshl_add_u32 v177, v38, 4, v37
v_add_u32 v177, 8192, v177
v_add_u32 v178, 71680, v176
v_add_u32 v179, 71680, v177
v_add_u32 v180, 147456, v176
v_add_u32 v181, 147456, v177
s_mul_i32 s65, s52, 6144
s_lshl_b32 s82, s52, 12
s_mov_b32 s83, 17236993
s_cmp_ge_u32 s54, 8
s_cselect_b32 s83, 272658448, s83
s_and_b32 s84, s33, 7
s_lshl_b32 s84, s84, 2
s_lshr_b32 s84, s83, s84
s_and_b32 s84, s84, 15
s_lshr_b32 s83, s33, 3
s_mul_i32 s83, s83, 3
s_add_u32 s83, s83, s84
s_sub_u32 s84, s83, 9
s_cmp_ge_u32 s83, 9
s_cselect_b32 s83, s84, s83
s_mov_b32 s84, s83
s_lshl_b32 s80, s83, 7
s_mul_i32 s81, s83, 221184
s_waitcnt lgkmcnt(0)
s_add_u32 m0, s65, 0
s_nop 0
buffer_load_dwordx4 v176, s[8:11], s80 offen offset:0 lds
s_and_b32 s58, s54, 1
s_lshl_b32 s58, s58, 3
s_mul_i32 s59, s54, 72
s_sub_u32 s59, s59, s58
s_and_b32 s64, s59, 127
s_sub_u32 s64, 128, s64
buffer_load_dwordx4 v177, s[8:11], s80 offen offset:1024 lds
s_lshr_b32 s64, s64, 4
s_min_u32 s64, s64, 4
s_sub_u32 s60, 5, s64
s_mov_b32 s61, 3456
v_bfe_u32 v37, v0, 2, 2
v_xor_b32 v37, v37, v12
buffer_load_dwordx4 v178, s[8:11], s80 offen offset:2048 lds
v_and_b32 v38, 3, v0
v_bfe_u32 v39, v0, 6, 1
v_lshlrev_b32 v39, 1, v39
v_xor_b32 v38, v38, v39
v_lshrrev_b32 v39, 1, v37
v_and_b32_e64 v37, 1, v37
buffer_load_dwordx4 v179, s[8:11], s80 offen offset:3072 lds
v_mul_u32_u24 v39, 1152, v39
v_mov_b32 v41, s64
v_mul_u32_u24 v40, v37, v41
v_add_u32 v40, v40, v38
v_cmp_eq_u32 vcc, 0, v37
v_mov_b32 v37, s60
s_add_u32 m0, s65, 4096
s_nop 0
buffer_load_dwordx4 v180, s[8:11], s80 offen offset:0 lds
v_cndmask_b32 v41, v37, v41, vcc
v_cmp_lt_u32 vcc, v38, v41
v_lshl_add_u32 v39, v40, 4, v39
v_lshl_add_u32 v36, v36, 3, v12
v_mad_u32_u24 v39, v36, s61, v39
s_add_u32 s62, s59, 1152
buffer_load_dwordx4 v181, s[8:11], s80 offen offset:1024 lds
v_add_u32 v39, s62, v39
v_mov_b32 v40, 1073741824
v_cndmask_b32_e64 v182, v40, v39, vcc
v_add_u32 v183, 12800, v182
v_add_u32 v184, 108544, v182
v_add_u32 v185, 121344, v182
s_add_u32 m0, s82, 73728
s_nop 0
buffer_load_dwordx4 v182, s[12:15], s81 offen offset:0 lds
buffer_load_dwordx4 v183, s[12:15], s81 offen offset:1024 lds
buffer_load_dwordx4 v184, s[12:15], s81 offen offset:2048 lds
buffer_load_dwordx4 v185, s[12:15], s81 offen offset:3072 lds
v_and_b32 v10, 63, v0
v_and_b32 v11, 15, v0
v_lshrrev_b32 v36, 1, v11
v_xor_b32_e64 v36, v36, v12
v_lshl_add_u32 v37, v11, 7, s65
v_lshl_add_u32 v17, v36, 4, v37
v_xor_b32 v18, 64, v17
v_lshrrev_b32 v36, 2, v10
v_and_b32 v37, 3, v10
v_and_b32 v156, 3, v36
v_and_b32 v157, 1, v12
v_lshlrev_b32 v157, 1, v157
v_bfe_u32 v161, v36, 1, 1
v_add_u32 v39, 0, v37
v_mov_b32 v40, 0
v_lshl_add_u32 v158, v39, 3, s58
v_and_b32 v160, 8, v158
v_lshrrev_b32 v159, 4, v158
v_cmp_le_u32 vcc, s64, v159
v_subrev_u32 v158, s64, v159
s_nop 0
v_cndmask_b32 v159, v159, v158, vcc
v_cndmask_b32 v158, 0, 1, vcc
v_xor_b32 v159, v159, v157
v_lshl_add_u32 v159, v159, 4, v160
v_or_b32 v158, v158, v40
v_xor_b32_e64 v158, v158, v156
v_lshl_add_u32 v159, v158, 6, v159
v_lshl_add_u32 v159, v156, 8, v159
v_lshl_add_u32 v159, v12, 12, v159
v_add_u32 v22, 73728, v159
v_add_u32 v39, 4, v37
v_mov_b32 v40, 0
v_lshl_add_u32 v158, v39, 3, s58
v_and_b32 v160, 8, v158
v_lshrrev_b32 v159, 4, v158
v_cmp_le_u32 vcc, s64, v159
v_subrev_u32 v158, s64, v159
s_nop 0
v_cndmask_b32 v159, v159, v158, vcc
v_cndmask_b32 v158, 0, 1, vcc
v_xor_b32 v159, v159, v157
v_lshl_add_u32 v159, v159, 4, v160
v_or_b32 v158, v158, v40
v_xor_b32_e64 v158, v158, v156
v_lshl_add_u32 v159, v158, 6, v159
v_lshl_add_u32 v159, v156, 8, v159
v_lshl_add_u32 v159, v12, 12, v159
v_add_u32 v23, 73728, v159
v_cmp_eq_u32 vcc, 0, v37
v_add_u32 v39, -1, v37
s_nop 0
v_cndmask_b32 v39, v39, 8, vcc
v_cndmask_b32 v40, 2, 0, vcc
v_lshl_add_u32 v158, v39, 3, s58
v_and_b32 v160, 8, v158
v_lshrrev_b32 v159, 4, v158
v_cmp_le_u32 vcc, s64, v159
v_subrev_u32 v158, s64, v159
s_nop 0
v_cndmask_b32 v159, v159, v158, vcc
v_cndmask_b32 v158, 0, 1, vcc
v_xor_b32 v159, v159, v157
v_lshl_add_u32 v159, v159, 4, v160
v_or_b32 v158, v158, v40
v_xor_b32 v158, v158, v156
v_lshl_add_u32 v159, v158, 6, v159
v_lshl_add_u32 v159, v156, 8, v159
v_lshl_add_u32 v159, v12, 12, v159
v_add_u32 v24, 73728, v159
v_add_u32 v39, 3, v37
v_min_u32 v39, 8, v39
v_mov_b32 v40, 2
v_lshl_add_u32 v158, v39, 3, s58
v_and_b32 v160, 8, v158
v_lshrrev_b32 v159, 4, v158
v_cmp_le_u32 vcc, s64, v159
v_subrev_u32 v158, s64, v159
s_nop 0
v_cndmask_b32 v159, v159, v158, vcc
v_cndmask_b32 v158, 0, 1, vcc
v_xor_b32 v159, v159, v157
v_lshl_add_u32 v159, v159, 4, v160
v_or_b32 v158, v158, v40
v_xor_b32 v158, v158, v156
v_lshl_add_u32 v159, v158, 6, v159
v_lshl_add_u32 v159, v156, 8, v159
v_lshl_add_u32 v159, v12, 12, v159
v_add_u32 v25, 73728, v159
v_add_u32 v39, 7, v37
v_min_u32 v39, 8, v39
v_mov_b32 v40, 2
v_lshl_add_u32 v158, v39, 3, s58
v_and_b32 v160, 8, v158
v_lshrrev_b32 v159, 4, v158
v_cmp_le_u32 vcc, s64, v159
v_subrev_u32 v158, s64, v159
s_nop 0
v_cndmask_b32 v159, v159, v158, vcc
v_cndmask_b32 v158, 0, 1, vcc
v_xor_b32 v159, v159, v157
v_lshl_add_u32 v159, v159, 4, v160
s_cmp_eq_u32 s64, 1
s_cselect_b32 s62, 0, 1
v_cmp_gt_u32 vcc, 2, v37
v_mov_b32 v160, s62
v_xor_b32 v41, 3, v157
v_lshlrev_b32 v41, 4, v41
v_cndmask_b32 v158, v160, v158, vcc
v_cndmask_b32 v159, v41, v159, vcc
v_or_b32 v158, v158, v40
v_xor_b32 v158, v158, v156
v_lshl_add_u32 v159, v158, 6, v159
v_lshl_add_u32 v159, v156, 8, v159
v_lshl_add_u32 v159, v12, 12, v159
v_add_u32 v26, 73728, v159
v_cmp_gt_u32 s[68:69], 4, v11
v_and_b32_e64 v41, 14, v11
v_cmp_eq_u32 s[70:71], 8, v41
v_cmp_eq_u32 s[72:73], 0, v12
s_mov_b32 s74, 0x3fb8aa3b
s_mov_b32 s75, 0x3fb8aa3b
s_mov_b32 s76, 0x358637bd
s_mov_b32 s77, 0x358637bd
v_mov_b32 v240, s76
v_cndmask_b32 v244, 0, v240, s[68:69]
v_mov_b32 v241, s76
v_cndmask_b32 v245, 0, v241, s[68:69]
v_mov_b32 v242, s76
v_cndmask_b32 v246, 0, v242, s[68:69]
v_mov_b32 v243, s76
v_cndmask_b32 v247, 0, v243, s[68:69]
v_cndmask_b32 v248, 0, 1.0, s[68:69]
v_mov_b32 v249, 0xff800000
v_cndmask_b32 v249, v249, v240, s[68:69]
s_cmp_lt_u32 s53, 10
s_cselect_b32 s62, 1.0, 0
v_cndmask_b32 v186, 0, 1.0, s[70:71]
v_mul_f32 v190, s62, v186
v_mov_b32 v187, v186
v_mov_b32 v191, v190
v_mov_b32 v188, v186
v_mov_b32 v192, v190
v_mov_b32 v189, v186
v_mov_b32 v193, v190
s_mov_b32 s90, s54
v_and_b32 v162, 7, v36
v_lshlrev_b32 v162, 7, v162
v_lshrrev_b32 v158, 1, v12
v_lshl_add_u32 v162, v158, 12, v162
v_lshlrev_b32 v158, 11, v158
v_sub_u32 v1, 0x10000, v158
s_cmp_eq_u32 s64, 1
s_cselect_b32 s62, 0, 1
v_add_u32 v39, 0, v37
v_lshl_add_u32 v158, v39, 3, s58
v_and_b32 v160, 8, v158
v_lshrrev_b32 v159, 4, v158
v_cmp_le_u32 vcc, s64, v159
v_subrev_u32 v158, s64, v159
s_nop 0
v_cndmask_b32 v159, v159, v158, vcc
v_cndmask_b32 v158, 0, 1, vcc
v_xor_b32 v159, v159, v157
v_lshl_add_u32 v159, v159, 4, v160
v_xor_b32 v158, v158, v161
v_lshl_add_u32 v159, v158, 6, v159
v_add_u32 v27, v162, v159
v_add_u32 v39, 4, v37
v_lshl_add_u32 v158, v39, 3, s58
v_and_b32 v160, 8, v158
v_lshrrev_b32 v159, 4, v158
v_cmp_le_u32 vcc, s64, v159
v_subrev_u32 v158, s64, v159
s_nop 0
v_cndmask_b32 v159, v159, v158, vcc
v_cndmask_b32 v158, 0, 1, vcc
v_xor_b32 v159, v159, v157
v_lshl_add_u32 v159, v159, 4, v160
v_xor_b32 v158, v158, v161
v_lshl_add_u32 v159, v158, 6, v159
v_add_u32 v28, v162, v159
v_add_u32 v39, 8, v37
v_lshl_add_u32 v158, v39, 3, s58
v_and_b32 v160, 8, v158
v_lshrrev_b32 v159, 4, v158
v_cmp_le_u32 vcc, s64, v159
v_subrev_u32 v158, s64, v159
s_nop 0
v_cndmask_b32 v159, v159, v158, vcc
v_cndmask_b32 v158, 0, 1, vcc
v_xor_b32 v159, v159, v157
v_lshl_add_u32 v159, v159, 4, v160
v_cmp_eq_u32 vcc, 0, v37
v_mov_b32 v40, s62
v_xor_b32 v41, 3, v157
v_lshlrev_b32 v41, 4, v41
v_cndmask_b32 v158, v40, v158, vcc
v_cndmask_b32 v159, v41, v159, vcc
v_xor_b32 v158, v158, v161
v_lshl_add_u32 v159, v158, 6, v159
v_add_u32 v29, v162, v159
v_and_b32 v38, 6, v36
v_lshrrev_b32 v39, 1, v37
v_and_b32 v40, 1, v37
v_lshlrev_b32 v40, 3, v40
v_add_u32 v40, v162, v40
v_lshl_add_u32 v40, v39, 4, v40
v_xor_b32 v39, 0, v38
v_lshl_add_u32 v2, v39, 4, v40
v_add_u32 v2, 73728, v2
v_xor_b32_e64 v39, 2, v38
v_lshl_add_u32 v3, v39, 4, v40
v_add_u32 v3, 73728, v3
v_xor_b32_e64 v39, 4, v38
v_lshl_add_u32 v4, v39, 4, v40
v_add_u32 v4, 73728, v4
v_xor_b32_e64 v39, 6, v38
v_lshl_add_u32 v5, v39, 4, v40
v_add_u32 v5, 73728, v5
v_lshrrev_b32_e64 v36, 3, v0
v_bfe_u32 v37, v0, 2, 1
v_bfe_u32 v38, v0, 4, 1
v_xor_b32 v37, v37, v38
v_and_b32 v38, 3, v0
v_bfe_u32 v39, v0, 5, 1
v_lshlrev_b32 v39, 1, v39
v_xor_b32 v38, v38, v39
v_mov_b32 v41, s64
v_mul_u32_u24 v40, v37, v41
v_add_u32 v40, v40, v38
v_cmp_eq_u32 vcc, 0, v37
v_mov_b32 v37, s60
s_nop 0
v_cndmask_b32 v41, v37, v41, vcc
v_cmp_lt_u32 vcc, v38, v41
v_and_b32 v37, 3, v36
v_and_b32 v38, 12, v36
v_lshl_or_b32 v37, v38, 1, v37
v_lshrrev_b32_e64 v38, 4, v36
v_lshl_or_b32 v37, v38, 2, v37
v_lshl_add_u32 v40, v40, 4, s59
v_mad_u32_u24 v40, v37, s61, v40
v_mov_b32 v37, 1073741824
v_cndmask_b32 v16, v37, v40, vcc
s_and_b32 s62, s3, 3
s_cmp_eq_u32 s62, 2
s_cselect_b32 s62, 20, 18
s_cmp_lt_u32 s33, s62
s_cselect_b32 s57, 1, 0
s_cselect_b32 s18, 663552, 0
s_cmp_ge_u32 s33, 18
s_cselect_b32 s62, 16, 0
s_mul_i32 s63, s3, 18
s_add_u32 s63, s63, s33
s_add_u32 s63, s63, s62
s_mul_i32 s55, s63, 7282
s_lshr_b32 s55, s55, 16
s_mul_i32 s62, s55, 9
s_sub_u32 s56, s63, s62
s_mov_b32 s16, s44
s_mov_b32 s17, s45
s_mov_b32 s19, 0x20000
s_sub_u32 s92, s42, 2048
s_subb_u32 s93, s43, 0
s_mov_b32 s94, 1992704
s_mov_b32 s95, 0x20000
s_add_u32 s20, s50, 0
s_addc_u32 s21, s51, 0
s_mov_b32 s22, 2899968
s_mov_b32 s23, 0x20000
s_mov_b32 s24, s48
s_mov_b32 s25, s49
s_mov_b32 s26, 256
s_mov_b32 s27, 0x20000
s_mov_b32 s28, s46
s_mov_b32 s29, s47
s_mov_b32 s30, 4718592
s_mov_b32 s31, 0x20000
v_lshrrev_b32 v36, 3, v0
v_and_b32 v37, 7, v0
v_and_b32 v38, 6, v36
v_xor_b32 v37, v37, v38
s_lshl_b32 s62, s56, 7
v_lshl_add_u32 v37, v37, 4, s62
v_mul_u32_u24 v38, 1152, v36
v_add_u32 v48, v37, v38
v_bfe_u32 v38, v36, 2, 2
v_lshrrev_b32 v39, 4, v36
v_lshl_add_u32 v38, v38, 1, v39
v_mul_u32_u24 v38, 36, v38
v_and_b32_e64 v39, 3, v36
v_add3_u32 v38, v38, v39, 32
v_mul_u32_u24 v38, 1152, v38
v_add_u32 v49, v37, v38
s_lshr_b32 s62, s52, 1
s_mul_i32 s62, s62, 5120
s_and_b32 s63, s52, 1
s_lshl_b32 s63, s63, 3
s_add_u32 s62, s62, s63
s_nop 0
s_add_u32 s62, s62, 110592
v_lshl_add_u32 v42, v10, 4, s62
s_mul_i32 s62, s52, 5120
s_add_u32 s62, s62, 90112
v_lshl_add_u32 v30, v10, 4, s62
s_lshl_b32 s63, s52, 2
s_lshr_b32 s62, 8448, s63
s_and_b32 s62, s62, 15
s_lshl_b32 s62, s62, 10
s_add_u32 s62, s62, 90112
v_lshl_add_u32 v44, v10, 4, s62
s_lshr_b32 s62, 12866, s63
s_and_b32 s62, s62, 15
s_lshl_b32 s62, s62, 10
s_add_u32 s62, s62, 90112
v_lshl_add_u32 v45, v10, 4, s62
s_lshr_b32 s62, 8464, s63
s_and_b32 s62, s62, 15
s_lshl_b32 s62, s62, 10
s_add_u32 s62, s62, 90112
v_lshl_add_u32 v46, v10, 4, s62
s_lshr_b32 s62, 17219, s63
s_and_b32 s62, s62, 15
s_lshl_b32 s62, s62, 10
s_add_u32 s62, s62, 90112
v_lshl_add_u32 v47, v10, 4, s62
s_mul_i32 s62, s90, 33792
v_lshl_add_u32 v36, v0, 4, s62
v_mov_b32 v37, 1073741824
v_cmp_gt_u32 vcc, 190, v0
s_nop 1
v_cndmask_b32 v31, v37, v36, vcc
v_mul_u32_u24 v36, 96, v11
v_lshl_add_u32 v36, v12, 3, v36
v_add_u32 v50, 147456, v36
v_and_b32_e64 v36, 1, v11
v_mul_u32_u24 v36, 96, v36
v_lshl_add_u32 v36, v12, 3, v36
v_add_u32 v51, 150912, v36
s_mul_i32 s62, s53, 12
s_add_u32 s62, s62, s52
s_lshl_b32 s62, s62, 4
s_lshr_b32 s34, s90, 3
s_xor_b32 s34, s34, s90
s_and_b32 s34, s34, 1
s_lshl_b32 s34, s34, 3
s_lshr_b32 s35, s90, 1
s_add_u32 s34, s34, s35
s_add_u32 s34, s34, s62
s_add_u32 s62, s62, s90
s_lshl_b32 s63, s34, 10
s_add_u32 s63, s63, 540672
v_lshl_add_u32 v52, v10, 4, s63
s_lshl_b32 s63, s62, 7
s_add_u32 s63, s63, 2637824
v_lshl_add_u32 v36, v11, 3, s63
v_cndmask_b32 v53, v37, v36, s[72:73]
s_lshl_b32 s62, s55, 2
s_add_u32 s62, s62, s52
s_lshl_b32 s63, s62, 15
s_add_u32 s63, s63, 540672
v_lshl_add_u32 v6, v10, 4, s63
s_lshl_b32 s63, s62, 12
s_add_u32 s63, s63, 2637824
v_lshl_add_u32 v36, v11, 3, s63
v_lshl_add_u32 v7, v12, 8, v36
s_lshl_b32 s62, s62, 5
v_lshrrev_b32 v37, 3, v10
v_add_u32 v36, s62, v37
v_mul_u32_u24 v36, 2304, v36
v_and_b32 v38, 7, v10
v_lshl_add_u32 v36, v38, 4, v36
s_lshl_b32 s62, s56, 7
s_add_u32 s62, s62, 1152
v_add_u32_e64 v8, s62, v36
s_mul_i32 s62, s52, 4608
v_mul_u32_u24 v37, 144, v37
v_lshl_add_u32 v37, v38, 4, v37
v_add_u32_e64 v251, s62, v37
v_mul_u32_u24 v37, 144, v11
v_lshl_add_u32 v37, v12, 3, v37
v_add_u32 v250, s62, v37
v_mov_b32 v55, 0
s_bitcmp1_b32 s56, 0
s_cselect_b32 s62, 0, 0
s_mul_i32 s86, s62, 41472
s_bitcmp1_b32 s56, 0
s_cselect_b32 s62, 9, 9
s_mul_i32 s87, s62, 41472
s_bitcmp1_b32 s56, 0
s_cselect_b32 s62, 1, 1
s_mul_i32 s88, s62, 41472
s_bitcmp1_b32 s56, 0
s_cselect_b32 s62, 8, 8
s_mul_i32 s89, s62, 41472
s_add_u32 s6, s4, L_TABB-L_PC
s_addc_u32 s7, s5, 0
s_mov_b32 s78, 0
v_mov_b32 v38, 0
v_mov_b32 v39, 0
v_mov_b32 v40, 0
v_mov_b32 v41, 0
v_lshlrev_b32_e64 v36, 4, v0
v_add_u32 v37, 147456, v36
ds_write_b128 v37, v[38:41]
ds_write_b128 v37, v[38:41] offset:4096
s_add_u32 m0, s65, 24576
s_add_u32 s83, s83, 1
s_cmp_eq_u32 s83, 9
s_cselect_b32 s83, 0, s83
s_lshl_b32 s80, s83, 7
buffer_load_dwordx4 v176, s[8:11], s80 offen offset:0 lds
buffer_load_dwordx4 v177, s[8:11], s80 offen offset:1024 lds
buffer_load_dwordx4 v178, s[8:11], s80 offen offset:2048 lds
buffer_load_dwordx4 v179, s[8:11], s80 offen offset:3072 lds
s_add_u32 m0, s65, 28672
s_nop 0
s_nop 0
buffer_load_dwordx4 v180, s[8:11], s80 offen offset:0 lds
buffer_load_dwordx4 v181, s[8:11], s80 offen offset:1024 lds
s_add_u32 m0, s82, 90112
s_mul_i32 s81, s83, 221184
buffer_load_dwordx4 v182, s[12:15], s81 offen offset:0 lds
buffer_load_dwordx4 v183, s[12:15], s81 offen offset:1024 lds
buffer_load_dwordx4 v184, s[12:15], s81 offen offset:2048 lds
buffer_load_dwordx4 v185, s[12:15], s81 offen offset:3072 lds
s_waitcnt vmcnt(10)
s_barrier
ds_read_b128 a[0:3], v17 offset:0
ds_read_b128 a[4:7], v17 offset:2048
ds_read_b128 a[8:11], v17 offset:4096
ds_read_b64_tr_b16 v[116:117], v22 offset:0
ds_read_b64_tr_b16 v[118:119], v22 offset:1024
ds_read_b64_tr_b16 v[120:121], v23 offset:0
ds_read_b64_tr_b16 v[122:123], v23 offset:1024
ds_read_b64_tr_b16 v[124:125], v24 offset:0
ds_read_b64_tr_b16 v[126:127], v24 offset:1024
ds_read_b64_tr_b16 v[128:129], v25 offset:0
ds_read_b64_tr_b16 v[130:131], v25 offset:1024
ds_read_b64_tr_b16 v[132:133], v26 offset:0
ds_read_b64_tr_b16 v[134:135], v26 offset:1024
ds_read_b128 a[12:15], v18 offset:0
ds_read_b128 a[16:19], v18 offset:2048
ds_read_b128 a[20:23], v18 offset:4096
s_waitcnt lgkmcnt(3)
v_mfma_f32_16x16x32_bf16 v[56:59], a[0:3], v[116:119], v[240:243]
ds_read_b64_tr_b16 v[136:137], v22 offset:2048
s_add_u32 m0, s65, 49152
v_mfma_f32_16x16x32_bf16 v[76:79], a[4:7], v[116:119], v[240:243]
ds_read_b64_tr_b16 v[138:139], v22 offset:3072
s_add_u32 s83, s83, 1
v_mfma_f32_16x16x32_bf16 v[96:99], a[8:11], v[116:119], v[240:243]
ds_read_b64_tr_b16 v[140:141], v23 offset:2048
s_cmp_eq_u32 s83, 9
s_cselect_b32 s83, 0, s83
v_mfma_f32_16x16x32_bf16 v[60:63], a[0:3], v[120:123], v[240:243]
ds_read_b64_tr_b16 v[142:143], v23 offset:3072
s_lshl_b32 s80, s83, 7
v_mfma_f32_16x16x32_bf16 v[80:83], a[4:7], v[120:123], v[240:243]
ds_read_b64_tr_b16 v[144:145], v24 offset:2048
buffer_load_dwordx4 v176, s[8:11], s80 offen offset:0 lds
v_mfma_f32_16x16x32_bf16 v[100:103], a[8:11], v[120:123], v[240:243]
ds_read_b64_tr_b16 v[146:147], v24 offset:3072
buffer_load_dwordx4 v177, s[8:11], s80 offen offset:1024 lds
v_mfma_f32_16x16x32_bf16 v[64:67], a[0:3], v[124:127], v[244:247]
ds_read_b64_tr_b16 v[148:149], v25 offset:2048
buffer_load_dwordx4 v178, s[8:11], s80 offen offset:2048 lds
buffer_load_dwordx4 v179, s[8:11], s80 offen offset:3072 lds
v_mfma_f32_16x16x32_bf16 v[84:87], a[4:7], v[124:127], v[244:247]
ds_read_b64_tr_b16 v[150:151], v25 offset:3072
s_add_u32 m0, s65, 53248
v_mfma_f32_16x16x32_bf16 v[104:107], a[8:11], v[124:127], v[244:247]
ds_read_b64_tr_b16 v[152:153], v26 offset:2048
buffer_load_dwordx4 v180, s[8:11], s80 offen offset:0 lds
v_mfma_f32_16x16x32_bf16 v[68:71], a[0:3], v[128:131], 0
ds_read_b64_tr_b16 v[154:155], v26 offset:3072
buffer_load_dwordx4 v181, s[8:11], s80 offen offset:1024 lds
v_mfma_f32_16x16x32_bf16 v[88:91], a[4:7], v[128:131], 0
s_add_u32 m0, s82, 106496
s_mul_i32 s81, s83, 221184
v_mfma_f32_16x16x32_bf16 v[108:111], a[8:11], v[128:131], 0
buffer_load_dwordx4 v182, s[12:15], s81 offen offset:0 lds
v_mfma_f32_16x16x32_bf16 v[72:75], a[0:3], v[132:135], v[186:189]
buffer_load_dwordx4 v183, s[12:15], s81 offen offset:1024 lds
v_mfma_f32_16x16x32_bf16 v[92:95], a[4:7], v[132:135], v[186:189]
buffer_load_dwordx4 v184, s[12:15], s81 offen offset:2048 lds
buffer_load_dwordx4 v185, s[12:15], s81 offen offset:3072 lds
v_mfma_f32_16x16x32_bf16 v[112:115], a[8:11], v[132:135], v[190:193]
s_waitcnt vmcnt(10)
s_barrier
s_waitcnt lgkmcnt(0)
v_mfma_f32_16x16x32_bf16 v[56:59], a[12:15], v[136:139], v[56:59]
ds_read_b128 a[24:27], v17 offset:24576
v_mfma_f32_16x16x32_bf16 v[76:79], a[16:19], v[136:139], v[76:79]
ds_read_b128 a[28:31], v17 offset:26624
s_add_u32 m0, s65, 0
v_mfma_f32_16x16x32_bf16 v[96:99], a[20:23], v[136:139], v[96:99]
ds_read_b128 a[32:35], v17 offset:28672
s_add_u32 s83, s83, 1
s_cmp_eq_u32 s83, 9
s_cselect_b32 s83, 0, s83
v_mfma_f32_16x16x32_bf16 v[60:63], a[12:15], v[140:143], v[60:63]
ds_read_b64_tr_b16 v[116:117], v22 offset:16384
v_mfma_f32_16x16x32_bf16 v[80:83], a[16:19], v[140:143], v[80:83]
ds_read_b64_tr_b16 v[118:119], v22 offset:17408
s_lshl_b32 s80, s83, 7
v_mfma_f32_16x16x32_bf16 v[100:103], a[20:23], v[140:143], v[100:103]
ds_read_b64_tr_b16 v[120:121], v23 offset:16384
ds_read_b64_tr_b16 v[122:123], v23 offset:17408
buffer_load_dwordx4 v176, s[8:11], s80 offen offset:0 lds
buffer_load_dwordx4 v177, s[8:11], s80 offen offset:1024 lds
v_mfma_f32_16x16x32_bf16 v[64:67], a[12:15], v[144:147], v[64:67]
ds_read_b64_tr_b16 v[124:125], v24 offset:16384
buffer_load_dwordx4 v178, s[8:11], s80 offen offset:2048 lds
v_mfma_f32_16x16x32_bf16 v[84:87], a[16:19], v[144:147], v[84:87]
ds_read_b64_tr_b16 v[126:127], v24 offset:17408
buffer_load_dwordx4 v179, s[8:11], s80 offen offset:3072 lds
v_mfma_f32_16x16x32_bf16 v[104:107], a[20:23], v[144:147], v[104:107]
ds_read_b64_tr_b16 v[128:129], v25 offset:16384
s_add_u32 m0, s65, 4096
s_nop 0
buffer_load_dwordx4 v180, s[8:11], s80 offen offset:0 lds
v_mfma_f32_16x16x32_bf16 v[68:71], a[12:15], v[148:151], v[68:71]
ds_read_b64_tr_b16 v[130:131], v25 offset:17408
buffer_load_dwordx4 v181, s[8:11], s80 offen offset:1024 lds
v_mfma_f32_16x16x32_bf16 v[88:91], a[16:19], v[148:151], v[88:91]
ds_read_b64_tr_b16 v[132:133], v26 offset:16384
ds_read_b64_tr_b16 v[134:135], v26 offset:17408
s_add_u32 m0, s82, 122880
v_mfma_f32_16x16x32_bf16 v[108:111], a[20:23], v[148:151], v[108:111]
ds_read_b128 a[36:39], v18 offset:24576
s_mul_i32 s81, s83, 221184
buffer_load_dwordx4 v182, s[12:15], s81 offen offset:0 lds
v_mfma_f32_16x16x32_bf16 v[72:75], a[12:15], v[152:155], v[72:75]
ds_read_b128 a[40:43], v18 offset:26624
buffer_load_dwordx4 v183, s[12:15], s81 offen offset:1024 lds
v_mfma_f32_16x16x32_bf16 v[92:95], a[16:19], v[152:155], v[92:95]
ds_read_b128 a[44:47], v18 offset:28672
buffer_load_dwordx4 v184, s[12:15], s81 offen offset:2048 lds
buffer_load_dwordx4 v185, s[12:15], s81 offen offset:3072 lds
v_mfma_f32_16x16x32_bf16 v[112:115], a[20:23], v[152:155], v[112:115]
s_waitcnt lgkmcnt(3)
v_mfma_f32_16x16x32_bf16 v[56:59], a[24:27], v[116:119], v[56:59]
ds_read_b64_tr_b16 v[136:137], v22 offset:18432
v_mfma_f32_16x16x32_bf16 v[76:79], a[28:31], v[116:119], v[76:79]
ds_read_b64_tr_b16 v[138:139], v22 offset:19456
s_waitcnt lgkmcnt(2)
v_mfma_f32_16x16x32_bf16 v[96:99], a[32:35], v[116:119], v[96:99]
ds_read_b64_tr_b16 v[140:141], v23 offset:18432
s_add_u32 m0, s65, 24576
v_mfma_f32_16x16x32_bf16 v[60:63], a[24:27], v[120:123], v[60:63]
ds_read_b64_tr_b16 v[142:143], v23 offset:19456
s_add_u32 s83, s83, 1
v_mfma_f32_16x16x32_bf16 v[80:83], a[28:31], v[120:123], v[80:83]
ds_read_b64_tr_b16 v[144:145], v24 offset:18432
s_cmp_eq_u32 s83, 9
s_cselect_b32 s83, 0, s83
v_mfma_f32_16x16x32_bf16 v[100:103], a[32:35], v[120:123], v[100:103]
ds_read_b64_tr_b16 v[146:147], v24 offset:19456
v_mfma_f32_16x16x32_bf16 v[64:67], a[24:27], v[124:127], v[64:67]
ds_read_b64_tr_b16 v[148:149], v25 offset:18432
s_lshl_b32 s80, s83, 7
v_mfma_f32_16x16x32_bf16 v[84:87], a[28:31], v[124:127], v[84:87]
ds_read_b64_tr_b16 v[150:151], v25 offset:19456
buffer_load_dwordx4 v176, s[8:11], s80 offen offset:0 lds
v_mfma_f32_16x16x32_bf16 v[104:107], a[32:35], v[124:127], v[104:107]
ds_read_b64_tr_b16 v[152:153], v26 offset:18432
buffer_load_dwordx4 v177, s[8:11], s80 offen offset:1024 lds
v_mfma_f32_16x16x32_bf16 v[68:71], a[24:27], v[128:131], v[68:71]
ds_read_b64_tr_b16 v[154:155], v26 offset:19456
buffer_load_dwordx4 v178, s[8:11], s80 offen offset:2048 lds
v_mfma_f32_16x16x32_bf16 v[88:91], a[28:31], v[128:131], v[88:91]
buffer_load_dwordx4 v179, s[8:11], s80 offen offset:3072 lds
v_mfma_f32_16x16x32_bf16 v[108:111], a[32:35], v[128:131], v[108:111]
s_add_u32 m0, s65, 28672
v_mfma_f32_16x16x32_bf16 v[72:75], a[24:27], v[132:135], v[72:75]
buffer_load_dwordx4 v180, s[8:11], s80 offen offset:0 lds
v_mfma_f32_16x16x32_bf16 v[92:95], a[28:31], v[132:135], v[92:95]
buffer_load_dwordx4 v181, s[8:11], s80 offen offset:1024 lds
v_mfma_f32_16x16x32_bf16 v[112:115], a[32:35], v[132:135], v[112:115]
s_waitcnt vmcnt(16)
s_barrier
s_waitcnt lgkmcnt(0)
v_mfma_f32_16x16x32_bf16 v[56:59], a[36:39], v[136:139], v[56:59]
ds_read_b128 a[48:51], v17 offset:49152
v_mfma_f32_16x16x32_bf16 v[76:79], a[40:43], v[136:139], v[76:79]
ds_read_b128 a[52:55], v17 offset:51200
v_mfma_f32_16x16x32_bf16 v[96:99], a[44:47], v[136:139], v[96:99]
ds_read_b128 a[56:59], v17 offset:53248
s_add_u32 m0, s82, 73728
v_mfma_f32_16x16x32_bf16 v[60:63], a[36:39], v[140:143], v[60:63]
ds_read_b64_tr_b16 v[116:117], v22 offset:32768
v_mfma_f32_16x16x32_bf16 v[80:83], a[40:43], v[140:143], v[80:83]
ds_read_b64_tr_b16 v[118:119], v22 offset:33792
s_mul_i32 s81, s83, 221184
v_mfma_f32_16x16x32_bf16 v[100:103], a[44:47], v[140:143], v[100:103]
ds_read_b64_tr_b16 v[120:121], v23 offset:32768
ds_read_b64_tr_b16 v[122:123], v23 offset:33792
v_mfma_f32_16x16x32_bf16 v[64:67], a[36:39], v[144:147], v[64:67]
ds_read_b64_tr_b16 v[124:125], v24 offset:32768
buffer_load_dwordx4 v182, s[12:15], s81 offen offset:0 lds
v_mfma_f32_16x16x32_bf16 v[84:87], a[40:43], v[144:147], v[84:87]
ds_read_b64_tr_b16 v[126:127], v24 offset:33792
v_mfma_f32_16x16x32_bf16 v[104:107], a[44:47], v[144:147], v[104:107]
ds_read_b64_tr_b16 v[128:129], v25 offset:32768
v_mfma_f32_16x16x32_bf16 v[68:71], a[36:39], v[148:151], v[68:71]
ds_read_b64_tr_b16 v[130:131], v25 offset:33792
buffer_load_dwordx4 v183, s[12:15], s81 offen offset:1024 lds
v_mfma_f32_16x16x32_bf16 v[88:91], a[40:43], v[148:151], v[88:91]
ds_read_b64_tr_b16 v[132:133], v26 offset:32768
ds_read_b64_tr_b16 v[134:135], v26 offset:33792
v_mfma_f32_16x16x32_bf16 v[108:111], a[44:47], v[148:151], v[108:111]
ds_read_b128 a[60:63], v18 offset:49152
buffer_load_dwordx4 v184, s[12:15], s81 offen offset:2048 lds
v_mfma_f32_16x16x32_bf16 v[72:75], a[36:39], v[152:155], v[72:75]
ds_read_b128 a[64:67], v18 offset:51200
v_mfma_f32_16x16x32_bf16 v[92:95], a[40:43], v[152:155], v[92:95]
ds_read_b128 a[68:71], v18 offset:53248
buffer_load_dwordx4 v185, s[12:15], s81 offen offset:3072 lds
v_mfma_f32_16x16x32_bf16 v[112:115], a[44:47], v[152:155], v[112:115]
s_waitcnt lgkmcnt(3)
v_mfma_f32_16x16x32_bf16 v[56:59], a[48:51], v[116:119], v[56:59]
ds_read_b64_tr_b16 v[136:137], v22 offset:34816
v_mfma_f32_16x16x32_bf16 v[76:79], a[52:55], v[116:119], v[76:79]
ds_read_b64_tr_b16 v[138:139], v22 offset:35840
s_waitcnt lgkmcnt(2)
v_mfma_f32_16x16x32_bf16 v[96:99], a[56:59], v[116:119], v[96:99]
ds_read_b64_tr_b16 v[140:141], v23 offset:34816
s_add_u32 m0, s65, 49152
v_mfma_f32_16x16x32_bf16 v[60:63], a[48:51], v[120:123], v[60:63]
ds_read_b64_tr_b16 v[142:143], v23 offset:35840
s_add_u32 s83, s83, 1
v_mfma_f32_16x16x32_bf16 v[80:83], a[52:55], v[120:123], v[80:83]
ds_read_b64_tr_b16 v[144:145], v24 offset:34816
s_cmp_eq_u32 s83, 9
s_cselect_b32 s83, 0, s83
v_mfma_f32_16x16x32_bf16 v[100:103], a[56:59], v[120:123], v[100:103]
ds_read_b64_tr_b16 v[146:147], v24 offset:35840
v_mfma_f32_16x16x32_bf16 v[64:67], a[48:51], v[124:127], v[64:67]
ds_read_b64_tr_b16 v[148:149], v25 offset:34816
s_lshl_b32 s80, s83, 7
v_mfma_f32_16x16x32_bf16 v[84:87], a[52:55], v[124:127], v[84:87]
ds_read_b64_tr_b16 v[150:151], v25 offset:35840
buffer_load_dwordx4 v176, s[8:11], s80 offen offset:0 lds
v_mfma_f32_16x16x32_bf16 v[104:107], a[56:59], v[124:127], v[104:107]
ds_read_b64_tr_b16 v[152:153], v26 offset:34816
buffer_load_dwordx4 v177, s[8:11], s80 offen offset:1024 lds
v_mfma_f32_16x16x32_bf16 v[68:71], a[48:51], v[128:131], v[68:71]
ds_read_b64_tr_b16 v[154:155], v26 offset:35840
buffer_load_dwordx4 v178, s[8:11], s80 offen offset:2048 lds
v_mfma_f32_16x16x32_bf16 v[88:91], a[52:55], v[128:131], v[88:91]
buffer_load_dwordx4 v179, s[8:11], s80 offen offset:3072 lds
v_mfma_f32_16x16x32_bf16 v[108:111], a[56:59], v[128:131], v[108:111]
s_add_u32 m0, s65, 53248
v_mfma_f32_16x16x32_bf16 v[72:75], a[48:51], v[132:135], v[72:75]
buffer_load_dwordx4 v180, s[8:11], s80 offen offset:0 lds
v_mfma_f32_16x16x32_bf16 v[92:95], a[52:55], v[132:135], v[92:95]
buffer_load_dwordx4 v181, s[8:11], s80 offen offset:1024 lds
v_mfma_f32_16x16x32_bf16 v[112:115], a[56:59], v[132:135], v[112:115]
s_waitcnt vmcnt(16)
s_barrier
s_waitcnt lgkmcnt(0)
v_mfma_f32_16x16x32_bf16 v[56:59], a[60:63], v[136:139], v[56:59]
ds_read_b128 a[72:75], v17 offset:0
v_mfma_f32_16x16x32_bf16 v[76:79], a[64:67], v[136:139], v[76:79]
ds_read_b128 a[76:79], v17 offset:2048
v_mfma_f32_16x16x32_bf16 v[96:99], a[68:71], v[136:139], v[96:99]
ds_read_b128 a[80:83], v17 offset:4096
s_add_u32 m0, s82, 90112
v_mfma_f32_16x16x32_bf16 v[60:63], a[60:63], v[140:143], v[60:63]
ds_read_b64_tr_b16 v[116:117], v22 offset:49152
v_mfma_f32_16x16x32_bf16 v[80:83], a[64:67], v[140:143], v[80:83]
ds_read_b64_tr_b16 v[118:119], v22 offset:50176
s_mul_i32 s81, s83, 221184
v_mfma_f32_16x16x32_bf16 v[100:103], a[68:71], v[140:143], v[100:103]
ds_read_b64_tr_b16 v[120:121], v23 offset:49152
ds_read_b64_tr_b16 v[122:123], v23 offset:50176
v_mfma_f32_16x16x32_bf16 v[64:67], a[60:63], v[144:147], v[64:67]
ds_read_b64_tr_b16 v[124:125], v24 offset:49152
buffer_load_dwordx4 v182, s[12:15], s81 offen offset:0 lds
v_mfma_f32_16x16x32_bf16 v[84:87], a[64:67], v[144:147], v[84:87]
ds_read_b64_tr_b16 v[126:127], v24 offset:50176
v_mfma_f32_16x16x32_bf16 v[104:107], a[68:71], v[144:147], v[104:107]
ds_read_b64_tr_b16 v[128:129], v25 offset:49152
v_mfma_f32_16x16x32_bf16 v[68:71], a[60:63], v[148:151], v[68:71]
ds_read_b64_tr_b16 v[130:131], v25 offset:50176
buffer_load_dwordx4 v183, s[12:15], s81 offen offset:1024 lds
v_mfma_f32_16x16x32_bf16 v[88:91], a[64:67], v[148:151], v[88:91]
ds_read_b64_tr_b16 v[132:133], v26 offset:49152
ds_read_b64_tr_b16 v[134:135], v26 offset:50176
v_mfma_f32_16x16x32_bf16 v[108:111], a[68:71], v[148:151], v[108:111]
ds_read_b128 a[84:87], v18 offset:0
buffer_load_dwordx4 v184, s[12:15], s81 offen offset:2048 lds
v_mfma_f32_16x16x32_bf16 v[72:75], a[60:63], v[152:155], v[72:75]
ds_read_b128 a[88:91], v18 offset:2048
v_mfma_f32_16x16x32_bf16 v[92:95], a[64:67], v[152:155], v[92:95]
ds_read_b128 a[92:95], v18 offset:4096
buffer_load_dwordx4 v185, s[12:15], s81 offen offset:3072 lds
v_mfma_f32_16x16x32_bf16 v[112:115], a[68:71], v[152:155], v[112:115]
s_waitcnt lgkmcnt(3)
v_mfma_f32_16x16x32_bf16 v[56:59], a[72:75], v[116:119], v[56:59]
ds_read_b64_tr_b16 v[136:137], v22 offset:51200
v_mfma_f32_16x16x32_bf16 v[76:79], a[76:79], v[116:119], v[76:79]
ds_read_b64_tr_b16 v[138:139], v22 offset:52224
s_waitcnt lgkmcnt(2)
v_mfma_f32_16x16x32_bf16 v[96:99], a[80:83], v[116:119], v[96:99]
ds_read_b64_tr_b16 v[140:141], v23 offset:51200
s_add_u32 m0, s65, 0
v_mfma_f32_16x16x32_bf16 v[60:63], a[72:75], v[120:123], v[60:63]
ds_read_b64_tr_b16 v[142:143], v23 offset:52224
s_add_u32 s83, s83, 1
v_mfma_f32_16x16x32_bf16 v[80:83], a[76:79], v[120:123], v[80:83]
ds_read_b64_tr_b16 v[144:145], v24 offset:51200
s_cmp_eq_u32 s83, 9
s_cselect_b32 s83, 0, s83
v_mfma_f32_16x16x32_bf16 v[100:103], a[80:83], v[120:123], v[100:103]
ds_read_b64_tr_b16 v[146:147], v24 offset:52224
v_mfma_f32_16x16x32_bf16 v[64:67], a[72:75], v[124:127], v[64:67]
ds_read_b64_tr_b16 v[148:149], v25 offset:51200
s_lshl_b32 s80, s83, 7
v_mfma_f32_16x16x32_bf16 v[84:87], a[76:79], v[124:127], v[84:87]
ds_read_b64_tr_b16 v[150:151], v25 offset:52224
buffer_load_dwordx4 v176, s[8:11], s80 offen offset:0 lds
v_mfma_f32_16x16x32_bf16 v[104:107], a[80:83], v[124:127], v[104:107]
ds_read_b64_tr_b16 v[152:153], v26 offset:51200
buffer_load_dwordx4 v177, s[8:11], s80 offen offset:1024 lds
v_mfma_f32_16x16x32_bf16 v[68:71], a[72:75], v[128:131], v[68:71]
ds_read_b64_tr_b16 v[154:155], v26 offset:52224
buffer_load_dwordx4 v178, s[8:11], s80 offen offset:2048 lds
v_mfma_f32_16x16x32_bf16 v[88:91], a[76:79], v[128:131], v[88:91]
buffer_load_dwordx4 v179, s[8:11], s80 offen offset:3072 lds
v_mfma_f32_16x16x32_bf16 v[108:111], a[80:83], v[128:131], v[108:111]
s_add_u32 m0, s65, 4096
v_mfma_f32_16x16x32_bf16 v[72:75], a[72:75], v[132:135], v[72:75]
buffer_load_dwordx4 v180, s[8:11], s80 offen offset:0 lds
v_mfma_f32_16x16x32_bf16 v[92:95], a[76:79], v[132:135], v[92:95]
buffer_load_dwordx4 v181, s[8:11], s80 offen offset:1024 lds
v_mfma_f32_16x16x32_bf16 v[112:115], a[80:83], v[132:135], v[112:115]
s_waitcnt vmcnt(16)
s_barrier
s_waitcnt lgkmcnt(0)
v_mfma_f32_16x16x32_bf16 v[56:59], a[84:87], v[136:139], v[56:59]
ds_read_b128 a[96:99], v17 offset:24576
v_mfma_f32_16x16x32_bf16 v[76:79], a[88:91], v[136:139], v[76:79]
ds_read_b128 a[100:103], v17 offset:26624
v_mfma_f32_16x16x32_bf16 v[96:99], a[92:95], v[136:139], v[96:99]
ds_read_b128 a[104:107], v17 offset:28672
s_add_u32 m0, s82, 106496
v_mfma_f32_16x16x32_bf16 v[60:63], a[84:87], v[140:143], v[60:63]
ds_read_b64_tr_b16 v[116:117], v22 offset:0
v_mfma_f32_16x16x32_bf16 v[80:83], a[88:91], v[140:143], v[80:83]
ds_read_b64_tr_b16 v[118:119], v22 offset:1024
s_mul_i32 s81, s83, 221184
v_mfma_f32_16x16x32_bf16 v[100:103], a[92:95], v[140:143], v[100:103]
ds_read_b64_tr_b16 v[120:121], v23 offset:0
ds_read_b64_tr_b16 v[122:123], v23 offset:1024
v_mfma_f32_16x16x32_bf16 v[64:67], a[84:87], v[144:147], v[64:67]
ds_read_b64_tr_b16 v[124:125], v24 offset:0
buffer_load_dwordx4 v182, s[12:15], s81 offen offset:0 lds
v_mfma_f32_16x16x32_bf16 v[84:87], a[88:91], v[144:147], v[84:87]
ds_read_b64_tr_b16 v[126:127], v24 offset:1024
v_mfma_f32_16x16x32_bf16 v[104:107], a[92:95], v[144:147], v[104:107]
ds_read_b64_tr_b16 v[128:129], v25 offset:0
v_mfma_f32_16x16x32_bf16 v[68:71], a[84:87], v[148:151], v[68:71]
ds_read_b64_tr_b16 v[130:131], v25 offset:1024
buffer_load_dwordx4 v183, s[12:15], s81 offen offset:1024 lds
v_mfma_f32_16x16x32_bf16 v[88:91], a[88:91], v[148:151], v[88:91]
ds_read_b64_tr_b16 v[132:133], v26 offset:0
ds_read_b64_tr_b16 v[134:135], v26 offset:1024
v_mfma_f32_16x16x32_bf16 v[108:111], a[92:95], v[148:151], v[108:111]
ds_read_b128 a[108:111], v18 offset:24576
buffer_load_dwordx4 v184, s[12:15], s81 offen offset:2048 lds
v_mfma_f32_16x16x32_bf16 v[72:75], a[84:87], v[152:155], v[72:75]
ds_read_b128 a[112:115], v18 offset:26624
v_mfma_f32_16x16x32_bf16 v[92:95], a[88:91], v[152:155], v[92:95]
ds_read_b128 a[116:119], v18 offset:28672
buffer_load_dwordx4 v185, s[12:15], s81 offen offset:3072 lds
v_mfma_f32_16x16x32_bf16 v[112:115], a[92:95], v[152:155], v[112:115]
s_waitcnt lgkmcnt(3)
v_mfma_f32_16x16x32_bf16 v[56:59], a[96:99], v[116:119], v[56:59]
ds_read_b64_tr_b16 v[136:137], v22 offset:2048
v_mfma_f32_16x16x32_bf16 v[76:79], a[100:103], v[116:119], v[76:79]
ds_read_b64_tr_b16 v[138:139], v22 offset:3072
s_waitcnt lgkmcnt(2)
v_mfma_f32_16x16x32_bf16 v[96:99], a[104:107], v[116:119], v[96:99]
ds_read_b64_tr_b16 v[140:141], v23 offset:2048
s_add_u32 m0, s65, 24576
v_mfma_f32_16x16x32_bf16 v[60:63], a[96:99], v[120:123], v[60:63]
ds_read_b64_tr_b16 v[142:143], v23 offset:3072
s_add_u32 s83, s83, 1
v_mfma_f32_16x16x32_bf16 v[80:83], a[100:103], v[120:123], v[80:83]
ds_read_b64_tr_b16 v[144:145], v24 offset:2048
s_cmp_eq_u32 s83, 9
s_cselect_b32 s83, 0, s83
v_mfma_f32_16x16x32_bf16 v[100:103], a[104:107], v[120:123], v[100:103]
ds_read_b64_tr_b16 v[146:147], v24 offset:3072
v_mfma_f32_16x16x32_bf16 v[64:67], a[96:99], v[124:127], v[64:67]
ds_read_b64_tr_b16 v[148:149], v25 offset:2048
s_lshl_b32 s80, s83, 7
v_mfma_f32_16x16x32_bf16 v[84:87], a[100:103], v[124:127], v[84:87]
ds_read_b64_tr_b16 v[150:151], v25 offset:3072
buffer_load_dwordx4 v176, s[8:11], s80 offen offset:0 lds
v_mfma_f32_16x16x32_bf16 v[104:107], a[104:107], v[124:127], v[104:107]
ds_read_b64_tr_b16 v[152:153], v26 offset:2048
buffer_load_dwordx4 v177, s[8:11], s80 offen offset:1024 lds
v_mfma_f32_16x16x32_bf16 v[68:71], a[96:99], v[128:131], v[68:71]
ds_read_b64_tr_b16 v[154:155], v26 offset:3072
buffer_load_dwordx4 v178, s[8:11], s80 offen offset:2048 lds
v_mfma_f32_16x16x32_bf16 v[88:91], a[100:103], v[128:131], v[88:91]
buffer_load_dwordx4 v179, s[8:11], s80 offen offset:3072 lds
v_mfma_f32_16x16x32_bf16 v[108:111], a[104:107], v[128:131], v[108:111]
s_add_u32 m0, s65, 28672
v_mfma_f32_16x16x32_bf16 v[72:75], a[96:99], v[132:135], v[72:75]
buffer_load_dwordx4 v180, s[8:11], s80 offen offset:0 lds
v_mfma_f32_16x16x32_bf16 v[92:95], a[100:103], v[132:135], v[92:95]
buffer_load_dwordx4 v181, s[8:11], s80 offen offset:1024 lds
v_mfma_f32_16x16x32_bf16 v[112:115], a[104:107], v[132:135], v[112:115]
s_waitcnt vmcnt(16)
s_barrier
s_waitcnt lgkmcnt(0)
v_mfma_f32_16x16x32_bf16 v[56:59], a[108:111], v[136:139], v[56:59]
ds_read_b128 a[120:123], v17 offset:49152
v_mfma_f32_16x16x32_bf16 v[76:79], a[112:115], v[136:139], v[76:79]
ds_read_b128 a[124:127], v17 offset:51200
v_mfma_f32_16x16x32_bf16 v[96:99], a[116:119], v[136:139], v[96:99]
ds_read_b128 a[128:131], v17 offset:53248
s_add_u32 m0, s82, 122880
v_mfma_f32_16x16x32_bf16 v[60:63], a[108:111], v[140:143], v[60:63]
ds_read_b64_tr_b16 v[116:117], v22 offset:16384
v_mfma_f32_16x16x32_bf16 v[80:83], a[112:115], v[140:143], v[80:83]
ds_read_b64_tr_b16 v[118:119], v22 offset:17408
s_mul_i32 s81, s83, 221184
v_mfma_f32_16x16x32_bf16 v[100:103], a[116:119], v[140:143], v[100:103]
ds_read_b64_tr_b16 v[120:121], v23 offset:16384
ds_read_b64_tr_b16 v[122:123], v23 offset:17408
v_mfma_f32_16x16x32_bf16 v[64:67], a[108:111], v[144:147], v[64:67]
ds_read_b64_tr_b16 v[124:125], v24 offset:16384
buffer_load_dwordx4 v182, s[12:15], s81 offen offset:0 lds
v_mfma_f32_16x16x32_bf16 v[84:87], a[112:115], v[144:147], v[84:87]
ds_read_b64_tr_b16 v[126:127], v24 offset:17408
v_mfma_f32_16x16x32_bf16 v[104:107], a[116:119], v[144:147], v[104:107]
ds_read_b64_tr_b16 v[128:129], v25 offset:16384
v_mfma_f32_16x16x32_bf16 v[68:71], a[108:111], v[148:151], v[68:71]
ds_read_b64_tr_b16 v[130:131], v25 offset:17408
buffer_load_dwordx4 v183, s[12:15], s81 offen offset:1024 lds
v_mfma_f32_16x16x32_bf16 v[88:91], a[112:115], v[148:151], v[88:91]
ds_read_b64_tr_b16 v[132:133], v26 offset:16384
ds_read_b64_tr_b16 v[134:135], v26 offset:17408
v_mfma_f32_16x16x32_bf16 v[108:111], a[116:119], v[148:151], v[108:111]
ds_read_b128 a[132:135], v18 offset:49152
buffer_load_dwordx4 v184, s[12:15], s81 offen offset:2048 lds
v_mfma_f32_16x16x32_bf16 v[72:75], a[108:111], v[152:155], v[72:75]
ds_read_b128 a[136:139], v18 offset:51200
v_mfma_f32_16x16x32_bf16 v[92:95], a[112:115], v[152:155], v[92:95]
ds_read_b128 a[140:143], v18 offset:53248
buffer_load_dwordx4 v185, s[12:15], s81 offen offset:3072 lds
v_mfma_f32_16x16x32_bf16 v[112:115], a[116:119], v[152:155], v[112:115]
s_waitcnt lgkmcnt(3)
v_mfma_f32_16x16x32_bf16 v[56:59], a[120:123], v[116:119], v[56:59]
ds_read_b64_tr_b16 v[136:137], v22 offset:18432
v_mfma_f32_16x16x32_bf16 v[76:79], a[124:127], v[116:119], v[76:79]
ds_read_b64_tr_b16 v[138:139], v22 offset:19456
s_waitcnt lgkmcnt(2)
v_mfma_f32_16x16x32_bf16 v[96:99], a[128:131], v[116:119], v[96:99]
ds_read_b64_tr_b16 v[140:141], v23 offset:18432
s_add_u32 m0, s65, 49152
v_mfma_f32_16x16x32_bf16 v[60:63], a[120:123], v[120:123], v[60:63]
ds_read_b64_tr_b16 v[142:143], v23 offset:19456
s_add_u32 s83, s83, 1
v_mfma_f32_16x16x32_bf16 v[80:83], a[124:127], v[120:123], v[80:83]
ds_read_b64_tr_b16 v[144:145], v24 offset:18432
s_cmp_eq_u32 s83, 9
s_cselect_b32 s83, 0, s83
v_mfma_f32_16x16x32_bf16 v[100:103], a[128:131], v[120:123], v[100:103]
ds_read_b64_tr_b16 v[146:147], v24 offset:19456
v_mfma_f32_16x16x32_bf16 v[64:67], a[120:123], v[124:127], v[64:67]
ds_read_b64_tr_b16 v[148:149], v25 offset:18432
s_lshl_b32 s80, s83, 7
v_mfma_f32_16x16x32_bf16 v[84:87], a[124:127], v[124:127], v[84:87]
ds_read_b64_tr_b16 v[150:151], v25 offset:19456
buffer_load_dwordx4 v176, s[8:11], s80 offen offset:0 lds
v_mfma_f32_16x16x32_bf16 v[104:107], a[128:131], v[124:127], v[104:107]
ds_read_b64_tr_b16 v[152:153], v26 offset:18432
buffer_load_dwordx4 v177, s[8:11], s80 offen offset:1024 lds
v_mfma_f32_16x16x32_bf16 v[68:71], a[120:123], v[128:131], v[68:71]
ds_read_b64_tr_b16 v[154:155], v26 offset:19456
buffer_load_dwordx4 v178, s[8:11], s80 offen offset:2048 lds
v_mfma_f32_16x16x32_bf16 v[88:91], a[124:127], v[128:131], v[88:91]
buffer_load_dwordx4 v179, s[8:11], s80 offen offset:3072 lds
v_mfma_f32_16x16x32_bf16 v[108:111], a[128:131], v[128:131], v[108:111]
s_add_u32 m0, s65, 53248
v_mfma_f32_16x16x32_bf16 v[72:75], a[120:123], v[132:135], v[72:75]
buffer_load_dwordx4 v180, s[8:11], s80 offen offset:0 lds
v_mfma_f32_16x16x32_bf16 v[92:95], a[124:127], v[132:135], v[92:95]
buffer_load_dwordx4 v181, s[8:11], s80 offen offset:1024 lds
v_mfma_f32_16x16x32_bf16 v[112:115], a[128:131], v[132:135], v[112:115]
s_waitcnt vmcnt(16)
s_barrier
s_waitcnt lgkmcnt(0)
v_mfma_f32_16x16x32_bf16 v[56:59], a[132:135], v[136:139], v[56:59]
ds_read_b128 a[144:147], v17 offset:0
v_mfma_f32_16x16x32_bf16 v[76:79], a[136:139], v[136:139], v[76:79]
ds_read_b128 a[148:151], v17 offset:2048
v_mfma_f32_16x16x32_bf16 v[96:99], a[140:143], v[136:139], v[96:99]
ds_read_b128 a[152:155], v17 offset:4096
s_add_u32 m0, s82, 73728
v_mfma_f32_16x16x32_bf16 v[60:63], a[132:135], v[140:143], v[60:63]
ds_read_b64_tr_b16 v[116:117], v22 offset:32768
v_mfma_f32_16x16x32_bf16 v[80:83], a[136:139], v[140:143], v[80:83]
ds_read_b64_tr_b16 v[118:119], v22 offset:33792
s_mul_i32 s81, s83, 221184
v_mfma_f32_16x16x32_bf16 v[100:103], a[140:143], v[140:143], v[100:103]
ds_read_b64_tr_b16 v[120:121], v23 offset:32768
ds_read_b64_tr_b16 v[122:123], v23 offset:33792
v_mfma_f32_16x16x32_bf16 v[64:67], a[132:135], v[144:147], v[64:67]
ds_read_b64_tr_b16 v[124:125], v24 offset:32768
buffer_load_dwordx4 v182, s[12:15], s81 offen offset:0 lds
v_mfma_f32_16x16x32_bf16 v[84:87], a[136:139], v[144:147], v[84:87]
ds_read_b64_tr_b16 v[126:127], v24 offset:33792
v_mfma_f32_16x16x32_bf16 v[104:107], a[140:143], v[144:147], v[104:107]
ds_read_b64_tr_b16 v[128:129], v25 offset:32768
v_mfma_f32_16x16x32_bf16 v[68:71], a[132:135], v[148:151], v[68:71]
ds_read_b64_tr_b16 v[130:131], v25 offset:33792
buffer_load_dwordx4 v183, s[12:15], s81 offen offset:1024 lds
v_mfma_f32_16x16x32_bf16 v[88:91], a[136:139], v[148:151], v[88:91]
ds_read_b64_tr_b16 v[132:133], v26 offset:32768
ds_read_b64_tr_b16 v[134:135], v26 offset:33792
v_mfma_f32_16x16x32_bf16 v[108:111], a[140:143], v[148:151], v[108:111]
ds_read_b128 a[156:159], v18 offset:0
buffer_load_dwordx4 v184, s[12:15], s81 offen offset:2048 lds
v_mfma_f32_16x16x32_bf16 v[72:75], a[132:135], v[152:155], v[72:75]
ds_read_b128 a[160:163], v18 offset:2048
v_mfma_f32_16x16x32_bf16 v[92:95], a[136:139], v[152:155], v[92:95]
ds_read_b128 a[164:167], v18 offset:4096
buffer_load_dwordx4 v185, s[12:15], s81 offen offset:3072 lds
v_mfma_f32_16x16x32_bf16 v[112:115], a[140:143], v[152:155], v[112:115]
s_waitcnt lgkmcnt(3)
v_mfma_f32_16x16x32_bf16 v[56:59], a[144:147], v[116:119], v[56:59]
ds_read_b64_tr_b16 v[136:137], v22 offset:34816
s_add_u32 s34, s84, 5
v_mfma_f32_16x16x32_bf16 v[76:79], a[148:151], v[116:119], v[76:79]
ds_read_b64_tr_b16 v[138:139], v22 offset:35840
s_sub_u32 s35, s34, 9
v_mfma_f32_16x16x32_bf16 v[96:99], a[152:155], v[116:119], v[96:99]
ds_read_b64_tr_b16 v[140:141], v23 offset:34816
s_cmp_ge_u32 s34, 9
s_cselect_b32 s34, s35, s34
v_mfma_f32_16x16x32_bf16 v[60:63], a[144:147], v[120:123], v[60:63]
ds_read_b64_tr_b16 v[142:143], v23 offset:35840
s_mul_i32 s36, s34, 221184
v_mfma_f32_16x16x32_bf16 v[80:83], a[148:151], v[120:123], v[80:83]
ds_read_b64_tr_b16 v[144:145], v24 offset:34816
s_add_u32 s34, s84, 6
s_sub_u32 s35, s34, 9
v_mfma_f32_16x16x32_bf16 v[100:103], a[152:155], v[120:123], v[100:103]
ds_read_b64_tr_b16 v[146:147], v24 offset:35840
s_cmp_ge_u32 s34, 9
s_cselect_b32 s34, s35, s34
v_mfma_f32_16x16x32_bf16 v[64:67], a[144:147], v[124:127], v[64:67]
ds_read_b64_tr_b16 v[148:149], v25 offset:34816
s_mul_i32 s37, s34, 221184
v_mfma_f32_16x16x32_bf16 v[84:87], a[148:151], v[124:127], v[84:87]
ds_read_b64_tr_b16 v[150:151], v25 offset:35840
s_add_u32 s34, s84, 7
v_mfma_f32_16x16x32_bf16 v[104:107], a[152:155], v[124:127], v[104:107]
ds_read_b64_tr_b16 v[152:153], v26 offset:34816
s_sub_u32 s35, s34, 9
v_mfma_f32_16x16x32_bf16 v[68:71], a[144:147], v[128:131], v[68:71]
ds_read_b64_tr_b16 v[154:155], v26 offset:35840
s_cmp_ge_u32 s34, 9
s_cselect_b32 s34, s35, s34
v_mfma_f32_16x16x32_bf16 v[88:91], a[148:151], v[128:131], v[88:91]
s_mul_i32 s38, s34, 221184
v_mfma_f32_16x16x32_bf16 v[108:111], a[152:155], v[128:131], v[108:111]
s_add_u32 s34, s84, 8
s_sub_u32 s35, s34, 9
v_mfma_f32_16x16x32_bf16 v[72:75], a[144:147], v[132:135], v[72:75]
s_cmp_ge_u32 s34, 9
s_cselect_b32 s34, s35, s34
v_mfma_f32_16x16x32_bf16 v[92:95], a[148:151], v[132:135], v[92:95]
s_mul_i32 s39, s34, 221184
v_mfma_f32_16x16x32_bf16 v[112:115], a[152:155], v[132:135], v[112:115]
s_waitcnt vmcnt(10)
s_waitcnt lgkmcnt(10)
s_barrier
s_waitcnt lgkmcnt(0)
v_mfma_f32_16x16x32_bf16 v[56:59], a[156:159], v[136:139], v[56:59]
ds_read_b128 a[168:171], v17 offset:24576
s_add_u32 m0, s82, 0
v_mfma_f32_16x16x32_bf16 v[76:79], a[160:163], v[136:139], v[76:79]
ds_read_b128 a[172:175], v17 offset:26624
s_mul_i32 s85, s84, 221184
v_mfma_f32_16x16x32_bf16 v[96:99], a[164:167], v[136:139], v[96:99]
ds_read_b128 a[176:179], v17 offset:28672
s_add_u32 s85, s85, 2048
v_mfma_f32_16x16x32_bf16 v[60:63], a[156:159], v[140:143], v[60:63]
ds_read_b64_tr_b16 v[116:117], v22 offset:49152
buffer_load_dwordx4 v16, s[92:95], s85 offen offset:0 lds
v_mfma_f32_16x16x32_bf16 v[80:83], a[160:163], v[140:143], v[80:83]
ds_read_b64_tr_b16 v[118:119], v22 offset:50176
s_add_u32 s79, s85, 109568
v_mfma_f32_16x16x32_bf16 v[100:103], a[164:167], v[140:143], v[100:103]
ds_read_b64_tr_b16 v[120:121], v23 offset:49152
ds_read_b64_tr_b16 v[122:123], v23 offset:50176
buffer_load_dwordx4 v16, s[92:95], s79 offen offset:1024 lds
v_mfma_f32_16x16x32_bf16 v[64:67], a[156:159], v[144:147], v[64:67]
ds_read_b64_tr_b16 v[124:125], v24 offset:49152
s_add_u32 s84, s84, 1
v_mfma_f32_16x16x32_bf16 v[84:87], a[160:163], v[144:147], v[84:87]
ds_read_b64_tr_b16 v[126:127], v24 offset:50176
s_cmp_eq_u32 s84, 9
s_cselect_b32 s84, 0, s84
v_mfma_f32_16x16x32_bf16 v[104:107], a[164:167], v[144:147], v[104:107]
ds_read_b64_tr_b16 v[128:129], v25 offset:49152
v_mfma_f32_16x16x32_bf16 v[68:71], a[156:159], v[148:151], v[68:71]
ds_read_b64_tr_b16 v[130:131], v25 offset:50176
s_mul_i32 s85, s84, 221184
v_mfma_f32_16x16x32_bf16 v[88:91], a[160:163], v[148:151], v[88:91]
ds_read_b64_tr_b16 v[132:133], v26 offset:49152
ds_read_b64_tr_b16 v[134:135], v26 offset:50176
s_add_u32 s85, s85, 2048
v_mfma_f32_16x16x32_bf16 v[108:111], a[164:167], v[148:151], v[108:111]
ds_read_b128 a[180:183], v18 offset:24576
s_add_u32 s79, s85, 4294965248
v_mfma_f32_16x16x32_bf16 v[72:75], a[156:159], v[152:155], v[72:75]
ds_read_b128 a[184:187], v18 offset:26624
buffer_load_dwordx4 v16, s[92:95], s79 offen offset:2048 lds
v_mfma_f32_16x16x32_bf16 v[92:95], a[160:163], v[152:155], v[92:95]
ds_read_b128 a[188:191], v18 offset:28672
s_add_u32 s79, s85, 107520
v_mfma_f32_16x16x32_bf16 v[112:115], a[164:167], v[152:155], v[112:115]
buffer_load_dwordx4 v16, s[92:95], s79 offen offset:3072 lds
s_waitcnt lgkmcnt(3)
v_mfma_f32_16x16x32_bf16 v[56:59], a[168:171], v[116:119], v[56:59]
ds_read_b64_tr_b16 v[136:137], v22 offset:51200
v_mfma_f32_16x16x32_bf16 v[76:79], a[172:175], v[116:119], v[76:79]
ds_read_b64_tr_b16 v[138:139], v22 offset:52224
v_mfma_f32_16x16x32_bf16 v[96:99], a[176:179], v[116:119], v[96:99]
ds_read_b64_tr_b16 v[140:141], v23 offset:51200
v_mfma_f32_16x16x32_bf16 v[60:63], a[168:171], v[120:123], v[60:63]
ds_read_b64_tr_b16 v[142:143], v23 offset:52224
v_mfma_f32_16x16x32_bf16 v[80:83], a[172:175], v[120:123], v[80:83]
ds_read_b64_tr_b16 v[144:145], v24 offset:51200
v_mfma_f32_16x16x32_bf16 v[100:103], a[176:179], v[120:123], v[100:103]
ds_read_b64_tr_b16 v[146:147], v24 offset:52224
v_mfma_f32_16x16x32_bf16 v[64:67], a[168:171], v[124:127], v[64:67]
ds_read_b64_tr_b16 v[148:149], v25 offset:51200
v_mfma_f32_16x16x32_bf16 v[84:87], a[172:175], v[124:127], v[84:87]
ds_read_b64_tr_b16 v[150:151], v25 offset:52224
v_lshlrev_b32 v36, 4, v0
v_mfma_f32_16x16x32_bf16 v[104:107], a[176:179], v[124:127], v[104:107]
ds_read_b64_tr_b16 v[152:153], v26 offset:51200
v_mfma_f32_16x16x32_bf16 v[68:71], a[168:171], v[128:131], v[68:71]
ds_read_b64_tr_b16 v[154:155], v26 offset:52224
v_mfma_f32_16x16x32_bf16 v[88:91], a[172:175], v[128:131], v[88:91]
v_mfma_f32_16x16x32_bf16 v[108:111], a[176:179], v[128:131], v[108:111]
v_mfma_f32_16x16x32_bf16 v[72:75], a[168:171], v[132:135], v[72:75]
v_mfma_f32_16x16x32_bf16 v[92:95], a[172:175], v[132:135], v[92:95]
v_mfma_f32_16x16x32_bf16 v[112:115], a[176:179], v[132:135], v[112:115]
global_load_dwordx4 v[32:35], v36, s[6:7]
s_waitcnt vmcnt(5)
s_waitcnt lgkmcnt(10)
s_barrier
s_waitcnt lgkmcnt(0)
v_mfma_f32_16x16x32_bf16 v[56:59], a[180:183], v[136:139], v[56:59]
ds_read_b128 a[192:195], v17 offset:49152
s_add_u32 m0, s82, 16384
v_mfma_f32_16x16x32_bf16 v[76:79], a[184:187], v[136:139], v[76:79]
ds_read_b128 a[196:199], v17 offset:51200
s_add_u32 s84, s84, 1
v_mfma_f32_16x16x32_bf16 v[96:99], a[188:191], v[136:139], v[96:99]
ds_read_b128 a[200:203], v17 offset:53248
s_cmp_eq_u32 s84, 9
s_cselect_b32 s84, 0, s84
v_mfma_f32_16x16x32_bf16 v[60:63], a[180:183], v[140:143], v[60:63]
ds_read_b64_tr_b16 v[116:117], v22 offset:0
s_mul_i32 s85, s84, 221184
v_mfma_f32_16x16x32_bf16 v[80:83], a[184:187], v[140:143], v[80:83]
ds_read_b64_tr_b16 v[118:119], v22 offset:1024
s_add_u32 s85, s85, 2048
v_mfma_f32_16x16x32_bf16 v[100:103], a[188:191], v[140:143], v[100:103]
ds_read_b64_tr_b16 v[120:121], v23 offset:0
ds_read_b64_tr_b16 v[122:123], v23 offset:1024
buffer_load_dwordx4 v16, s[92:95], s85 offen offset:0 lds
v_mfma_f32_16x16x32_bf16 v[64:67], a[180:183], v[144:147], v[64:67]
ds_read_b64_tr_b16 v[124:125], v24 offset:0
s_add_u32 s79, s85, 109568
buffer_load_dwordx4 v16, s[92:95], s79 offen offset:1024 lds
v_mfma_f32_16x16x32_bf16 v[84:87], a[184:187], v[144:147], v[84:87]
ds_read_b64_tr_b16 v[126:127], v24 offset:1024
s_add_u32 s84, s84, 1
v_mfma_f32_16x16x32_bf16 v[104:107], a[188:191], v[144:147], v[104:107]
ds_read_b64_tr_b16 v[128:129], v25 offset:0
s_cmp_eq_u32 s84, 9
s_cselect_b32 s84, 0, s84
v_mfma_f32_16x16x32_bf16 v[68:71], a[180:183], v[148:151], v[68:71]
ds_read_b64_tr_b16 v[130:131], v25 offset:1024
v_mfma_f32_16x16x32_bf16 v[88:91], a[184:187], v[148:151], v[88:91]
ds_read_b64_tr_b16 v[132:133], v26 offset:0
ds_read_b64_tr_b16 v[134:135], v26 offset:1024
s_mul_i32 s85, s84, 221184
s_add_u32 s85, s85, 2048
v_mfma_f32_16x16x32_bf16 v[108:111], a[188:191], v[148:151], v[108:111]
ds_read_b128 a[204:207], v18 offset:49152
s_add_u32 s79, s85, 4294965248
v_mfma_f32_16x16x32_bf16 v[72:75], a[180:183], v[152:155], v[72:75]
ds_read_b128 a[208:211], v18 offset:51200
buffer_load_dwordx4 v16, s[92:95], s79 offen offset:2048 lds
v_mfma_f32_16x16x32_bf16 v[92:95], a[184:187], v[152:155], v[92:95]
ds_read_b128 a[212:215], v18 offset:53248
s_add_u32 s79, s85, 107520
buffer_load_dwordx4 v16, s[92:95], s79 offen offset:3072 lds
v_mfma_f32_16x16x32_bf16 v[112:115], a[188:191], v[152:155], v[112:115]
s_waitcnt lgkmcnt(3)
v_mfma_f32_16x16x32_bf16 v[56:59], a[192:195], v[116:119], v[56:59]
ds_read_b64_tr_b16 v[136:137], v22 offset:2048
v_mfma_f32_16x16x32_bf16 v[76:79], a[196:199], v[116:119], v[76:79]
ds_read_b64_tr_b16 v[138:139], v22 offset:3072
v_mfma_f32_16x16x32_bf16 v[96:99], a[200:203], v[116:119], v[96:99]
ds_read_b64_tr_b16 v[140:141], v23 offset:2048
v_mfma_f32_16x16x32_bf16 v[60:63], a[192:195], v[120:123], v[60:63]
ds_read_b64_tr_b16 v[142:143], v23 offset:3072
v_mfma_f32_16x16x32_bf16 v[80:83], a[196:199], v[120:123], v[80:83]
ds_read_b64_tr_b16 v[144:145], v24 offset:2048
v_mfma_f32_16x16x32_bf16 v[100:103], a[200:203], v[120:123], v[100:103]
ds_read_b64_tr_b16 v[146:147], v24 offset:3072
v_mfma_f32_16x16x32_bf16 v[64:67], a[192:195], v[124:127], v[64:67]
ds_read_b64_tr_b16 v[148:149], v25 offset:2048
v_mfma_f32_16x16x32_bf16 v[84:87], a[196:199], v[124:127], v[84:87]
ds_read_b64_tr_b16 v[150:151], v25 offset:3072
v_mfma_f32_16x16x32_bf16 v[104:107], a[200:203], v[124:127], v[104:107]
ds_read_b64_tr_b16 v[152:153], v26 offset:2048
v_mfma_f32_16x16x32_bf16 v[68:71], a[192:195], v[128:131], v[68:71]
ds_read_b64_tr_b16 v[154:155], v26 offset:3072
v_mfma_f32_16x16x32_bf16 v[88:91], a[196:199], v[128:131], v[88:91]
v_mfma_f32_16x16x32_bf16 v[108:111], a[200:203], v[128:131], v[108:111]
v_mfma_f32_16x16x32_bf16 v[72:75], a[192:195], v[132:135], v[72:75]
v_mfma_f32_16x16x32_bf16 v[92:95], a[196:199], v[132:135], v[92:95]
v_mfma_f32_16x16x32_bf16 v[112:115], a[200:203], v[132:135], v[112:115]
s_waitcnt lgkmcnt(10)
s_waitcnt vmcnt(5)
s_barrier
s_waitcnt lgkmcnt(0)
v_mfma_f32_16x16x32_bf16 v[56:59], a[204:207], v[136:139], v[56:59]
ds_read_b64_tr_b16 v[116:117], v27 offset:0
v_mfma_f32_16x16x32_bf16 v[76:79], a[208:211], v[136:139], v[76:79]
ds_read_b64_tr_b16 v[118:119], v27 offset:8192
s_add_u32 m0, s82, 32768
v_mfma_f32_16x16x32_bf16 v[96:99], a[212:215], v[136:139], v[96:99]
ds_read_b64_tr_b16 v[120:121], v28 offset:0
s_add_u32 s84, s84, 1
v_mfma_f32_16x16x32_bf16 v[60:63], a[204:207], v[140:143], v[60:63]
ds_read_b64_tr_b16 v[122:123], v28 offset:8192
v_mfma_f32_16x16x32_bf16 v[80:83], a[208:211], v[140:143], v[80:83]
ds_read_b64_tr_b16 v[124:125], v29 offset:0
s_cmp_eq_u32 s84, 9
s_cselect_b32 s84, 0, s84
v_mfma_f32_16x16x32_bf16 v[100:103], a[212:215], v[140:143], v[100:103]
ds_read_b64_tr_b16 v[126:127], v29 offset:8192
v_mfma_f32_16x16x32_bf16 v[64:67], a[204:207], v[144:147], v[64:67]
s_mul_i32 s85, s84, 221184
v_mfma_f32_16x16x32_bf16 v[84:87], a[208:211], v[144:147], v[84:87]
v_mfma_f32_16x16x32_bf16 v[104:107], a[212:215], v[144:147], v[104:107]
s_add_u32 s85, s85, 2048
v_mfma_f32_16x16x32_bf16 v[68:71], a[204:207], v[148:151], v[68:71]
buffer_load_dwordx4 v16, s[92:95], s85 offen offset:0 lds
v_mfma_f32_16x16x32_bf16 v[88:91], a[208:211], v[148:151], v[88:91]
v_mfma_f32_16x16x32_bf16 v[108:111], a[212:215], v[148:151], v[108:111]
s_add_u32 s79, s85, 109568
v_mfma_f32_16x16x32_bf16 v[72:75], a[204:207], v[152:155], v[72:75]
buffer_load_dwordx4 v16, s[92:95], s79 offen offset:1024 lds
v_mfma_f32_16x16x32_bf16 v[92:95], a[208:211], v[152:155], v[92:95]
v_mfma_f32_16x16x32_bf16 v[112:115], a[212:215], v[152:155], v[112:115]
buffer_load_dword v54, v55, s[24:27], 0 offen sc1
v_cvt_pk_bf16_f32 v168, v68, v69
v_cvt_pk_bf16_f32 v169, v70, v71
v_cvt_pk_bf16_f32 v170, v88, v89
v_cvt_pk_bf16_f32 v171, v90, v91
ds_write_b128 v30, v[168:171] offset:3072
s_waitcnt lgkmcnt(1)
v_mfma_f32_16x16x32_bf16 v[186:189], v[116:119], a[0:3], v[240:243]
ds_read_b64_tr_b16 v[128:129], v27 offset:1024
ds_read_b64_tr_b16 v[130:131], v27 offset:9216
ds_read_b64_tr_b16 v[132:133], v28 offset:1024
v_cvt_pk_bf16_f32 v172, v72, v73
v_cvt_pk_bf16_f32 v173, v74, v75
buffer_load_dwordx4 v16, s[92:95], s36 offen offset:2048 lds
v_mfma_f32_16x16x32_bf16 v[198:201], v[116:119], a[4:7], v[240:243]
ds_read_b64_tr_b16 v[134:135], v28 offset:9216
ds_read_b64_tr_b16 v[136:137], v29 offset:1024
ds_read_b64_tr_b16 v[138:139], v29 offset:9216
v_cvt_pk_bf16_f32 v174, v92, v93
v_cvt_pk_bf16_f32 v175, v94, v95
s_add_u32 s79, s36, 109568
buffer_load_dwordx4 v16, s[92:95], s79 offen offset:3072 lds
ds_write_b128 v30, v[172:175] offset:4096
v_pk_mul_f32 v[156:157], v[56:57], s[74:75]
v_pk_mul_f32 v[158:159], v[58:59], s[74:75]
v_mfma_f32_16x16x32_bf16 v[210:213], v[116:119], a[8:11], v[240:243]
v_exp_f32_e64 v156, v156 clamp
v_max_f32 v56, s76, v56
v_exp_f32_e64 v157, v157 clamp
v_max_f32 v57, s76, v57
v_mfma_f32_16x16x32_bf16 v[190:193], v[120:123], a[0:3], v[240:243]
v_exp_f32_e64 v158, v158 clamp
v_max_f32 v58, s76, v58
v_exp_f32_e64 v159, v159 clamp
v_max_f32 v59, s76, v59
v_pk_add_f32 v[156:157], v[156:157], v[56:57]
v_pk_add_f32 v[158:159], v[158:159], v[58:59]
v_mfma_f32_16x16x32_bf16 v[202:205], v[120:123], a[4:7], v[240:243]
v_cvt_pk_bf16_f32 v168, v156, v157
v_cvt_pk_bf16_f32 v169, v158, v159
s_add_u32 m0, s82, 49152
s_add_u32 s79, s37, 2048
buffer_load_dwordx4 v16, s[92:95], s79 offen offset:0 lds
v_pk_mul_f32 v[160:161], v[76:77], s[74:75]
v_pk_mul_f32 v[162:163], v[78:79], s[74:75]
v_mfma_f32_16x16x32_bf16 v[214:217], v[120:123], a[8:11], v[240:243]
v_exp_f32_e64 v160, v160 clamp
v_max_f32 v76, s76, v76
v_exp_f32_e64 v161, v161 clamp
v_max_f32 v77, s76, v77
v_mfma_f32_16x16x32_bf16 v[194:197], v[124:127], a[0:3], v[240:243]
v_exp_f32_e64 v162, v162 clamp
v_max_f32 v78, s76, v78
v_exp_f32_e64 v163, v163 clamp
v_max_f32 v79, s76, v79
v_pk_add_f32 v[160:161], v[160:161], v[76:77]
v_pk_add_f32 v[162:163], v[162:163], v[78:79]
v_mfma_f32_16x16x32_bf16 v[206:209], v[124:127], a[4:7], v[240:243]
v_cvt_pk_bf16_f32 v170, v160, v161
v_cvt_pk_bf16_f32 v171, v162, v163
s_add_u32 s79, s37, 111616
buffer_load_dwordx4 v16, s[92:95], s79 offen offset:1024 lds
ds_write_b128 v30, v[168:171] offset:0
v_pk_mul_f32 v[156:157], v[60:61], s[74:75]
v_pk_mul_f32 v[158:159], v[62:63], s[74:75]
v_mfma_f32_16x16x32_bf16 v[218:221], v[124:127], a[8:11], v[240:243]
v_exp_f32_e64 v156, v156 clamp
v_max_f32 v60, s76, v60
v_exp_f32_e64 v157, v157 clamp
v_max_f32 v61, s76, v61
s_waitcnt lgkmcnt(2)
v_mfma_f32_16x16x32_bf16 v[186:189], v[128:131], a[12:15], v[186:189]
ds_read_b64_tr_b16 v[140:141], v27 offset:2048
ds_read_b64_tr_b16 v[142:143], v27 offset:10240
ds_read_b64_tr_b16 v[144:145], v28 offset:2048
v_exp_f32_e64 v158, v158 clamp
v_max_f32 v62, s76, v62
v_exp_f32_e64 v159, v159 clamp
v_max_f32 v63, s76, v63
v_pk_add_f32 v[156:157], v[156:157], v[60:61]
v_pk_add_f32 v[158:159], v[158:159], v[62:63]
v_mfma_f32_16x16x32_bf16 v[198:201], v[128:131], a[16:19], v[198:201]
ds_read_b64_tr_b16 v[146:147], v28 offset:10240
ds_read_b64_tr_b16 v[148:149], v29 offset:2048
ds_read_b64_tr_b16 v[150:151], v29 offset:10240
v_cvt_pk_bf16_f32 v172, v156, v157
v_cvt_pk_bf16_f32 v173, v158, v159
buffer_load_dwordx4 v16, s[92:95], s38 offen offset:2048 lds
v_pk_mul_f32 v[160:161], v[80:81], s[74:75]
v_pk_mul_f32 v[162:163], v[82:83], s[74:75]
v_mfma_f32_16x16x32_bf16 v[210:213], v[128:131], a[20:23], v[210:213]
v_exp_f32_e64 v160, v160 clamp
v_max_f32 v80, s76, v80
v_exp_f32_e64 v161, v161 clamp
v_max_f32 v81, s76, v81
v_mfma_f32_16x16x32_bf16 v[190:193], v[132:135], a[12:15], v[190:193]
v_exp_f32_e64 v162, v162 clamp
v_max_f32 v82, s76, v82
v_exp_f32_e64 v163, v163 clamp
v_max_f32 v83, s76, v83
v_pk_add_f32 v[160:161], v[160:161], v[80:81]
v_pk_add_f32 v[162:163], v[162:163], v[82:83]
v_mfma_f32_16x16x32_bf16 v[202:205], v[132:135], a[16:19], v[202:205]
v_cvt_pk_bf16_f32 v174, v160, v161
v_cvt_pk_bf16_f32 v175, v162, v163
s_add_u32 s79, s38, 109568
buffer_load_dwordx4 v16, s[92:95], s79 offen offset:3072 lds
ds_write_b128 v30, v[172:175] offset:1024
v_pk_mul_f32 v[156:157], v[64:65], s[74:75]
v_pk_mul_f32 v[158:159], v[66:67], s[74:75]
v_mfma_f32_16x16x32_bf16 v[214:217], v[132:135], a[20:23], v[214:217]
v_exp_f32_e64 v156, v156 clamp
v_max_f32 v64, v249, v64
v_exp_f32_e64 v157, v157 clamp
v_max_f32 v65, v249, v65
v_mfma_f32_16x16x32_bf16 v[194:197], v[136:139], a[12:15], v[194:197]
v_exp_f32_e64 v158, v158 clamp
v_max_f32 v66, v249, v66
v_exp_f32_e64 v159, v159 clamp
v_max_f32 v67, v249, v67
v_pk_fma_f32 v[156:157], v[156:157], v[248:249], v[64:65] op_sel_hi:[1,0,1]
v_pk_fma_f32 v[158:159], v[158:159], v[248:249], v[66:67] op_sel_hi:[1,0,1]
v_mfma_f32_16x16x32_bf16 v[206:209], v[136:139], a[16:19], v[206:209]
v_cvt_pk_bf16_f32 v168, v156, v157
v_cvt_pk_bf16_f32 v169, v158, v159
s_lshr_b32 s79, s82, 1
s_add_u32 m0, s79, 65536
s_add_u32 s79, s39, 2048
buffer_load_dwordx4 v16, s[92:95], s79 offen offset:0 lds
v_pk_mul_f32 v[160:161], v[84:85], s[74:75]
v_pk_mul_f32 v[162:163], v[86:87], s[74:75]
v_mfma_f32_16x16x32_bf16 v[218:221], v[136:139], a[20:23], v[218:221]
v_exp_f32_e64 v160, v160 clamp
v_max_f32 v84, v249, v84
v_exp_f32_e64 v161, v161 clamp
v_max_f32 v85, v249, v85
s_waitcnt lgkmcnt(1)
v_mfma_f32_16x16x32_bf16 v[186:189], v[140:143], a[24:27], v[186:189]
ds_read_b64_tr_b16 v[116:117], v27 offset:3072
ds_read_b64_tr_b16 v[118:119], v27 offset:11264
ds_read_b64_tr_b16 v[120:121], v28 offset:3072
v_exp_f32_e64 v162, v162 clamp
v_max_f32 v86, v249, v86
v_exp_f32_e64 v163, v163 clamp
v_max_f32 v87, v249, v87
v_pk_fma_f32 v[160:161], v[160:161], v[248:249], v[84:85] op_sel_hi:[1,0,1]
v_pk_fma_f32 v[162:163], v[162:163], v[248:249], v[86:87] op_sel_hi:[1,0,1]
v_mfma_f32_16x16x32_bf16 v[198:201], v[140:143], a[28:31], v[198:201]
ds_read_b64_tr_b16 v[122:123], v28 offset:11264
ds_read_b64_tr_b16 v[124:125], v29 offset:3072
ds_read_b64_tr_b16 v[126:127], v29 offset:11264
v_cvt_pk_bf16_f32 v170, v160, v161
v_cvt_pk_bf16_f32 v171, v162, v163
s_add_u32 s79, s39, 111616
buffer_load_dwordx4 v16, s[92:95], s79 offen offset:1024 lds
ds_write_b128 v30, v[168:171] offset:2048
v_mfma_f32_16x16x32_bf16 v[210:213], v[140:143], a[32:35], v[210:213]
v_cvt_pk_bf16_f32 v172, v108, v109
v_cvt_pk_bf16_f32 v173, v110, v111
ds_write_b64 v42, v[172:173] offset:3072
v_mfma_f32_16x16x32_bf16 v[190:193], v[144:147], a[24:27], v[190:193]
v_cvt_pk_bf16_f32 v174, v112, v113
v_cvt_pk_bf16_f32 v175, v114, v115
ds_write_b64 v42, v[174:175] offset:4096
v_pk_mul_f32 v[156:157], v[96:97], s[74:75]
v_pk_mul_f32 v[158:159], v[98:99], s[74:75]
v_mfma_f32_16x16x32_bf16 v[202:205], v[144:147], a[28:31], v[202:205]
v_exp_f32_e64 v156, v156 clamp
v_max_f32 v96, s76, v96
v_exp_f32_e64 v157, v157 clamp
v_max_f32 v97, s76, v97
v_mfma_f32_16x16x32_bf16 v[214:217], v[144:147], a[32:35], v[214:217]
v_exp_f32_e64 v158, v158 clamp
v_max_f32 v98, s76, v98
v_exp_f32_e64 v159, v159 clamp
v_max_f32 v99, s76, v99
v_pk_add_f32 v[156:157], v[156:157], v[96:97]
v_pk_add_f32 v[158:159], v[158:159], v[98:99]
v_mfma_f32_16x16x32_bf16 v[194:197], v[148:151], a[24:27], v[194:197]
v_cvt_pk_bf16_f32 v168, v156, v157
v_cvt_pk_bf16_f32 v169, v158, v159
ds_write_b64 v42, v[168:169] offset:0
v_pk_mul_f32 v[160:161], v[100:101], s[74:75]
v_pk_mul_f32 v[162:163], v[102:103], s[74:75]
v_mfma_f32_16x16x32_bf16 v[206:209], v[148:151], a[28:31], v[206:209]
v_exp_f32_e64 v160, v160 clamp
v_max_f32 v100, s76, v100
v_exp_f32_e64 v161, v161 clamp
v_max_f32 v101, s76, v101
v_mfma_f32_16x16x32_bf16 v[218:221], v[148:151], a[32:35], v[218:221]
v_exp_f32_e64 v162, v162 clamp
v_max_f32 v102, s76, v102
v_exp_f32_e64 v163, v163 clamp
v_max_f32 v103, s76, v103
v_pk_add_f32 v[160:161], v[160:161], v[100:101]
v_pk_add_f32 v[162:163], v[162:163], v[102:103]
s_waitcnt lgkmcnt(4)
v_mfma_f32_16x16x32_bf16 v[186:189], v[116:119], a[36:39], v[186:189]
v_cvt_pk_bf16_f32 v170, v160, v161
v_cvt_pk_bf16_f32 v171, v162, v163
ds_write_b64 v42, v[170:171] offset:1024
v_pk_mul_f32 v[156:157], v[104:105], s[74:75]
v_pk_mul_f32 v[158:159], v[106:107], s[74:75]
v_mfma_f32_16x16x32_bf16 v[198:201], v[116:119], a[40:43], v[198:201]
v_exp_f32_e64 v156, v156 clamp
v_max_f32 v104, v249, v104
v_exp_f32_e64 v157, v157 clamp
v_max_f32 v105, v249, v105
v_mfma_f32_16x16x32_bf16 v[210:213], v[116:119], a[44:47], v[210:213]
v_exp_f32_e64 v158, v158 clamp
v_max_f32 v106, v249, v106
v_exp_f32_e64 v159, v159 clamp
v_max_f32 v107, v249, v107
v_pk_fma_f32 v[156:157], v[156:157], v[248:249], v[104:105] op_sel_hi:[1,0,1]
v_pk_fma_f32 v[158:159], v[158:159], v[248:249], v[106:107] op_sel_hi:[1,0,1]
v_mfma_f32_16x16x32_bf16 v[190:193], v[120:123], a[36:39], v[190:193]
v_cvt_pk_bf16_f32 v172, v156, v157
v_cvt_pk_bf16_f32 v173, v158, v159
ds_write_b64 v42, v[172:173] offset:2048
v_mfma_f32_16x16x32_bf16 v[202:205], v[120:123], a[40:43], v[202:205]
v_mfma_f32_16x16x32_bf16 v[214:217], v[120:123], a[44:47], v[214:217]
v_mfma_f32_16x16x32_bf16 v[194:197], v[124:127], a[36:39], v[194:197]
v_mfma_f32_16x16x32_bf16 v[206:209], v[124:127], a[40:43], v[206:209]
v_mfma_f32_16x16x32_bf16 v[218:221], v[124:127], a[44:47], v[218:221]
s_waitcnt vmcnt(11)
s_waitcnt lgkmcnt(0)
s_barrier
ds_read_b64_tr_b16 v[128:129], v27 offset:16384
ds_read_b64_tr_b16 v[130:131], v27 offset:24576
ds_read_b64_tr_b16 v[132:133], v28 offset:16384
ds_read_b64_tr_b16 v[134:135], v28 offset:24576
ds_read_b64_tr_b16 v[136:137], v29 offset:16384
ds_read_b64_tr_b16 v[138:139], v29 offset:24576
ds_read_b128 a[216:219], v44 offset:0
ds_read_b128 a[220:223], v45 offset:0
ds_read_b128 a[224:227], v46 offset:0
ds_read_b128 a[228:231], v47 offset:0
ds_read_b128 a[232:235], v44 offset:5120
ds_read_b128 a[236:239], v45 offset:5120
ds_read_b128 a[240:243], v46 offset:5120
ds_read_b128 a[244:247], v47 offset:5120
s_waitcnt lgkmcnt(8)
ds_read_b128 v[56:59], v44 offset:10240
v_mfma_f32_16x16x32_bf16 v[186:189], v[128:131], a[48:51], v[186:189]
ds_read_b128 v[60:63], v45 offset:10240
ds_read_b128 v[64:67], v46 offset:10240
v_mfma_f32_16x16x32_bf16 v[198:201], v[128:131], a[52:55], v[198:201]
ds_read_b128 v[68:71], v47 offset:10240
v_mfma_f32_16x16x32_bf16 v[210:213], v[128:131], a[56:59], v[210:213]
ds_read_b128 v[72:75], v44 offset:15360
ds_read_b128 v[76:79], v45 offset:15360
v_mfma_f32_16x16x32_bf16 v[190:193], v[132:135], a[48:51], v[190:193]
ds_read_b128 v[80:83], v46 offset:15360
ds_read_b128 v[84:87], v47 offset:15360
v_mfma_f32_16x16x32_bf16 v[202:205], v[132:135], a[52:55], v[202:205]
ds_read_b128 v[88:91], v44 offset:20480
v_mfma_f32_16x16x32_bf16 v[214:217], v[132:135], a[56:59], v[214:217]
ds_read_b128 v[92:95], v45 offset:20480
ds_read_b128 v[96:99], v46 offset:20480
v_mfma_f32_16x16x32_bf16 v[194:197], v[136:139], a[48:51], v[194:197]
ds_read_b128 v[100:103], v47 offset:20480
v_mfma_f32_16x16x32_bf16 v[206:209], v[136:139], a[52:55], v[206:209]
ds_read_b128 v[156:159], v44 offset:25600
ds_read_b128 v[160:163], v45 offset:25600
v_mfma_f32_16x16x32_bf16 v[218:221], v[136:139], a[56:59], v[218:221]
ds_read_b128 v[164:167], v46 offset:25600
ds_read_b128 v[168:171], v47 offset:25600
s_mul_i32 s58, s54, 11
s_add_u32 s58, s58, s53
s_mul_i32 s58, s58, 3072
s_waitcnt lgkmcnt(15)
v_mfma_f32_16x16x32_bf16 v[104:107], a[216:219], a[220:223], 0
ds_read_b64_tr_b16 v[140:141], v27 offset:17408
v_mfma_f32_16x16x32_bf16 v[108:111], a[224:227], a[228:231], 0
ds_read_b64_tr_b16 v[142:143], v27 offset:25600
v_mfma_f32_16x16x32_bf16 v[104:107], a[232:235], a[236:239], v[104:107]
ds_read_b64_tr_b16 v[144:145], v28 offset:17408
v_mfma_f32_16x16x32_bf16 v[108:111], a[240:243], a[244:247], v[108:111]
ds_read_b64_tr_b16 v[146:147], v28 offset:25600
s_waitcnt lgkmcnt(15)
v_mfma_f32_16x16x32_bf16 v[104:107], v[56:59], v[60:63], v[104:107]
ds_read_b64_tr_b16 v[148:149], v29 offset:17408
v_mfma_f32_16x16x32_bf16 v[108:111], v[64:67], v[68:71], v[108:111]
ds_read_b64_tr_b16 v[150:151], v29 offset:25600
s_waitcnt lgkmcnt(15)
v_mfma_f32_16x16x32_bf16 v[104:107], v[72:75], v[76:79], v[104:107]
ds_read_b64_tr_b16 v[116:117], v27 offset:18432
s_waitcnt lgkmcnt(15)
v_mfma_f32_16x16x32_bf16 v[108:111], v[80:83], v[84:87], v[108:111]
ds_read_b64_tr_b16 v[118:119], v27 offset:26624
s_waitcnt lgkmcnt(14)
v_mfma_f32_16x16x32_bf16 v[104:107], v[88:91], v[92:95], v[104:107]
ds_read_b64_tr_b16 v[120:121], v28 offset:18432
s_waitcnt lgkmcnt(13)
v_mfma_f32_16x16x32_bf16 v[108:111], v[96:99], v[100:103], v[108:111]
ds_read_b64_tr_b16 v[122:123], v28 offset:26624
s_waitcnt lgkmcnt(12)
v_mfma_f32_16x16x32_bf16 v[104:107], v[156:159], v[160:163], v[104:107]
ds_read_b64_tr_b16 v[124:125], v29 offset:18432
s_waitcnt lgkmcnt(11)
v_mfma_f32_16x16x32_bf16 v[108:111], v[164:167], v[168:171], v[108:111]
ds_read_b64_tr_b16 v[126:127], v29 offset:26624
s_waitcnt vmcnt(8)
v_cmp_gt_u32 vcc, 8, v54
s_waitcnt lgkmcnt(6)
ds_read_b64_tr_b16 v[128:129], v27 offset:19456
v_mfma_f32_16x16x32_bf16 v[186:189], v[140:143], a[60:63], v[186:189]
ds_read_b64_tr_b16 v[130:131], v27 offset:27648
v_mfma_f32_16x16x32_bf16 v[198:201], v[140:143], a[64:67], v[198:201]
ds_read_b64_tr_b16 v[132:133], v28 offset:19456
v_mfma_f32_16x16x32_bf16 v[210:213], v[140:143], a[68:71], v[210:213]
ds_read_b64_tr_b16 v[134:135], v28 offset:27648
v_mfma_f32_16x16x32_bf16 v[190:193], v[144:147], a[60:63], v[190:193]
ds_read_b64_tr_b16 v[136:137], v29 offset:19456
ds_read_b64_tr_b16 v[138:139], v29 offset:27648
s_cbranch_vccnz L_B_INIT
L_B_INIT_OK:
buffer_store_dwordx4 v[104:107], v32, s[20:23], s58 offen sc1
v_mfma_f32_16x16x32_bf16 v[202:205], v[144:147], a[64:67], v[202:205]
v_mfma_f32_16x16x32_bf16 v[214:217], v[144:147], a[68:71], v[214:217]
buffer_store_dwordx4 v[108:111], v33, s[20:23], s58 offen sc1
v_mfma_f32_16x16x32_bf16 v[194:197], v[148:151], a[60:63], v[194:197]
v_mfma_f32_16x16x32_bf16 v[206:209], v[148:151], a[64:67], v[206:209]
v_mfma_f32_16x16x32_bf16 v[218:221], v[148:151], a[68:71], v[218:221]
s_waitcnt vmcnt(2)
s_barrier
s_waitcnt lgkmcnt(6)
v_mfma_f32_16x16x32_bf16 v[186:189], v[116:119], a[72:75], v[186:189]
v_mfma_f32_16x16x32_bf16 v[198:201], v[116:119], a[76:79], v[198:201]
ds_read_b64_tr_b16 v[140:141], v27 offset:32768
s_add_u32 m0, s82, 73728
v_mfma_f32_16x16x32_bf16 v[210:213], v[116:119], a[80:83], v[210:213]
ds_read_b64_tr_b16 v[142:143], v27 offset:40960
v_mfma_f32_16x16x32_bf16 v[190:193], v[120:123], a[72:75], v[190:193]
buffer_load_dwordx4 v48, s[16:19], s86 offen offset:0 lds
ds_read_b64_tr_b16 v[144:145], v28 offset:32768
v_mfma_f32_16x16x32_bf16 v[202:205], v[120:123], a[76:79], v[202:205]
v_mfma_f32_16x16x32_bf16 v[214:217], v[120:123], a[80:83], v[214:217]
v_mfma_f32_16x16x32_bf16 v[194:197], v[124:127], a[72:75], v[194:197]
ds_read_b64_tr_b16 v[146:147], v28 offset:40960
s_add_u32 s79, s86, 81920
v_mfma_f32_16x16x32_bf16 v[206:209], v[124:127], a[76:79], v[206:209]
ds_read_b64_tr_b16 v[148:149], v29 offset:32768
v_mfma_f32_16x16x32_bf16 v[218:221], v[124:127], a[80:83], v[218:221]
buffer_load_dwordx4 v48, s[16:19], s79 offen offset:1024 lds
ds_read_b64_tr_b16 v[150:151], v29 offset:40960
s_waitcnt lgkmcnt(6)
v_mfma_f32_16x16x32_bf16 v[186:189], v[128:131], a[84:87], v[186:189]
v_mfma_f32_16x16x32_bf16 v[198:201], v[128:131], a[88:91], v[198:201]
ds_read_b64_tr_b16 v[116:117], v27 offset:33792
s_add_u32 s79, s86, 163840
v_mfma_f32_16x16x32_bf16 v[210:213], v[128:131], a[92:95], v[210:213]
ds_read_b64_tr_b16 v[118:119], v27 offset:41984
v_mfma_f32_16x16x32_bf16 v[190:193], v[132:135], a[84:87], v[190:193]
buffer_load_dwordx4 v48, s[16:19], s79 offen offset:2048 lds
ds_read_b64_tr_b16 v[120:121], v28 offset:33792
v_mfma_f32_16x16x32_bf16 v[202:205], v[132:135], a[88:91], v[202:205]
v_mfma_f32_16x16x32_bf16 v[214:217], v[132:135], a[92:95], v[214:217]
v_mfma_f32_16x16x32_bf16 v[194:197], v[136:139], a[84:87], v[194:197]
ds_read_b64_tr_b16 v[122:123], v28 offset:41984
s_add_u32 s79, s86, 245760
v_mfma_f32_16x16x32_bf16 v[206:209], v[136:139], a[88:91], v[206:209]
ds_read_b64_tr_b16 v[124:125], v29 offset:33792
v_mfma_f32_16x16x32_bf16 v[218:221], v[136:139], a[92:95], v[218:221]
buffer_load_dwordx4 v48, s[16:19], s79 offen offset:3072 lds
ds_read_b64_tr_b16 v[126:127], v29 offset:41984
s_waitcnt lgkmcnt(6)
v_mfma_f32_16x16x32_bf16 v[186:189], v[140:143], a[96:99], v[186:189]
v_mfma_f32_16x16x32_bf16 v[198:201], v[140:143], a[100:103], v[198:201]
ds_read_b64_tr_b16 v[128:129], v27 offset:34816
s_add_u32 m0, s82, 90112
v_mfma_f32_16x16x32_bf16 v[210:213], v[140:143], a[104:107], v[210:213]
ds_read_b64_tr_b16 v[130:131], v27 offset:43008
v_mfma_f32_16x16x32_bf16 v[190:193], v[144:147], a[96:99], v[190:193]
buffer_load_dwordx4 v48, s[16:19], s87 offen offset:0 lds
ds_read_b64_tr_b16 v[132:133], v28 offset:34816
v_mfma_f32_16x16x32_bf16 v[202:205], v[144:147], a[100:103], v[202:205]
v_mfma_f32_16x16x32_bf16 v[214:217], v[144:147], a[104:107], v[214:217]
v_mfma_f32_16x16x32_bf16 v[194:197], v[148:151], a[96:99], v[194:197]
ds_read_b64_tr_b16 v[134:135], v28 offset:43008
s_add_u32 s79, s87, 81920
v_mfma_f32_16x16x32_bf16 v[206:209], v[148:151], a[100:103], v[206:209]
ds_read_b64_tr_b16 v[136:137], v29 offset:34816
v_mfma_f32_16x16x32_bf16 v[218:221], v[148:151], a[104:107], v[218:221]
buffer_load_dwordx4 v48, s[16:19], s79 offen offset:1024 lds
ds_read_b64_tr_b16 v[138:139], v29 offset:43008
s_waitcnt lgkmcnt(6)
v_mfma_f32_16x16x32_bf16 v[186:189], v[116:119], a[108:111], v[186:189]
v_mfma_f32_16x16x32_bf16 v[198:201], v[116:119], a[112:115], v[198:201]
ds_read_b64_tr_b16 v[140:141], v27 offset:35840
s_add_u32 s79, s87, 163840
v_mfma_f32_16x16x32_bf16 v[210:213], v[116:119], a[116:119], v[210:213]
ds_read_b64_tr_b16 v[142:143], v27 offset:44032
v_mfma_f32_16x16x32_bf16 v[190:193], v[120:123], a[108:111], v[190:193]
buffer_load_dwordx4 v48, s[16:19], s79 offen offset:2048 lds
ds_read_b64_tr_b16 v[144:145], v28 offset:35840
v_mfma_f32_16x16x32_bf16 v[202:205], v[120:123], a[112:115], v[202:205]
v_mfma_f32_16x16x32_bf16 v[214:217], v[120:123], a[116:119], v[214:217]
v_mfma_f32_16x16x32_bf16 v[194:197], v[124:127], a[108:111], v[194:197]
ds_read_b64_tr_b16 v[146:147], v28 offset:44032
s_add_u32 s79, s87, 245760
v_mfma_f32_16x16x32_bf16 v[206:209], v[124:127], a[112:115], v[206:209]
ds_read_b64_tr_b16 v[148:149], v29 offset:35840
v_mfma_f32_16x16x32_bf16 v[218:221], v[124:127], a[116:119], v[218:221]
buffer_load_dwordx4 v48, s[16:19], s79 offen offset:3072 lds
ds_read_b64_tr_b16 v[150:151], v29 offset:44032
s_waitcnt lgkmcnt(6)
v_mfma_f32_16x16x32_bf16 v[186:189], v[128:131], a[120:123], v[186:189]
v_mfma_f32_16x16x32_bf16 v[198:201], v[128:131], a[124:127], v[198:201]
ds_read_b64_tr_b16 v[116:117], v27 offset:49152
s_add_u32 m0, s82, 106496
v_mfma_f32_16x16x32_bf16 v[210:213], v[128:131], a[128:131], v[210:213]
ds_read_b64_tr_b16 v[118:119], v27 offset:57344
v_mfma_f32_16x16x32_bf16 v[190:193], v[132:135], a[120:123], v[190:193]
buffer_load_dwordx4 v48, s[16:19], s88 offen offset:0 lds
ds_read_b64_tr_b16 v[120:121], v28 offset:49152
v_mfma_f32_16x16x32_bf16 v[202:205], v[132:135], a[124:127], v[202:205]
v_mfma_f32_16x16x32_bf16 v[214:217], v[132:135], a[128:131], v[214:217]
v_mfma_f32_16x16x32_bf16 v[194:197], v[136:139], a[120:123], v[194:197]
ds_read_b64_tr_b16 v[122:123], v28 offset:57344
s_add_u32 s79, s88, 81920
v_mfma_f32_16x16x32_bf16 v[206:209], v[136:139], a[124:127], v[206:209]
ds_read_b64_tr_b16 v[124:125], v29 offset:49152
v_mfma_f32_16x16x32_bf16 v[218:221], v[136:139], a[128:131], v[218:221]
buffer_load_dwordx4 v48, s[16:19], s79 offen offset:1024 lds
ds_read_b64_tr_b16 v[126:127], v29 offset:57344
s_waitcnt lgkmcnt(6)
v_mfma_f32_16x16x32_bf16 v[186:189], v[140:143], a[132:135], v[186:189]
v_mfma_f32_16x16x32_bf16 v[198:201], v[140:143], a[136:139], v[198:201]
ds_read_b64_tr_b16 v[128:129], v27 offset:50176
s_add_u32 s79, s88, 163840
v_mfma_f32_16x16x32_bf16 v[210:213], v[140:143], a[140:143], v[210:213]
ds_read_b64_tr_b16 v[130:131], v27 offset:58368
v_mfma_f32_16x16x32_bf16 v[190:193], v[144:147], a[132:135], v[190:193]
buffer_load_dwordx4 v48, s[16:19], s79 offen offset:2048 lds
ds_read_b64_tr_b16 v[132:133], v28 offset:50176
v_mfma_f32_16x16x32_bf16 v[202:205], v[144:147], a[136:139], v[202:205]
v_mfma_f32_16x16x32_bf16 v[214:217], v[144:147], a[140:143], v[214:217]
v_mfma_f32_16x16x32_bf16 v[194:197], v[148:151], a[132:135], v[194:197]
ds_read_b64_tr_b16 v[134:135], v28 offset:58368
s_add_u32 s79, s88, 245760
v_mfma_f32_16x16x32_bf16 v[206:209], v[148:151], a[136:139], v[206:209]
ds_read_b64_tr_b16 v[136:137], v29 offset:50176
v_mfma_f32_16x16x32_bf16 v[218:221], v[148:151], a[140:143], v[218:221]
buffer_load_dwordx4 v48, s[16:19], s79 offen offset:3072 lds
ds_read_b64_tr_b16 v[138:139], v29 offset:58368
s_waitcnt lgkmcnt(6)
v_mfma_f32_16x16x32_bf16 v[186:189], v[116:119], a[144:147], v[186:189]
v_mfma_f32_16x16x32_bf16 v[198:201], v[116:119], a[148:151], v[198:201]
ds_read_b64_tr_b16 v[140:141], v27 offset:51200
s_add_u32 m0, s82, 122880
v_mfma_f32_16x16x32_bf16 v[210:213], v[116:119], a[152:155], v[210:213]
ds_read_b64_tr_b16 v[142:143], v27 offset:59392
v_mfma_f32_16x16x32_bf16 v[190:193], v[120:123], a[144:147], v[190:193]
buffer_load_dwordx4 v48, s[16:19], s89 offen offset:0 lds
ds_read_b64_tr_b16 v[144:145], v28 offset:51200
v_mfma_f32_16x16x32_bf16 v[202:205], v[120:123], a[148:151], v[202:205]
v_mfma_f32_16x16x32_bf16 v[214:217], v[120:123], a[152:155], v[214:217]
v_mfma_f32_16x16x32_bf16 v[194:197], v[124:127], a[144:147], v[194:197]
ds_read_b64_tr_b16 v[146:147], v28 offset:59392
s_add_u32 s79, s89, 81920
v_mfma_f32_16x16x32_bf16 v[206:209], v[124:127], a[148:151], v[206:209]
ds_read_b64_tr_b16 v[148:149], v29 offset:51200
v_mfma_f32_16x16x32_bf16 v[218:221], v[124:127], a[152:155], v[218:221]
buffer_load_dwordx4 v48, s[16:19], s79 offen offset:1024 lds
ds_read_b64_tr_b16 v[150:151], v29 offset:59392
s_waitcnt lgkmcnt(6)
v_mfma_f32_16x16x32_bf16 v[186:189], v[128:131], a[156:159], v[186:189]
v_mfma_f32_16x16x32_bf16 v[198:201], v[128:131], a[160:163], v[198:201]
ds_read_b64_tr_b16 v[116:117], v27 offset:52224
s_add_u32 s79, s89, 163840
v_mfma_f32_16x16x32_bf16 v[210:213], v[128:131], a[164:167], v[210:213]
ds_read_b64_tr_b16 v[118:119], v27 offset:60416
v_mfma_f32_16x16x32_bf16 v[190:193], v[132:135], a[156:159], v[190:193]
buffer_load_dwordx4 v48, s[16:19], s79 offen offset:2048 lds
ds_read_b64_tr_b16 v[120:121], v28 offset:52224
v_mfma_f32_16x16x32_bf16 v[202:205], v[132:135], a[160:163], v[202:205]
v_mfma_f32_16x16x32_bf16 v[214:217], v[132:135], a[164:167], v[214:217]
v_mfma_f32_16x16x32_bf16 v[194:197], v[136:139], a[156:159], v[194:197]
ds_read_b64_tr_b16 v[122:123], v28 offset:60416
s_add_u32 s79, s89, 245760
v_mfma_f32_16x16x32_bf16 v[206:209], v[136:139], a[160:163], v[206:209]
ds_read_b64_tr_b16 v[124:125], v29 offset:52224
v_mfma_f32_16x16x32_bf16 v[218:221], v[136:139], a[164:167], v[218:221]
buffer_load_dwordx4 v48, s[16:19], s79 offen offset:3072 lds
ds_read_b64_tr_b16 v[126:127], v29 offset:60416
s_waitcnt lgkmcnt(6)
v_mfma_f32_16x16x32_bf16 v[186:189], v[140:143], a[168:171], v[186:189]
v_add_u32 v27, v1, v27
s_lshr_b32 s79, s82, 1
v_mfma_f32_16x16x32_bf16 v[198:201], v[140:143], a[172:175], v[198:201]
v_add_u32 v28, v1, v28
v_mfma_f32_16x16x32_bf16 v[210:213], v[140:143], a[176:179], v[210:213]
s_add_u32 m0, s79, 139264
v_add_u32 v29, v1, v29
v_mfma_f32_16x16x32_bf16 v[190:193], v[144:147], a[168:171], v[190:193]
s_mov_b32 s79, 0
ds_read_b64_tr_b16 v[128:129], v27 offset:0
v_mfma_f32_16x16x32_bf16 v[202:205], v[144:147], a[172:175], v[202:205]
ds_read_b64_tr_b16 v[130:131], v27 offset:4096
v_mfma_f32_16x16x32_bf16 v[214:217], v[144:147], a[176:179], v[214:217]
buffer_load_dwordx4 v49, s[16:19], s79 offen offset:0 lds
ds_read_b64_tr_b16 v[132:133], v28 offset:0
v_mfma_f32_16x16x32_bf16 v[194:197], v[148:151], a[168:171], v[194:197]
v_mfma_f32_16x16x32_bf16 v[206:209], v[148:151], a[172:175], v[206:209]
ds_read_b64_tr_b16 v[134:135], v28 offset:4096
s_mov_b32 s79, 330752
v_mfma_f32_16x16x32_bf16 v[218:221], v[148:151], a[176:179], v[218:221]
ds_read_b64_tr_b16 v[136:137], v29 offset:0
buffer_load_dwordx4 v49, s[16:19], s79 offen offset:1024 lds
ds_read_b64_tr_b16 v[138:139], v29 offset:4096
s_waitcnt lgkmcnt(6)
v_mfma_f32_16x16x32_bf16 v[186:189], v[116:119], a[180:183], v[186:189]
buffer_load_dwordx4 v[56:59], v31, s[20:23], 0 offen sc1
ds_read_b64_tr_b16 v[140:141], v27 offset:1024
v_mfma_f32_16x16x32_bf16 v[198:201], v[116:119], a[184:187], v[198:201]
s_mov_b32 s79, 3072
v_mfma_f32_16x16x32_bf16 v[210:213], v[116:119], a[188:191], v[210:213]
ds_read_b64_tr_b16 v[142:143], v27 offset:5120
v_mfma_f32_16x16x32_bf16 v[190:193], v[120:123], a[180:183], v[190:193]
buffer_load_dwordx4 v[60:63], v31, s[20:23], s79 offen sc1
v_mfma_f32_16x16x32_bf16 v[202:205], v[120:123], a[184:187], v[202:205]
ds_read_b64_tr_b16 v[144:145], v28 offset:1024
s_mov_b32 s79, 6144
v_mfma_f32_16x16x32_bf16 v[214:217], v[120:123], a[188:191], v[214:217]
v_mfma_f32_16x16x32_bf16 v[194:197], v[124:127], a[180:183], v[194:197]
ds_read_b64_tr_b16 v[146:147], v28 offset:5120
buffer_load_dwordx4 v[64:67], v31, s[20:23], s79 offen sc1
v_mfma_f32_16x16x32_bf16 v[206:209], v[124:127], a[184:187], v[206:209]
s_mov_b32 s79, 9216
ds_read_b64_tr_b16 v[148:149], v29 offset:1024
v_mfma_f32_16x16x32_bf16 v[218:221], v[124:127], a[188:191], v[218:221]
buffer_load_dwordx4 v[68:71], v31, s[20:23], s79 offen sc1
ds_read_b64_tr_b16 v[150:151], v29 offset:5120
s_waitcnt lgkmcnt(6)
v_mfma_f32_16x16x32_bf16 v[186:189], v[128:131], a[192:195], v[186:189]
s_mov_b32 s79, 12288
v_mfma_f32_16x16x32_bf16 v[198:201], v[128:131], a[196:199], v[198:201]
buffer_load_dwordx4 v[72:75], v31, s[20:23], s79 offen sc1
v_mfma_f32_16x16x32_bf16 v[210:213], v[128:131], a[200:203], v[210:213]
v_mfma_f32_16x16x32_bf16 v[190:193], v[132:135], a[192:195], v[190:193]
s_mov_b32 s79, 15360
v_mfma_f32_16x16x32_bf16 v[202:205], v[132:135], a[196:199], v[202:205]
buffer_load_dwordx4 v[76:79], v31, s[20:23], s79 offen sc1
v_mfma_f32_16x16x32_bf16 v[214:217], v[132:135], a[200:203], v[214:217]
v_mfma_f32_16x16x32_bf16 v[194:197], v[136:139], a[192:195], v[194:197]
s_mov_b32 s79, 18432
v_mfma_f32_16x16x32_bf16 v[206:209], v[136:139], a[196:199], v[206:209]
buffer_load_dwordx4 v[80:83], v31, s[20:23], s79 offen sc1
v_mfma_f32_16x16x32_bf16 v[218:221], v[136:139], a[200:203], v[218:221]
s_mov_b32 s79, 21504
s_waitcnt lgkmcnt(0)
v_mfma_f32_16x16x32_bf16 v[186:189], v[140:143], a[204:207], v[186:189]
buffer_load_dwordx4 v[84:87], v31, s[20:23], s79 offen sc1
v_mfma_f32_16x16x32_bf16 v[198:201], v[140:143], a[208:211], v[198:201]
s_mov_b32 s79, 24576
v_mfma_f32_16x16x32_bf16 v[210:213], v[140:143], a[212:215], v[210:213]
buffer_load_dwordx4 v[88:91], v31, s[20:23], s79 offen sc1
v_mfma_f32_16x16x32_bf16 v[190:193], v[144:147], a[204:207], v[190:193]
s_mov_b32 s79, 27648
v_mfma_f32_16x16x32_bf16 v[202:205], v[144:147], a[208:211], v[202:205]
v_mfma_f32_16x16x32_bf16 v[214:217], v[144:147], a[212:215], v[214:217]
buffer_load_dwordx4 v[92:95], v31, s[20:23], s79 offen sc1
v_mfma_f32_16x16x32_bf16 v[194:197], v[148:151], a[204:207], v[194:197]
s_mov_b32 s79, 30720
v_mfma_f32_16x16x32_bf16 v[206:209], v[148:151], a[208:211], v[206:209]
buffer_load_dwordx4 v[96:99], v31, s[20:23], s79 offen sc1
v_mfma_f32_16x16x32_bf16 v[218:221], v[148:151], a[212:215], v[218:221]
buffer_load_dword v54, v55, s[24:27], 0 offen offset:128 sc1
v_pk_mul_f32 v[128:129], v[186:187], s[74:75]
v_pk_mul_f32 v[130:131], v[188:189], s[74:75]
v_exp_f32_e64 v128, v128 clamp
v_max_f32 v186, s76, v186
v_exp_f32_e64 v129, v129 clamp
v_max_f32 v187, s76, v187
v_exp_f32_e64 v130, v130 clamp
v_max_f32 v188, s76, v188
v_exp_f32_e64 v131, v131 clamp
v_max_f32_e64 v189, s76, v189
v_pk_add_f32 v[128:129], v[128:129], v[186:187]
v_pk_add_f32 v[130:131], v[130:131], v[188:189]
v_cvt_pk_bf16_f32 v222, v128, v129
v_cvt_pk_bf16_f32 v223, v130, v131
v_pk_mul_f32 v[132:133], v[190:191], s[74:75]
v_pk_mul_f32 v[134:135], v[192:193], s[74:75]
v_exp_f32_e64 v132, v132 clamp
v_max_f32 v190, s76, v190
v_exp_f32_e64 v133, v133 clamp
v_max_f32 v191, s76, v191
v_exp_f32_e64 v134, v134 clamp
v_max_f32 v192, s76, v192
v_exp_f32_e64 v135, v135 clamp
v_max_f32 v193, s76, v193
v_pk_add_f32 v[132:133], v[132:133], v[190:191]
v_pk_add_f32 v[134:135], v[134:135], v[192:193]
v_cvt_pk_bf16_f32 v224, v132, v133
v_cvt_pk_bf16_f32 v225, v134, v135
v_pk_mul_f32 v[128:129], v[194:195], s[74:75]
v_pk_mul_f32 v[130:131], v[196:197], s[74:75]
v_exp_f32_e64 v128, v128 clamp
v_max_f32 v194, s76, v194
v_exp_f32_e64 v129, v129 clamp
v_max_f32 v195, s76, v195
v_exp_f32_e64 v130, v130 clamp
v_max_f32 v196, s76, v196
v_exp_f32_e64 v131, v131 clamp
v_max_f32 v197, s76, v197
v_pk_add_f32 v[128:129], v[128:129], v[194:195]
v_pk_add_f32 v[130:131], v[130:131], v[196:197]
v_cvt_pk_bf16_f32 v226, v128, v129
v_cvt_pk_bf16_f32 v227, v130, v131
v_pk_mul_f32 v[128:129], v[198:199], s[74:75]
v_pk_mul_f32 v[130:131], v[200:201], s[74:75]
v_exp_f32_e64 v128, v128 clamp
v_max_f32 v198, s76, v198
v_exp_f32_e64 v129, v129 clamp
v_max_f32 v199, s76, v199
v_exp_f32_e64 v130, v130 clamp
v_max_f32 v200, s76, v200
v_exp_f32_e64 v131, v131 clamp
v_max_f32 v201, s76, v201
v_pk_add_f32 v[128:129], v[128:129], v[198:199]
v_pk_add_f32 v[130:131], v[130:131], v[200:201]
v_cvt_pk_bf16_f32 v228, v128, v129
v_cvt_pk_bf16_f32 v229, v130, v131
v_pk_mul_f32 v[132:133], v[202:203], s[74:75]
v_pk_mul_f32 v[134:135], v[204:205], s[74:75]
v_exp_f32_e64 v132, v132 clamp
v_max_f32 v202, s76, v202
v_exp_f32_e64 v133, v133 clamp
v_max_f32 v203, s76, v203
v_exp_f32_e64 v134, v134 clamp
v_max_f32 v204, s76, v204
v_exp_f32_e64 v135, v135 clamp
v_max_f32 v205, s76, v205
v_pk_add_f32 v[132:133], v[132:133], v[202:203]
v_pk_add_f32 v[134:135], v[134:135], v[204:205]
v_cvt_pk_bf16_f32 v230, v132, v133
v_cvt_pk_bf16_f32 v231, v134, v135
v_pk_mul_f32 v[128:129], v[206:207], s[74:75]
v_pk_mul_f32 v[130:131], v[208:209], s[74:75]
v_exp_f32_e64 v128, v128 clamp
v_max_f32 v206, s76, v206
v_exp_f32_e64 v129, v129 clamp
v_max_f32 v207, s76, v207
v_exp_f32_e64 v130, v130 clamp
v_max_f32 v208, s76, v208
v_exp_f32_e64 v131, v131 clamp
v_max_f32 v209, s76, v209
v_pk_add_f32 v[128:129], v[128:129], v[206:207]
v_pk_add_f32 v[130:131], v[130:131], v[208:209]
v_cvt_pk_bf16_f32 v232, v128, v129
v_cvt_pk_bf16_f32 v233, v130, v131
v_pk_mul_f32 v[128:129], v[210:211], s[74:75]
v_pk_mul_f32 v[130:131], v[212:213], s[74:75]
v_exp_f32_e64 v128, v128 clamp
v_max_f32 v210, s76, v210
v_exp_f32_e64 v129, v129 clamp
v_max_f32 v211, s76, v211
v_exp_f32_e64 v130, v130 clamp
v_max_f32 v212, s76, v212
v_exp_f32_e64 v131, v131 clamp
v_max_f32 v213, s76, v213
v_pk_add_f32 v[128:129], v[128:129], v[210:211]
v_pk_add_f32 v[130:131], v[130:131], v[212:213]
v_cvt_pk_bf16_f32 v234, v128, v129
v_cvt_pk_bf16_f32 v235, v130, v131
v_pk_mul_f32 v[132:133], v[214:215], s[74:75]
v_pk_mul_f32 v[134:135], v[216:217], s[74:75]
v_exp_f32_e64 v132, v132 clamp
v_max_f32 v214, s76, v214
v_exp_f32_e64 v133, v133 clamp
v_max_f32 v215, s76, v215
v_exp_f32_e64 v134, v134 clamp
v_max_f32 v216, s76, v216
v_exp_f32_e64 v135, v135 clamp
v_max_f32 v217, s76, v217
v_pk_add_f32 v[132:133], v[132:133], v[214:215]
v_pk_add_f32 v[134:135], v[134:135], v[216:217]
v_cvt_pk_bf16_f32 v236, v132, v133
v_cvt_pk_bf16_f32 v237, v134, v135
v_pk_mul_f32 v[128:129], v[218:219], s[74:75]
v_pk_mul_f32 v[130:131], v[220:221], s[74:75]
v_exp_f32_e64 v128, v128 clamp
v_max_f32 v218, s76, v218
v_exp_f32_e64 v129, v129 clamp
v_max_f32 v219, s76, v219
v_exp_f32_e64 v130, v130 clamp
v_max_f32 v220, s76, v220
v_exp_f32_e64 v131, v131 clamp
v_max_f32 v221, s76, v221
v_pk_add_f32 v[128:129], v[128:129], v[218:219]
v_pk_add_f32 v[130:131], v[130:131], v[220:221]
v_cvt_pk_bf16_f32 v238, v128, v129
v_cvt_pk_bf16_f32 v239, v130, v131
s_waitcnt vmcnt(10)
v_pk_add_f32 v[56:57], v[56:57], v[60:61]
v_pk_add_f32 v[58:59], v[58:59], v[62:63]
s_waitcnt vmcnt(8)
v_pk_add_f32 v[64:65], v[64:65], v[68:69]
v_pk_add_f32 v[66:67], v[66:67], v[70:71]
s_waitcnt vmcnt(6)
v_pk_add_f32 v[72:73], v[72:73], v[76:77]
v_pk_add_f32 v[74:75], v[74:75], v[78:79]
s_waitcnt vmcnt(4)
v_pk_add_f32 v[80:81], v[80:81], v[84:85]
v_pk_add_f32 v[82:83], v[82:83], v[86:87]
s_waitcnt vmcnt(2)
s_nop 0
v_pk_add_f32 v[88:89], v[88:89], v[92:93]
v_pk_add_f32 v[90:91], v[90:91], v[94:95]
v_pk_add_f32 v[56:57], v[56:57], v[64:65]
v_pk_add_f32 v[58:59], v[58:59], v[66:67]
v_pk_add_f32 v[72:73], v[72:73], v[80:81]
v_pk_add_f32 v[74:75], v[74:75], v[82:83]
s_waitcnt vmcnt(1)
s_nop 0
v_pk_add_f32 v[88:89], v[88:89], v[96:97]
v_pk_add_f32 v[90:91], v[90:91], v[98:99]
v_pk_add_f32 v[56:57], v[56:57], v[72:73]
v_pk_add_f32 v[58:59], v[58:59], v[74:75]
v_pk_add_f32 v[56:57], v[56:57], v[88:89]
v_pk_add_f32 v[58:59], v[58:59], v[90:91]
v_cmp_u_f32 vcc, v56, v57
v_cmp_u_f32 s[62:63], v58, v59
s_nop 0
s_or_b64 vcc, vcc, s[62:63]
s_cbranch_vccnz L_B_GA
L_B_GA_OK:
v_bfe_i32 v36, v35, 0, 1
v_bfe_i32 v37, v35, 1, 1
v_cvt_pk_bf16_f32 v38, v56, v57
v_cvt_pk_bf16_f32 v39, v58, v59
v_and_b32 v38, v38, v36
v_and_b32 v39, v39, v37
ds_write_b64 v34, v[38:39]
s_waitcnt lgkmcnt(0)
s_barrier
ds_read_b64 v[168:169], v51 offset:0
ds_read_b64 v[170:171], v51 offset:32
ds_read_b64 v[176:177], v51 offset:64
ds_read_b64 v[156:157], v50 offset:0
ds_read_b64 v[158:159], v50 offset:32
ds_read_b64 v[160:161], v50 offset:1536
ds_read_b64 v[162:163], v50 offset:1568
ds_read_b64 v[172:173], v50 offset:1600
ds_read_b64 v[164:165], v50 offset:3072
ds_read_b64 v[166:167], v50 offset:3104
ds_read_b64 v[174:175], v50 offset:3136
s_waitcnt lgkmcnt(9)
v_mfma_f32_16x16x32_bf16 v[68:71], v[168:171], v[222:225], v[240:243]
s_and_b32 s62, s56, 0
s_waitcnt lgkmcnt(6)
v_mfma_f32_16x16x32_bf16 v[56:59], v[156:159], v[222:225], 0
s_xor_b32 s62, s62, 0
s_waitcnt lgkmcnt(4)
v_mfma_f32_16x16x32_bf16 v[60:63], v[160:163], v[222:225], 0
s_lshl_b32 s64, s62, 12
s_add_u32 s86, s64, 16384
s_waitcnt lgkmcnt(1)
v_mfma_f32_16x16x32_bf16 v[64:67], v[164:167], v[222:225], 0
s_and_b32 s62, s56, 0
v_mfma_f32_16x16x16_bf16 v[68:71], v[176:177], v[226:227], v[68:71]
s_xor_b32 s62, s62, 1
s_lshl_b32 s65, s62, 12
v_mfma_f32_16x16x16_bf16 v[60:63], v[172:173], v[226:227], v[60:63]
s_add_u32 s87, s65, 16384
s_waitcnt lgkmcnt(0)
v_mfma_f32_16x16x16_bf16 v[64:67], v[174:175], v[226:227], v[64:67]
s_and_b32 s62, s56, 0
s_xor_b32 s62, s62, 2
v_mfma_f32_16x16x32_bf16 v[84:87], v[168:171], v[228:231], v[240:243]
s_lshl_b32 s66, s62, 12
v_mfma_f32_16x16x32_bf16 v[72:75], v[156:159], v[228:231], 0
s_add_u32 s88, s66, 16384
s_and_b32 s62, s56, 0
v_mfma_f32_16x16x32_bf16 v[76:79], v[160:163], v[228:231], 0
s_xor_b32 s62, s62, 3
v_mfma_f32_16x16x32_bf16 v[80:83], v[164:167], v[228:231], 0
s_lshl_b32 s67, s62, 12
s_add_u32 s89, s67, 16384
s_waitcnt vmcnt(0)
v_cmp_gt_u32 vcc, 80, v54
s_nop 0
s_cbranch_vccnz L_B_INI2
L_B_INI2_OK:
v_rcp_f32 v124, v68
v_rcp_f32 v125, v69
s_mov_b32 s58, 0
v_mfma_f32_16x16x16_bf16 v[84:87], v[176:177], v[232:233], v[84:87]
s_mov_b32 s59, 0
v_cndmask_b32 v126, v125, v124, s[72:73]
v_mfma_f32_16x16x16_bf16 v[76:79], v[172:173], v[232:233], v[76:79]
v_mul_f32 v56, v124, v56
v_mul_f32 v57, v124, v57
v_mul_f32 v58, v124, v58
v_mfma_f32_16x16x16_bf16 v[80:83], v[174:175], v[232:233], v[80:83]
v_mul_f32 v59, v124, v59
v_mul_f32 v60, v126, v60
v_mfma_f32_16x16x32_bf16 v[100:103], v[168:171], v[234:237], v[240:243]
v_mul_f32 v61, v126, v61
v_mul_f32 v62, v125, v62
v_mul_f32 v63, v125, v63
v_mfma_f32_16x16x32_bf16 v[88:91], v[156:159], v[234:237], 0
v_mul_f32 v64, v125, v64
v_mul_f32 v65, v125, v65
v_mfma_f32_16x16x32_bf16 v[92:95], v[160:163], v[234:237], 0
v_mul_f32 v66, v125, v66
v_mul_f32 v67, v125, v67
v_cvt_pk_bf16_f32 v104, v56, v57
v_mfma_f32_16x16x32_bf16 v[96:99], v[164:167], v[234:237], 0
v_cvt_pk_bf16_f32 v105, v58, v59
v_cvt_pk_bf16_f32 v106, v60, v61
v_mfma_f32_16x16x16_bf16 v[100:103], v[176:177], v[238:239], v[100:103]
v_cvt_pk_bf16_f32 v107, v62, v63
v_cvt_pk_bf16_f32 v108, v64, v65
v_cvt_pk_bf16_f32 v109, v66, v67
v_mfma_f32_16x16x16_bf16 v[92:95], v[172:173], v[238:239], v[92:95]
buffer_store_dwordx4 v[104:107], v52, s[20:23], s58 offen sc1
buffer_store_dwordx2 v[108:109], v53, s[20:23], s59 offen sc1
v_mfma_f32_16x16x16_bf16 v[96:99], v[174:175], v[238:239], v[96:99]
v_rcp_f32 v124, v84
v_rcp_f32 v125, v85
s_mov_b32 s58, 65536
s_mov_b32 s59, 8192
v_cndmask_b32 v126, v125, v124, s[72:73]
v_pk_mul_f32 v[72:73], v[72:73], v[124:125] op_sel_hi:[1,0]
v_pk_mul_f32 v[74:75], v[74:75], v[124:125] op_sel_hi:[1,0]
v_pk_mul_f32 v[76:77], v[76:77], v[126:127] op_sel_hi:[1,0]
v_pk_mul_f32 v[78:79], v[78:79], v[124:125] op_sel:[0,1] op_sel_hi:[1,1]
v_pk_mul_f32 v[80:81], v[80:81], v[124:125] op_sel:[0,1] op_sel_hi:[1,1]
v_pk_mul_f32 v[82:83], v[82:83], v[124:125] op_sel:[0,1] op_sel_hi:[1,1]
v_cvt_pk_bf16_f32 v110, v72, v73
v_cvt_pk_bf16_f32 v111, v74, v75
v_cvt_pk_bf16_f32 v112, v76, v77
v_cvt_pk_bf16_f32 v113, v78, v79
v_cvt_pk_bf16_f32 v114, v80, v81
v_cvt_pk_bf16_f32 v115, v82, v83
buffer_store_dwordx4 v[110:113], v52, s[20:23], s58 offen sc1
buffer_store_dwordx2 v[114:115], v53, s[20:23], s59 offen sc1
v_rcp_f32 v124, v100
v_rcp_f32 v125, v101
s_cmp_lt_u32 s53, 10
s_cselect_b32 s58, 0, 1073741824
s_add_u32 s59, s58, 16384
s_add_u32 s58, s58, 131072
v_cndmask_b32 v126, v125, v124, s[72:73]
v_pk_mul_f32 v[88:89], v[88:89], v[124:125] op_sel_hi:[1,0]
v_pk_mul_f32 v[90:91], v[90:91], v[124:125] op_sel_hi:[1,0]
v_pk_mul_f32 v[92:93], v[92:93], v[126:127] op_sel_hi:[1,0]
v_pk_mul_f32 v[94:95], v[94:95], v[124:125] op_sel:[0,1] op_sel_hi:[1,1]
v_pk_mul_f32 v[96:97], v[96:97], v[124:125] op_sel:[0,1] op_sel_hi:[1,1]
v_pk_mul_f32 v[98:99], v[98:99], v[124:125] op_sel:[0,1] op_sel_hi:[1,1]
v_cvt_pk_bf16_f32 v116, v88, v89
v_cvt_pk_bf16_f32 v117, v90, v91
v_cvt_pk_bf16_f32 v118, v92, v93
v_cvt_pk_bf16_f32 v119, v94, v95
v_cvt_pk_bf16_f32 v120, v96, v97
v_cvt_pk_bf16_f32 v121, v98, v99
buffer_store_dwordx4 v[116:119], v52, s[20:23], s58 offen sc1
buffer_store_dwordx2 v[120:121], v53, s[20:23], s59 offen sc1
s_cmp_eq_u32 s57, 0
s_cbranch_scc1 L_END
ds_read_b64_tr_b16 a[0:1], v2 offset:0
ds_read_b64_tr_b16 a[2:3], v2 offset:8192
ds_read_b64_tr_b16 a[4:5], v3 offset:0
ds_read_b64_tr_b16 a[6:7], v3 offset:8192
ds_read_b64_tr_b16 a[8:9], v4 offset:0
ds_read_b64_tr_b16 a[10:11], v4 offset:8192
ds_read_b64_tr_b16 a[12:13], v5 offset:0
ds_read_b64_tr_b16 a[14:15], v5 offset:8192
ds_read_b64_tr_b16 a[16:17], v2 offset:1024
ds_read_b64_tr_b16 a[18:19], v2 offset:9216
ds_read_b64_tr_b16 a[20:21], v3 offset:1024
ds_read_b64_tr_b16 a[22:23], v3 offset:9216
ds_read_b64_tr_b16 a[24:25], v4 offset:1024
ds_read_b64_tr_b16 a[26:27], v4 offset:9216
ds_read_b64_tr_b16 a[28:29], v5 offset:1024
ds_read_b64_tr_b16 a[30:31], v5 offset:9216
ds_read_b64_tr_b16 a[32:33], v2 offset:2048
ds_read_b64_tr_b16 a[34:35], v2 offset:10240
ds_read_b64_tr_b16 a[36:37], v3 offset:2048
ds_read_b64_tr_b16 a[38:39], v3 offset:10240
ds_read_b64_tr_b16 a[40:41], v4 offset:2048
ds_read_b64_tr_b16 a[42:43], v4 offset:10240
ds_read_b64_tr_b16 a[44:45], v5 offset:2048
ds_read_b64_tr_b16 a[46:47], v5 offset:10240
ds_read_b64_tr_b16 a[48:49], v2 offset:3072
ds_read_b64_tr_b16 a[50:51], v2 offset:11264
ds_read_b64_tr_b16 a[52:53], v3 offset:3072
ds_read_b64_tr_b16 a[54:55], v3 offset:11264
ds_read_b64_tr_b16 a[56:57], v4 offset:3072
ds_read_b64_tr_b16 a[58:59], v4 offset:11264
ds_read_b64_tr_b16 a[60:61], v5 offset:3072
ds_read_b64_tr_b16 a[62:63], v5 offset:11264
ds_read_b64_tr_b16 a[64:65], v2 offset:16384
ds_read_b64_tr_b16 a[66:67], v2 offset:24576
ds_read_b64_tr_b16 a[68:69], v3 offset:16384
ds_read_b64_tr_b16 a[70:71], v3 offset:24576
ds_read_b64_tr_b16 a[72:73], v4 offset:16384
ds_read_b64_tr_b16 a[74:75], v4 offset:24576
ds_read_b64_tr_b16 a[76:77], v5 offset:16384
ds_read_b64_tr_b16 a[78:79], v5 offset:24576
ds_read_b64_tr_b16 a[80:81], v2 offset:17408
ds_read_b64_tr_b16 a[82:83], v2 offset:25600
ds_read_b64_tr_b16 a[84:85], v3 offset:17408
ds_read_b64_tr_b16 a[86:87], v3 offset:25600
ds_read_b64_tr_b16 a[88:89], v4 offset:17408
ds_read_b64_tr_b16 a[90:91], v4 offset:25600
ds_read_b64_tr_b16 a[92:93], v5 offset:17408
ds_read_b64_tr_b16 a[94:95], v5 offset:25600
ds_read_b64_tr_b16 a[96:97], v2 offset:18432
ds_read_b64_tr_b16 a[98:99], v2 offset:26624
ds_read_b64_tr_b16 a[100:101], v3 offset:18432
ds_read_b64_tr_b16 a[102:103], v3 offset:26624
ds_read_b64_tr_b16 a[104:105], v4 offset:18432
ds_read_b64_tr_b16 a[106:107], v4 offset:26624
ds_read_b64_tr_b16 a[108:109], v5 offset:18432
ds_read_b64_tr_b16 a[110:111], v5 offset:26624
ds_read_b64_tr_b16 a[112:113], v2 offset:19456
ds_read_b64_tr_b16 a[114:115], v2 offset:27648
ds_read_b64_tr_b16 a[116:117], v3 offset:19456
ds_read_b64_tr_b16 a[118:119], v3 offset:27648
ds_read_b64_tr_b16 a[120:121], v4 offset:19456
ds_read_b64_tr_b16 a[122:123], v4 offset:27648
ds_read_b64_tr_b16 a[124:125], v5 offset:19456
ds_read_b64_tr_b16 a[126:127], v5 offset:27648
ds_read_b64_tr_b16 a[128:129], v2 offset:32768
ds_read_b64_tr_b16 a[130:131], v2 offset:40960
ds_read_b64_tr_b16 a[132:133], v3 offset:32768
ds_read_b64_tr_b16 a[134:135], v3 offset:40960
ds_read_b64_tr_b16 a[136:137], v4 offset:32768
ds_read_b64_tr_b16 a[138:139], v4 offset:40960
ds_read_b64_tr_b16 a[140:141], v5 offset:32768
ds_read_b64_tr_b16 a[142:143], v5 offset:40960
ds_read_b64_tr_b16 a[144:145], v2 offset:33792
ds_read_b64_tr_b16 a[146:147], v2 offset:41984
ds_read_b64_tr_b16 a[148:149], v3 offset:33792
ds_read_b64_tr_b16 a[150:151], v3 offset:41984
ds_read_b64_tr_b16 a[152:153], v4 offset:33792
ds_read_b64_tr_b16 a[154:155], v4 offset:41984
ds_read_b64_tr_b16 a[156:157], v5 offset:33792
ds_read_b64_tr_b16 a[158:159], v5 offset:41984
ds_read_b64_tr_b16 a[160:161], v2 offset:34816
ds_read_b64_tr_b16 a[162:163], v2 offset:43008
ds_read_b64_tr_b16 a[164:165], v3 offset:34816
ds_read_b64_tr_b16 a[166:167], v3 offset:43008
ds_read_b64_tr_b16 a[168:169], v4 offset:34816
ds_read_b64_tr_b16 a[170:171], v4 offset:43008
ds_read_b64_tr_b16 a[172:173], v5 offset:34816
ds_read_b64_tr_b16 a[174:175], v5 offset:43008
ds_read_b64_tr_b16 a[176:177], v2 offset:35840
ds_read_b64_tr_b16 a[178:179], v2 offset:44032
ds_read_b64_tr_b16 a[180:181], v3 offset:35840
ds_read_b64_tr_b16 a[182:183], v3 offset:44032
ds_read_b64_tr_b16 a[184:185], v4 offset:35840
ds_read_b64_tr_b16 a[186:187], v4 offset:44032
ds_read_b64_tr_b16 a[188:189], v5 offset:35840
ds_read_b64_tr_b16 a[190:191], v5 offset:44032
ds_read_b64_tr_b16 a[192:193], v2 offset:49152
v_mov_b32 v12, 0
ds_read_b64_tr_b16 a[194:195], v2 offset:57344
v_mov_b32 v13, 0
ds_read_b64_tr_b16 a[196:197], v3 offset:49152
v_mov_b32 v14, 0
ds_read_b64_tr_b16 a[198:199], v3 offset:57344
v_mov_b32 v15, 0
ds_read_b64_tr_b16 a[200:201], v4 offset:49152
v_mov_b32 v16, 0
ds_read_b64_tr_b16 a[202:203], v4 offset:57344
v_mov_b32 v17, 0
ds_read_b64_tr_b16 a[204:205], v5 offset:49152
v_mov_b32 v18, 0
ds_read_b64_tr_b16 a[206:207], v5 offset:57344
v_mov_b32 v19, 0
ds_read_b64_tr_b16 a[208:209], v2 offset:50176
v_mov_b32 v20, 0
ds_read_b64_tr_b16 a[210:211], v2 offset:58368
v_mov_b32 v21, 0
ds_read_b64_tr_b16 a[212:213], v3 offset:50176
v_mov_b32 v22, 0
ds_read_b64_tr_b16 a[214:215], v3 offset:58368
v_mov_b32 v23, 0
ds_read_b64_tr_b16 a[216:217], v4 offset:50176
v_mov_b32 v24, 0
ds_read_b64_tr_b16 a[218:219], v4 offset:58368
v_mov_b32 v25, 0
ds_read_b64_tr_b16 a[220:221], v5 offset:50176
v_mov_b32 v26, 0
ds_read_b64_tr_b16 a[222:223], v5 offset:58368
v_mov_b32 v27, 0
ds_read_b64_tr_b16 a[224:225], v2 offset:51200
v_mov_b32 v28, 0
ds_read_b64_tr_b16 a[226:227], v2 offset:59392
v_mov_b32 v29, 0
ds_read_b64_tr_b16 a[228:229], v3 offset:51200
v_mov_b32 v30, 0
ds_read_b64_tr_b16 a[230:231], v3 offset:59392
v_mov_b32 v31, 0
ds_read_b64_tr_b16 a[232:233], v4 offset:51200
v_mov_b32 v32, 0
ds_read_b64_tr_b16 a[234:235], v4 offset:59392
v_mov_b32 v33, 0
ds_read_b64_tr_b16 a[236:237], v5 offset:51200
v_mov_b32 v34, 0
ds_read_b64_tr_b16 a[238:239], v5 offset:59392
v_mov_b32 v35, 0
ds_read_b64_tr_b16 a[240:241], v2 offset:52224
v_mov_b32 v36, 0
ds_read_b64_tr_b16 a[242:243], v2 offset:60416
v_mov_b32 v37, 0
ds_read_b64_tr_b16 a[244:245], v3 offset:52224
v_mov_b32 v38, 0
ds_read_b64_tr_b16 a[246:247], v3 offset:60416
v_mov_b32 v39, 0
ds_read_b64_tr_b16 a[248:249], v4 offset:52224
v_mov_b32 v40, 0
ds_read_b64_tr_b16 a[250:251], v4 offset:60416
v_mov_b32 v41, 0
ds_read_b64_tr_b16 a[252:253], v5 offset:52224
v_mov_b32 v42, 0
ds_read_b64_tr_b16 a[254:255], v5 offset:60416
v_mov_b32 v43, 0
v_add_u32 v2, v1, v2
v_add_u32 v3, v1, v3
v_add_u32 v4, v1, v4
v_add_u32 v5, v1, v5
ds_read_b64_tr_b16 v[44:45], v2 offset:0
buffer_load_dwordx4 v[76:79], v6, s[20:23], s64 offen offset:0 sc1
ds_read_b64_tr_b16 v[46:47], v2 offset:4096
buffer_load_dwordx4 v[80:83], v6, s[20:23], s86 offen offset:0 sc1
ds_read_b64_tr_b16 v[48:49], v3 offset:0
buffer_load_dwordx4 v[84:87], v6, s[20:23], s64 offen offset:1024 sc1
ds_read_b64_tr_b16 v[50:51], v3 offset:4096
buffer_load_dwordx4 v[88:91], v6, s[20:23], s86 offen offset:1024 sc1
ds_read_b64_tr_b16 v[52:53], v4 offset:0
buffer_load_dwordx4 v[92:95], v6, s[20:23], s64 offen offset:2048 sc1
ds_read_b64_tr_b16 v[54:55], v4 offset:4096
buffer_load_dwordx4 v[96:99], v6, s[20:23], s86 offen offset:2048 sc1
ds_read_b64_tr_b16 v[56:57], v5 offset:0
buffer_load_dwordx4 v[100:103], v6, s[20:23], s64 offen offset:3072 sc1
ds_read_b64_tr_b16 v[58:59], v5 offset:4096
buffer_load_dwordx4 v[104:107], v6, s[20:23], s86 offen offset:3072 sc1
ds_read_b64_tr_b16 v[60:61], v2 offset:1024
buffer_load_dwordx4 v[108:111], v6, s[20:23], s65 offen offset:0 sc1
ds_read_b64_tr_b16 v[62:63], v2 offset:5120
buffer_load_dwordx4 v[112:115], v6, s[20:23], s87 offen offset:0 sc1
ds_read_b64_tr_b16 v[64:65], v3 offset:1024
buffer_load_dwordx4 v[116:119], v6, s[20:23], s65 offen offset:1024 sc1
ds_read_b64_tr_b16 v[66:67], v3 offset:5120
buffer_load_dwordx4 v[120:123], v6, s[20:23], s87 offen offset:1024 sc1
ds_read_b64_tr_b16 v[68:69], v4 offset:1024
buffer_load_dwordx4 v[124:127], v6, s[20:23], s65 offen offset:2048 sc1
ds_read_b64_tr_b16 v[70:71], v4 offset:5120
buffer_load_dwordx4 v[128:131], v6, s[20:23], s87 offen offset:2048 sc1
ds_read_b64_tr_b16 v[72:73], v5 offset:1024
buffer_load_dwordx4 v[132:135], v6, s[20:23], s65 offen offset:3072 sc1
ds_read_b64_tr_b16 v[74:75], v5 offset:5120
buffer_load_dwordx4 v[136:139], v6, s[20:23], s87 offen offset:3072 sc1
s_mov_b32 s58, 36864
s_waitcnt vmcnt(15)
v_max3_u32 v9, v76, v77, v78
s_waitcnt vmcnt(14)
v_max3_u32 v9, v79, v80, v9
v_max3_u32 v9, v81, v82, v9
s_waitcnt vmcnt(13)
v_max3_u32 v9, v83, v84, v9
v_max3_u32 v9, v85, v86, v9
s_waitcnt vmcnt(12)
v_max3_u32 v9, v87, v88, v9
v_max3_u32 v9, v89, v90, v9
s_waitcnt vmcnt(11)
v_max3_u32 v9, v91, v92, v9
v_max3_u32 v9, v93, v94, v9
s_waitcnt vmcnt(10)
v_max3_u32 v9, v95, v96, v9
v_max3_u32 v9, v97, v98, v9
s_waitcnt vmcnt(9)
v_max3_u32 v9, v99, v100, v9
v_max3_u32 v9, v101, v102, v9
s_waitcnt vmcnt(8)
v_max3_u32 v9, v103, v104, v9
v_max3_u32 v9, v105, v106, v9
v_max_u32 v9, v107, v9
v_cmp_eq_u32 vcc, -1, v9
s_nop 0
s_cbranch_vccnz L_B_R0
L_B_R0_OK:
s_waitcnt lgkmcnt(0)
v_mfma_f32_16x16x32_bf16 v[12:15], a[0:3], v[76:79], v[12:15]
v_mfma_f32_16x16x32_bf16 v[16:19], a[4:7], v[76:79], v[16:19]
v_mfma_f32_16x16x32_bf16 v[20:23], a[8:11], v[76:79], v[20:23]
v_mfma_f32_16x16x32_bf16 v[24:27], a[12:15], v[76:79], v[24:27]
buffer_load_dwordx4 v[140:143], v6, s[20:23], s66 offen offset:0 sc1
v_mfma_f32_16x16x32_bf16 v[28:31], a[0:3], v[80:83], v[28:31]
v_mfma_f32_16x16x32_bf16 v[32:35], a[4:7], v[80:83], v[32:35]
v_mfma_f32_16x16x32_bf16 v[36:39], a[8:11], v[80:83], v[36:39]
buffer_load_dwordx4 v[144:147], v6, s[20:23], s88 offen offset:0 sc1
v_mfma_f32_16x16x32_bf16 v[40:43], a[12:15], v[80:83], v[40:43]
v_mfma_f32_16x16x32_bf16 v[12:15], a[16:19], v[84:87], v[12:15]
v_mfma_f32_16x16x32_bf16 v[16:19], a[20:23], v[84:87], v[16:19]
v_mfma_f32_16x16x32_bf16 v[20:23], a[24:27], v[84:87], v[20:23]
buffer_load_dwordx4 v[148:151], v6, s[20:23], s66 offen offset:1024 sc1
v_mfma_f32_16x16x32_bf16 v[24:27], a[28:31], v[84:87], v[24:27]
v_mfma_f32_16x16x32_bf16 v[28:31], a[16:19], v[88:91], v[28:31]
v_mfma_f32_16x16x32_bf16 v[32:35], a[20:23], v[88:91], v[32:35]
buffer_load_dwordx4 v[152:155], v6, s[20:23], s88 offen offset:1024 sc1
v_mfma_f32_16x16x32_bf16 v[36:39], a[24:27], v[88:91], v[36:39]
s_waitcnt vmcnt(11)
v_max3_u32 v9, v108, v109, v110
v_mfma_f32_16x16x32_bf16 v[40:43], a[28:31], v[88:91], v[40:43]
s_waitcnt vmcnt(10)
v_max3_u32 v9, v111, v112, v9
v_mfma_f32_16x16x32_bf16 v[12:15], a[32:35], v[92:95], v[12:15]
v_max3_u32 v9, v113, v114, v9
buffer_load_dwordx4 v[156:159], v6, s[20:23], s66 offen offset:2048 sc1
v_mfma_f32_16x16x32_bf16 v[16:19], a[36:39], v[92:95], v[16:19]
s_waitcnt vmcnt(10)
v_max3_u32 v9, v115, v116, v9
v_mfma_f32_16x16x32_bf16 v[20:23], a[40:43], v[92:95], v[20:23]
v_max3_u32 v9, v117, v118, v9
v_mfma_f32_16x16x32_bf16 v[24:27], a[44:47], v[92:95], v[24:27]
s_waitcnt vmcnt(9)
v_max3_u32 v9, v119, v120, v9
v_mfma_f32_16x16x32_bf16 v[28:31], a[32:35], v[96:99], v[28:31]
v_max3_u32 v9, v121, v122, v9
buffer_load_dwordx4 v[160:163], v6, s[20:23], s88 offen offset:2048 sc1
v_mfma_f32_16x16x32_bf16 v[32:35], a[36:39], v[96:99], v[32:35]
s_waitcnt vmcnt(9)
v_max3_u32 v9, v123, v124, v9
v_mfma_f32_16x16x32_bf16 v[36:39], a[40:43], v[96:99], v[36:39]
v_max3_u32 v9, v125, v126, v9
v_mfma_f32_16x16x32_bf16 v[40:43], a[44:47], v[96:99], v[40:43]
s_waitcnt vmcnt(8)
v_max3_u32 v9, v127, v128, v9
buffer_load_dwordx4 v[164:167], v6, s[20:23], s66 offen offset:3072 sc1
v_mfma_f32_16x16x32_bf16 v[12:15], a[48:51], v[100:103], v[12:15]
v_max3_u32 v9, v129, v130, v9
v_mfma_f32_16x16x32_bf16 v[16:19], a[52:55], v[100:103], v[16:19]
s_waitcnt vmcnt(8)
v_max3_u32 v9, v131, v132, v9
v_mfma_f32_16x16x32_bf16 v[20:23], a[56:59], v[100:103], v[20:23]
v_max3_u32 v9, v133, v134, v9
buffer_load_dwordx4 v[168:171], v6, s[20:23], s88 offen offset:3072 sc1
v_mfma_f32_16x16x32_bf16 v[24:27], a[60:63], v[100:103], v[24:27]
s_waitcnt vmcnt(8)
v_max3_u32 v9, v135, v136, v9
v_mfma_f32_16x16x32_bf16 v[28:31], a[48:51], v[104:107], v[28:31]
v_max3_u32 v9, v137, v138, v9
v_mfma_f32_16x16x32_bf16 v[32:35], a[52:55], v[104:107], v[32:35]
v_max_u32 v9, v139, v9
v_mfma_f32_16x16x32_bf16 v[36:39], a[56:59], v[104:107], v[36:39]
v_cmp_eq_u32 vcc, -1, v9
v_mfma_f32_16x16x32_bf16 v[40:43], a[60:63], v[104:107], v[40:43]
s_cbranch_vccnz L_B_R1
L_B_R1_OK:
v_mfma_f32_16x16x32_bf16 v[12:15], a[64:67], v[108:111], v[12:15]
v_mfma_f32_16x16x32_bf16 v[16:19], a[68:71], v[108:111], v[16:19]
v_mfma_f32_16x16x32_bf16 v[20:23], a[72:75], v[108:111], v[20:23]
v_mfma_f32_16x16x32_bf16 v[24:27], a[76:79], v[108:111], v[24:27]
buffer_load_dwordx4 v[172:175], v6, s[20:23], s67 offen offset:0 sc1
v_mfma_f32_16x16x32_bf16 v[28:31], a[64:67], v[112:115], v[28:31]
v_mfma_f32_16x16x32_bf16 v[32:35], a[68:71], v[112:115], v[32:35]
v_mfma_f32_16x16x32_bf16 v[36:39], a[72:75], v[112:115], v[36:39]
buffer_load_dwordx4 v[176:179], v6, s[20:23], s89 offen offset:0 sc1
v_mfma_f32_16x16x32_bf16 v[40:43], a[76:79], v[112:115], v[40:43]
v_mfma_f32_16x16x32_bf16 v[12:15], a[80:83], v[116:119], v[12:15]
v_mfma_f32_16x16x32_bf16 v[16:19], a[84:87], v[116:119], v[16:19]
v_mfma_f32_16x16x32_bf16 v[20:23], a[88:91], v[116:119], v[20:23]
buffer_load_dwordx4 v[180:183], v6, s[20:23], s67 offen offset:1024 sc1
v_mfma_f32_16x16x32_bf16 v[24:27], a[92:95], v[116:119], v[24:27]
v_mfma_f32_16x16x32_bf16 v[28:31], a[80:83], v[120:123], v[28:31]
v_mfma_f32_16x16x32_bf16 v[32:35], a[84:87], v[120:123], v[32:35]
buffer_load_dwordx4 v[184:187], v6, s[20:23], s89 offen offset:1024 sc1
v_mfma_f32_16x16x32_bf16 v[36:39], a[88:91], v[120:123], v[36:39]
s_waitcnt vmcnt(11)
v_max3_u32 v9, v140, v141, v142
v_mfma_f32_16x16x32_bf16 v[40:43], a[92:95], v[120:123], v[40:43]
s_waitcnt vmcnt(10)
v_max3_u32 v9, v143, v144, v9
v_mfma_f32_16x16x32_bf16 v[12:15], a[96:99], v[124:127], v[12:15]
v_max3_u32 v9, v145, v146, v9
buffer_load_dwordx4 v[188:191], v6, s[20:23], s67 offen offset:2048 sc1
v_mfma_f32_16x16x32_bf16 v[16:19], a[100:103], v[124:127], v[16:19]
s_waitcnt vmcnt(10)
v_max3_u32 v9, v147, v148, v9
v_mfma_f32_16x16x32_bf16 v[20:23], a[104:107], v[124:127], v[20:23]
v_max3_u32 v9, v149, v150, v9
v_mfma_f32_16x16x32_bf16 v[24:27], a[108:111], v[124:127], v[24:27]
s_waitcnt vmcnt(9)
v_max3_u32 v9, v151, v152, v9
v_mfma_f32_16x16x32_bf16 v[28:31], a[96:99], v[128:131], v[28:31]
v_max3_u32 v9, v153, v154, v9
buffer_load_dwordx4 v[192:195], v6, s[20:23], s89 offen offset:2048 sc1
v_mfma_f32_16x16x32_bf16 v[32:35], a[100:103], v[128:131], v[32:35]
s_waitcnt vmcnt(9)
v_max3_u32 v9, v155, v156, v9
v_mfma_f32_16x16x32_bf16 v[36:39], a[104:107], v[128:131], v[36:39]
v_max3_u32 v9, v157, v158, v9
v_mfma_f32_16x16x32_bf16 v[40:43], a[108:111], v[128:131], v[40:43]
s_waitcnt vmcnt(8)
v_max3_u32 v9, v159, v160, v9
buffer_load_dwordx4 v[196:199], v6, s[20:23], s67 offen offset:3072 sc1
v_mfma_f32_16x16x32_bf16 v[12:15], a[112:115], v[132:135], v[12:15]
v_max3_u32 v9, v161, v162, v9
v_mfma_f32_16x16x32_bf16 v[16:19], a[116:119], v[132:135], v[16:19]
s_waitcnt vmcnt(8)
v_max3_u32 v9, v163, v164, v9
v_mfma_f32_16x16x32_bf16 v[20:23], a[120:123], v[132:135], v[20:23]
v_max3_u32 v9, v165, v166, v9
buffer_load_dwordx4 v[200:203], v6, s[20:23], s89 offen offset:3072 sc1
v_mfma_f32_16x16x32_bf16 v[24:27], a[124:127], v[132:135], v[24:27]
s_waitcnt vmcnt(8)
v_max3_u32 v9, v167, v168, v9
v_mfma_f32_16x16x32_bf16 v[28:31], a[112:115], v[136:139], v[28:31]
v_max3_u32 v9, v169, v170, v9
v_mfma_f32_16x16x32_bf16 v[32:35], a[116:119], v[136:139], v[32:35]
v_max_u32 v9, v171, v9
v_mfma_f32_16x16x32_bf16 v[36:39], a[120:123], v[136:139], v[36:39]
v_cmp_eq_u32 vcc, -1, v9
v_mfma_f32_16x16x32_bf16 v[40:43], a[124:127], v[136:139], v[40:43]
s_cbranch_vccnz L_B_R2
L_B_R2_OK:
v_mfma_f32_16x16x32_bf16 v[12:15], a[128:131], v[140:143], v[12:15]
v_mfma_f32_16x16x32_bf16 v[16:19], a[132:135], v[140:143], v[16:19]
buffer_load_dwordx2 v[204:205], v7, s[20:23], 0 offen offset:0 sc1
v_mfma_f32_16x16x32_bf16 v[20:23], a[136:139], v[140:143], v[20:23]
v_mfma_f32_16x16x32_bf16 v[24:27], a[140:143], v[140:143], v[24:27]
buffer_load_dwordx2 v[206:207], v7, s[20:23], 0 offen offset:128 sc1
v_mfma_f32_16x16x32_bf16 v[28:31], a[128:131], v[144:147], v[28:31]
v_mfma_f32_16x16x32_bf16 v[32:35], a[132:135], v[144:147], v[32:35]
buffer_load_dwordx2 v[208:209], v7, s[20:23], 0 offen offset:2048 sc1
v_mfma_f32_16x16x32_bf16 v[36:39], a[136:139], v[144:147], v[36:39]
v_mfma_f32_16x16x32_bf16 v[40:43], a[140:143], v[144:147], v[40:43]
buffer_load_dwordx2 v[210:211], v7, s[20:23], 0 offen offset:2176 sc1
v_mfma_f32_16x16x32_bf16 v[12:15], a[144:147], v[148:151], v[12:15]
v_mfma_f32_16x16x32_bf16 v[16:19], a[148:151], v[148:151], v[16:19]
buffer_load_dwordx2 v[212:213], v7, s[20:23], 0 offen offset:1024 sc1
v_mfma_f32_16x16x32_bf16 v[20:23], a[152:155], v[148:151], v[20:23]
v_mfma_f32_16x16x32_bf16 v[24:27], a[156:159], v[148:151], v[24:27]
buffer_load_dwordx2 v[214:215], v7, s[20:23], 0 offen offset:1152 sc1
v_mfma_f32_16x16x32_bf16 v[28:31], a[144:147], v[152:155], v[28:31]
v_mfma_f32_16x16x32_bf16 v[32:35], a[148:151], v[152:155], v[32:35]
buffer_load_dwordx2 v[216:217], v7, s[20:23], 0 offen offset:3072 sc1
v_mfma_f32_16x16x32_bf16 v[36:39], a[152:155], v[152:155], v[36:39]
s_waitcnt vmcnt(14)
v_max3_u32 v9, v172, v173, v174
v_mfma_f32_16x16x32_bf16 v[40:43], a[156:159], v[152:155], v[40:43]
s_waitcnt vmcnt(13)
v_max3_u32 v9, v175, v176, v9
buffer_load_dwordx2 v[218:219], v7, s[20:23], 0 offen offset:3200 sc1
v_mfma_f32_16x16x32_bf16 v[12:15], a[160:163], v[156:159], v[12:15]
v_max3_u32 v9, v177, v178, v9
v_mfma_f32_16x16x32_bf16 v[16:19], a[164:167], v[156:159], v[16:19]
s_waitcnt vmcnt(13)
v_max3_u32 v9, v179, v180, v9
v_mfma_f32_16x16x32_bf16 v[20:23], a[168:171], v[156:159], v[20:23]
v_max3_u32 v9, v181, v182, v9
v_mfma_f32_16x16x32_bf16 v[24:27], a[172:175], v[156:159], v[24:27]
s_waitcnt vmcnt(12)
v_max3_u32 v9, v183, v184, v9
v_mfma_f32_16x16x32_bf16 v[28:31], a[160:163], v[160:163], v[28:31]
v_max3_u32 v9, v185, v186, v9
v_mfma_f32_16x16x32_bf16 v[32:35], a[164:167], v[160:163], v[32:35]
s_waitcnt vmcnt(11)
v_max3_u32 v9, v187, v188, v9
v_mfma_f32_16x16x32_bf16 v[36:39], a[168:171], v[160:163], v[36:39]
v_max3_u32 v9, v189, v190, v9
v_mfma_f32_16x16x32_bf16 v[40:43], a[172:175], v[160:163], v[40:43]
s_waitcnt vmcnt(10)
v_max3_u32 v9, v191, v192, v9
v_mfma_f32_16x16x32_bf16 v[12:15], a[176:179], v[164:167], v[12:15]
v_max3_u32 v9, v193, v194, v9
v_mfma_f32_16x16x32_bf16 v[16:19], a[180:183], v[164:167], v[16:19]
s_waitcnt vmcnt(9)
v_max3_u32 v9, v195, v196, v9
v_mfma_f32_16x16x32_bf16 v[20:23], a[184:187], v[164:167], v[20:23]
v_max3_u32 v9, v197, v198, v9
v_mfma_f32_16x16x32_bf16 v[24:27], a[188:191], v[164:167], v[24:27]
s_waitcnt vmcnt(8)
v_max3_u32 v9, v199, v200, v9
v_mfma_f32_16x16x32_bf16 v[28:31], a[176:179], v[168:171], v[28:31]
v_max3_u32 v9, v201, v202, v9
v_mfma_f32_16x16x32_bf16 v[32:35], a[180:183], v[168:171], v[32:35]
v_max_u32 v9, v203, v9
v_mfma_f32_16x16x32_bf16 v[36:39], a[184:187], v[168:171], v[36:39]
v_cmp_eq_u32 vcc, -1, v9
v_mfma_f32_16x16x32_bf16 v[40:43], a[188:191], v[168:171], v[40:43]
s_cbranch_vccnz L_B_R3
L_B_R3_OK:
v_mfma_f32_16x16x32_bf16 v[12:15], a[192:195], v[172:175], v[12:15]
v_mfma_f32_16x16x32_bf16 v[16:19], a[196:199], v[172:175], v[16:19]
v_mfma_f32_16x16x32_bf16 v[20:23], a[200:203], v[172:175], v[20:23]
v_mfma_f32_16x16x32_bf16 v[24:27], a[204:207], v[172:175], v[24:27]
v_mfma_f32_16x16x32_bf16 v[12:15], a[208:211], v[180:183], v[12:15]
v_mfma_f32_16x16x32_bf16 v[16:19], a[212:215], v[180:183], v[16:19]
v_mfma_f32_16x16x32_bf16 v[20:23], a[216:219], v[180:183], v[20:23]
s_waitcnt vmcnt(6)
v_max3_u32 v9, v204, v205, v206
v_mfma_f32_16x16x32_bf16 v[24:27], a[220:223], v[180:183], v[24:27]
s_waitcnt vmcnt(5)
v_max3_u32 v9, v207, v208, v9
v_mfma_f32_16x16x32_bf16 v[12:15], a[224:227], v[188:191], v[12:15]
s_waitcnt vmcnt(4)
v_max3_u32 v9, v209, v210, v9
v_mfma_f32_16x16x32_bf16 v[16:19], a[228:231], v[188:191], v[16:19]
s_waitcnt vmcnt(3)
v_max3_u32 v9, v211, v212, v9
v_mfma_f32_16x16x32_bf16 v[20:23], a[232:235], v[188:191], v[20:23]
s_waitcnt vmcnt(2)
v_max3_u32 v9, v213, v214, v9
v_mfma_f32_16x16x32_bf16 v[24:27], a[236:239], v[188:191], v[24:27]
s_waitcnt vmcnt(1)
v_max3_u32 v9, v215, v216, v9
v_mfma_f32_16x16x32_bf16 v[12:15], a[240:243], v[196:199], v[12:15]
s_waitcnt vmcnt(0)
v_max3_u32 v9, v217, v218, v9
v_mfma_f32_16x16x32_bf16 v[16:19], a[244:247], v[196:199], v[16:19]
v_max_u32 v9, v219, v9
v_mfma_f32_16x16x32_bf16 v[20:23], a[248:251], v[196:199], v[20:23]
v_cmp_eq_u32 vcc, -1, v9
v_mfma_f32_16x16x32_bf16 v[24:27], a[252:255], v[196:199], v[24:27]
s_cbranch_vccnz L_B_R4
L_B_R4_OK:
v_mfma_f32_16x16x32_bf16 v[12:15], v[44:47], v[204:207], v[12:15]
v_mfma_f32_16x16x32_bf16 v[16:19], v[48:51], v[204:207], v[16:19]
v_mfma_f32_16x16x32_bf16 v[20:23], v[52:55], v[204:207], v[20:23]
v_mfma_f32_16x16x32_bf16 v[24:27], v[56:59], v[204:207], v[24:27]
v_mfma_f32_16x16x32_bf16 v[12:15], v[60:63], v[212:215], v[12:15]
v_mfma_f32_16x16x32_bf16 v[16:19], v[64:67], v[212:215], v[16:19]
v_mfma_f32_16x16x32_bf16 v[20:23], v[68:71], v[212:215], v[20:23]
v_mfma_f32_16x16x32_bf16 v[24:27], v[72:75], v[212:215], v[24:27]
v_mfma_f32_16x16x32_bf16 v[28:31], a[192:195], v[176:179], v[28:31]
v_mfma_f32_16x16x32_bf16 v[32:35], a[196:199], v[176:179], v[32:35]
v_mfma_f32_16x16x32_bf16 v[36:39], a[200:203], v[176:179], v[36:39]
s_nop 1
v_cvt_pk_bf16_f32 v76, v12, v13
v_mfma_f32_16x16x32_bf16 v[40:43], a[204:207], v[176:179], v[40:43]
v_cvt_pk_bf16_f32 v77, v14, v15
v_mfma_f32_16x16x32_bf16 v[28:31], a[208:211], v[184:187], v[28:31]
ds_write_b64 v250, v[76:77] offset:0
v_mfma_f32_16x16x32_bf16 v[32:35], a[212:215], v[184:187], v[32:35]
v_cvt_pk_bf16_f32 v78, v16, v17
v_mfma_f32_16x16x32_bf16 v[36:39], a[216:219], v[184:187], v[36:39]
v_cvt_pk_bf16_f32 v79, v18, v19
v_mfma_f32_16x16x32_bf16 v[40:43], a[220:223], v[184:187], v[40:43]
ds_write_b64 v250, v[78:79] offset:32
v_mfma_f32_16x16x32_bf16 v[28:31], a[224:227], v[192:195], v[28:31]
v_cvt_pk_bf16_f32 v80, v20, v21
v_mfma_f32_16x16x32_bf16 v[32:35], a[228:231], v[192:195], v[32:35]
v_cvt_pk_bf16_f32 v81, v22, v23
v_mfma_f32_16x16x32_bf16 v[36:39], a[232:235], v[192:195], v[36:39]
ds_write_b64 v250, v[80:81] offset:64
v_mfma_f32_16x16x32_bf16 v[40:43], a[236:239], v[192:195], v[40:43]
v_cvt_pk_bf16_f32 v82, v24, v25
v_mfma_f32_16x16x32_bf16 v[28:31], a[240:243], v[200:203], v[28:31]
v_cvt_pk_bf16_f32 v83, v26, v27
v_mfma_f32_16x16x32_bf16 v[32:35], a[244:247], v[200:203], v[32:35]
ds_write_b64 v250, v[82:83] offset:96
v_mfma_f32_16x16x32_bf16 v[36:39], a[248:251], v[200:203], v[36:39]
ds_read_b128 v[92:95], v251 offset:0
v_mfma_f32_16x16x32_bf16 v[40:43], a[252:255], v[200:203], v[40:43]
ds_read_b128 v[96:99], v251 offset:1152
v_mfma_f32_16x16x32_bf16 v[28:31], v[44:47], v[208:211], v[28:31]
s_waitcnt lgkmcnt(1)
buffer_store_dwordx4 v[92:95], v8, s[28:31], 0 offen
v_mfma_f32_16x16x32_bf16 v[32:35], v[48:51], v[208:211], v[32:35]
s_mov_b32 s58, 18432
v_mfma_f32_16x16x32_bf16 v[36:39], v[52:55], v[208:211], v[36:39]
s_waitcnt lgkmcnt(0)
buffer_store_dwordx4 v[96:99], v8, s[28:31], s58 offen
v_mfma_f32_16x16x32_bf16 v[40:43], v[56:59], v[208:211], v[40:43]
v_mfma_f32_16x16x32_bf16 v[28:31], v[60:63], v[216:219], v[28:31]
v_mfma_f32_16x16x32_bf16 v[32:35], v[64:67], v[216:219], v[32:35]
v_mfma_f32_16x16x32_bf16 v[36:39], v[68:71], v[216:219], v[36:39]
v_mfma_f32_16x16x32_bf16 v[40:43], v[72:75], v[216:219], v[40:43]
s_nop 4
v_cvt_pk_bf16_f32 v84, v28, v29
v_cvt_pk_bf16_f32 v85, v30, v31
ds_write_b64 v250, v[84:85] offset:2304
v_cvt_pk_bf16_f32 v86, v32, v33
v_cvt_pk_bf16_f32 v87, v34, v35
ds_write_b64 v250, v[86:87] offset:2336
v_cvt_pk_bf16_f32 v88, v36, v37
v_cvt_pk_bf16_f32 v89, v38, v39
ds_write_b64 v250, v[88:89] offset:2368
v_cvt_pk_bf16_f32 v90, v40, v41
v_cvt_pk_bf16_f32 v91, v42, v43
ds_write_b64 v250, v[90:91] offset:2400
ds_read_b128 v[100:103], v251 offset:2304
ds_read_b128 v[104:107], v251 offset:3456
s_mov_b32 s58, 36864
s_waitcnt lgkmcnt(1)
buffer_store_dwordx4 v[100:103], v8, s[28:31], s58 offen
s_mov_b32 s58, 55296
s_waitcnt lgkmcnt(0)
buffer_store_dwordx4 v[104:107], v8, s[28:31], s58 offen
s_endpgm
L_B_INIT:
buffer_load_dword v54, v55, s[24:27], 0 offen sc1
s_add_u32 s78, s78, 1
s_cmp_gt_u32 s78, 0x40000
s_waitcnt vmcnt(0)
s_cbranch_scc1 L_B_INIT_OK
v_cmp_gt_u32 vcc, 8, v54
s_nop 1
s_cbranch_vccnz L_B_INIT
s_branch L_B_INIT_OK
L_B_GA:
buffer_load_dwordx4 v[56:59], v31, s[20:23], 0 offen sc1
s_mov_b32 s79, 3072
buffer_load_dwordx4 v[60:63], v31, s[20:23], s79 offen sc1
s_mov_b32 s79, 6144
buffer_load_dwordx4 v[64:67], v31, s[20:23], s79 offen sc1
s_mov_b32 s79, 9216
buffer_load_dwordx4 v[68:71], v31, s[20:23], s79 offen sc1
s_mov_b32 s79, 12288
buffer_load_dwordx4 v[72:75], v31, s[20:23], s79 offen sc1
s_mov_b32 s79, 15360
buffer_load_dwordx4 v[76:79], v31, s[20:23], s79 offen sc1
s_mov_b32 s79, 18432
buffer_load_dwordx4 v[80:83], v31, s[20:23], s79 offen sc1
s_mov_b32 s79, 21504
buffer_load_dwordx4 v[84:87], v31, s[20:23], s79 offen sc1
s_mov_b32 s79, 24576
buffer_load_dwordx4 v[88:91], v31, s[20:23], s79 offen sc1
s_mov_b32 s79, 27648
buffer_load_dwordx4 v[92:95], v31, s[20:23], s79 offen sc1
s_mov_b32 s79, 30720
buffer_load_dwordx4 v[96:99], v31, s[20:23], s79 offen sc1
s_add_u32 s78, s78, 1
s_cmp_gt_u32 s78, 0x40000
s_waitcnt vmcnt(0)
s_cbranch_scc1 L_B_GA_OK
s_nop 0
v_max3_u32 v9, v56, v57, v58
v_max3_u32 v9, v59, v60, v9
v_max3_u32 v9, v61, v62, v9
v_max3_u32 v9, v63, v64, v9
v_max3_u32 v9, v65, v66, v9
v_max3_u32 v9, v67, v68, v9
v_max3_u32 v9, v69, v70, v9
v_max3_u32 v9, v71, v72, v9
v_max3_u32 v9, v73, v74, v9
v_max3_u32 v9, v75, v76, v9
v_max3_u32 v9, v77, v78, v9
v_max3_u32 v9, v79, v80, v9
v_max3_u32 v9, v81, v82, v9
v_max3_u32 v9, v83, v84, v9
v_max3_u32 v9, v85, v86, v9
v_max3_u32 v9, v87, v88, v9
v_max3_u32 v9, v89, v90, v9
v_max3_u32 v9, v91, v92, v9
v_max3_u32 v9, v93, v94, v9
v_max3_u32 v9, v95, v96, v9
v_max3_u32 v9, v97, v98, v9
v_max_u32 v9, v99, v9
v_cmp_eq_u32 vcc, -1, v9
s_nop 0
s_cbranch_vccnz L_B_GA
v_pk_add_f32 v[56:57], v[56:57], v[60:61]
v_pk_add_f32 v[58:59], v[58:59], v[62:63]
v_pk_add_f32 v[64:65], v[64:65], v[68:69]
v_pk_add_f32 v[66:67], v[66:67], v[70:71]
v_pk_add_f32 v[72:73], v[72:73], v[76:77]
v_pk_add_f32 v[74:75], v[74:75], v[78:79]
v_pk_add_f32 v[80:81], v[80:81], v[84:85]
v_pk_add_f32 v[82:83], v[82:83], v[86:87]
v_pk_add_f32 v[88:89], v[88:89], v[92:93]
v_pk_add_f32 v[90:91], v[90:91], v[94:95]
v_pk_add_f32 v[56:57], v[56:57], v[64:65]
v_pk_add_f32 v[58:59], v[58:59], v[66:67]
v_pk_add_f32 v[72:73], v[72:73], v[80:81]
v_pk_add_f32 v[74:75], v[74:75], v[82:83]
v_pk_add_f32 v[88:89], v[88:89], v[96:97]
v_pk_add_f32 v[90:91], v[90:91], v[98:99]
v_pk_add_f32 v[56:57], v[56:57], v[72:73]
v_pk_add_f32 v[58:59], v[58:59], v[74:75]
v_pk_add_f32 v[56:57], v[56:57], v[88:89]
v_pk_add_f32 v[58:59], v[58:59], v[90:91]
s_branch L_B_GA_OK
L_B_INI2:
buffer_load_dword v54, v55, s[24:27], 0 offen offset:128 sc1
s_add_u32 s78, s78, 1
s_cmp_gt_u32 s78, 0x40000
s_waitcnt vmcnt(0)
s_cbranch_scc1 L_B_INI2_OK
v_cmp_gt_u32 vcc, 80, v54
s_nop 1
s_cbranch_vccnz L_B_INI2
s_branch L_B_INI2_OK
L_B_R0:
s_nop 0
buffer_load_dwordx4 v[76:79], v6, s[20:23], s64 offen offset:0 sc1
buffer_load_dwordx4 v[80:83], v6, s[20:23], s86 offen offset:0 sc1
buffer_load_dwordx4 v[84:87], v6, s[20:23], s64 offen offset:1024 sc1
buffer_load_dwordx4 v[88:91], v6, s[20:23], s86 offen offset:1024 sc1
buffer_load_dwordx4 v[92:95], v6, s[20:23], s64 offen offset:2048 sc1
buffer_load_dwordx4 v[96:99], v6, s[20:23], s86 offen offset:2048 sc1
buffer_load_dwordx4 v[100:103], v6, s[20:23], s64 offen offset:3072 sc1
buffer_load_dwordx4 v[104:107], v6, s[20:23], s86 offen offset:3072 sc1
s_add_u32 s78, s78, 1
s_cmp_gt_u32 s78, 0x40000
s_waitcnt vmcnt(0)
s_cbranch_scc1 L_B_R0_OK
s_nop 0
v_max3_u32 v9, v76, v77, v78
v_max3_u32 v9, v79, v80, v9
v_max3_u32 v9, v81, v82, v9
v_max3_u32 v9, v83, v84, v9
v_max3_u32 v9, v85, v86, v9
v_max3_u32 v9, v87, v88, v9
v_max3_u32 v9, v89, v90, v9
v_max3_u32 v9, v91, v92, v9
v_max3_u32 v9, v93, v94, v9
v_max3_u32 v9, v95, v96, v9
v_max3_u32 v9, v97, v98, v9
v_max3_u32 v9, v99, v100, v9
v_max3_u32 v9, v101, v102, v9
v_max3_u32 v9, v103, v104, v9
v_max3_u32 v9, v105, v106, v9
v_max_u32 v9, v107, v9
v_cmp_eq_u32 vcc, -1, v9
s_nop 0
s_cbranch_vccnz L_B_R0
s_waitcnt vmcnt(0)
s_branch L_B_R0_OK
L_B_R1:
buffer_load_dwordx4 v[108:111], v6, s[20:23], s65 offen offset:0 sc1
buffer_load_dwordx4 v[112:115], v6, s[20:23], s87 offen offset:0 sc1
buffer_load_dwordx4 v[116:119], v6, s[20:23], s65 offen offset:1024 sc1
buffer_load_dwordx4 v[120:123], v6, s[20:23], s87 offen offset:1024 sc1
buffer_load_dwordx4 v[124:127], v6, s[20:23], s65 offen offset:2048 sc1
buffer_load_dwordx4 v[128:131], v6, s[20:23], s87 offen offset:2048 sc1
buffer_load_dwordx4 v[132:135], v6, s[20:23], s65 offen offset:3072 sc1
buffer_load_dwordx4 v[136:139], v6, s[20:23], s87 offen offset:3072 sc1
s_add_u32 s78, s78, 1
s_cmp_gt_u32 s78, 0x40000
s_waitcnt vmcnt(0)
s_cbranch_scc1 L_B_R1_OK
s_nop 0
v_max3_u32 v9, v108, v109, v110
v_max3_u32 v9, v111, v112, v9
v_max3_u32 v9, v113, v114, v9
v_max3_u32 v9, v115, v116, v9
v_max3_u32 v9, v117, v118, v9
v_max3_u32 v9, v119, v120, v9
v_max3_u32 v9, v121, v122, v9
v_max3_u32 v9, v123, v124, v9
v_max3_u32 v9, v125, v126, v9
v_max3_u32 v9, v127, v128, v9
v_max3_u32 v9, v129, v130, v9
v_max3_u32 v9, v131, v132, v9
v_max3_u32 v9, v133, v134, v9
v_max3_u32 v9, v135, v136, v9
v_max3_u32 v9, v137, v138, v9
v_max_u32 v9, v139, v9
v_cmp_eq_u32 vcc, -1, v9
s_nop 0
s_cbranch_vccnz L_B_R1
s_waitcnt vmcnt(0)
s_branch L_B_R1_OK
L_B_R2:
buffer_load_dwordx4 v[140:143], v6, s[20:23], s66 offen offset:0 sc1
buffer_load_dwordx4 v[144:147], v6, s[20:23], s88 offen offset:0 sc1
buffer_load_dwordx4 v[148:151], v6, s[20:23], s66 offen offset:1024 sc1
buffer_load_dwordx4 v[152:155], v6, s[20:23], s88 offen offset:1024 sc1
buffer_load_dwordx4 v[156:159], v6, s[20:23], s66 offen offset:2048 sc1
buffer_load_dwordx4 v[160:163], v6, s[20:23], s88 offen offset:2048 sc1
buffer_load_dwordx4 v[164:167], v6, s[20:23], s66 offen offset:3072 sc1
buffer_load_dwordx4 v[168:171], v6, s[20:23], s88 offen offset:3072 sc1
s_add_u32 s78, s78, 1
s_cmp_gt_u32 s78, 0x40000
s_waitcnt vmcnt(0)
s_cbranch_scc1 L_B_R2_OK
s_nop 0
v_max3_u32 v9, v140, v141, v142
v_max3_u32 v9, v143, v144, v9
v_max3_u32 v9, v145, v146, v9
v_max3_u32 v9, v147, v148, v9
v_max3_u32 v9, v149, v150, v9
v_max3_u32 v9, v151, v152, v9
v_max3_u32 v9, v153, v154, v9
v_max3_u32 v9, v155, v156, v9
v_max3_u32 v9, v157, v158, v9
v_max3_u32 v9, v159, v160, v9
v_max3_u32 v9, v161, v162, v9
v_max3_u32 v9, v163, v164, v9
v_max3_u32 v9, v165, v166, v9
v_max3_u32 v9, v167, v168, v9
v_max3_u32 v9, v169, v170, v9
v_max_u32 v9, v171, v9
v_cmp_eq_u32 vcc, -1, v9
s_nop 0
s_cbranch_vccnz L_B_R2
s_waitcnt vmcnt(0)
s_branch L_B_R2_OK
L_B_R3:
buffer_load_dwordx4 v[172:175], v6, s[20:23], s67 offen offset:0 sc1
buffer_load_dwordx4 v[176:179], v6, s[20:23], s89 offen offset:0 sc1
buffer_load_dwordx4 v[180:183], v6, s[20:23], s67 offen offset:1024 sc1
buffer_load_dwordx4 v[184:187], v6, s[20:23], s89 offen offset:1024 sc1
buffer_load_dwordx4 v[188:191], v6, s[20:23], s67 offen offset:2048 sc1
buffer_load_dwordx4 v[192:195], v6, s[20:23], s89 offen offset:2048 sc1
buffer_load_dwordx4 v[196:199], v6, s[20:23], s67 offen offset:3072 sc1
buffer_load_dwordx4 v[200:203], v6, s[20:23], s89 offen offset:3072 sc1
s_add_u32 s78, s78, 1
s_cmp_gt_u32 s78, 0x40000
s_waitcnt vmcnt(0)
s_cbranch_scc1 L_B_R3_OK
s_nop 0
v_max3_u32 v9, v172, v173, v174
v_max3_u32 v9, v175, v176, v9
v_max3_u32 v9, v177, v178, v9
v_max3_u32 v9, v179, v180, v9
v_max3_u32 v9, v181, v182, v9
v_max3_u32 v9, v183, v184, v9
v_max3_u32 v9, v185, v186, v9
v_max3_u32 v9, v187, v188, v9
v_max3_u32 v9, v189, v190, v9
v_max3_u32 v9, v191, v192, v9
v_max3_u32 v9, v193, v194, v9
v_max3_u32 v9, v195, v196, v9
v_max3_u32 v9, v197, v198, v9
v_max3_u32 v9, v199, v200, v9
v_max3_u32 v9, v201, v202, v9
v_max_u32 v9, v203, v9
v_cmp_eq_u32 vcc, -1, v9
s_nop 0
s_cbranch_vccnz L_B_R3
s_waitcnt vmcnt(0)
s_branch L_B_R3_OK
L_B_R4:
buffer_load_dwordx2 v[204:205], v7, s[20:23], 0 offen offset:0 sc1
buffer_load_dwordx2 v[206:207], v7, s[20:23], 0 offen offset:128 sc1
buffer_load_dwordx2 v[208:209], v7, s[20:23], 0 offen offset:2048 sc1
buffer_load_dwordx2 v[210:211], v7, s[20:23], 0 offen offset:2176 sc1
buffer_load_dwordx2 v[212:213], v7, s[20:23], 0 offen offset:1024 sc1
buffer_load_dwordx2 v[214:215], v7, s[20:23], 0 offen offset:1152 sc1
buffer_load_dwordx2 v[216:217], v7, s[20:23], 0 offen offset:3072 sc1
buffer_load_dwordx2 v[218:219], v7, s[20:23], 0 offen offset:3200 sc1
s_add_u32 s78, s78, 1
s_cmp_gt_u32 s78, 0x40000
s_waitcnt vmcnt(0)
s_cbranch_scc1 L_B_R4_OK
s_nop 0
v_max3_u32 v9, v204, v205, v206
v_max3_u32 v9, v207, v208, v9
v_max3_u32 v9, v209, v210, v9
v_max3_u32 v9, v211, v212, v9
v_max3_u32 v9, v213, v214, v9
v_max3_u32 v9, v215, v216, v9
v_max3_u32 v9, v217, v218, v9
v_max_u32 v9, v219, v9
v_cmp_eq_u32 vcc, -1, v9
s_nop 0
s_cbranch_vccnz L_B_R4
s_waitcnt vmcnt(0)
s_branch L_B_R4_OK
L_A:
s_mov_b32 s71, s33
s_add_u32 s6, s4, L_TABA-L_PC
s_addc_u32 s7, s5, 0
global_load_dwordx4 v[14:17], v27, s[6:7]
global_load_dword v8, v26, s[54:55] offset:256
global_load_dword v9, v26, s[56:57] offset:256
global_load_dword v10, v26, s[58:59] offset:256
global_load_dword v11, v26, s[60:61] offset:256
global_load_dword v12, v26, s[62:63] offset:256
global_load_dword v13, v26, s[64:65] offset:256
global_load_dwordx4 v[18:21], v27, s[6:7] offset:1024
s_add_u32 s6, s6, 2048
s_addc_u32 s7, s7, 0
global_load_dwordx4 a[0:3], v27, s[6:7] offset:0
global_load_dwordx4 a[4:7], v27, s[6:7] offset:1024
global_load_dwordx4 a[8:11], v27, s[6:7] offset:2048
global_load_dwordx4 a[12:15], v27, s[6:7] offset:3072
s_mov_b32 s12, s42
s_mov_b32 s13, s43
s_mov_b32 s14, 1990656
s_mov_b32 s15, 0x20000
s_lshl_b32 s34, s33, 2
s_add_u32 s34, s34, s68
v_mul_u32_u24 v32, 3456, v1
s_and_b32 s35, s34, 1
s_mul_i32 s35, s35, 9
s_add_u32 s35, s35, 9
s_lshr_b32 s80, s34, 1
s_sub_u32 s74, s80, 9
s_mul_i32 s74, s74, 3
s_add_u32 s74, s74, 2
s_and_b32 s75, s3, 4
s_lshl_b32 s75, s75, 1
s_cmp_lt_u32 s34, 18
s_cselect_b32 s80, s80, s74
s_cselect_b32 s75, 4, s75
s_add_u32 s35, s35, s75
s_sub_u32 s74, s34, 24
s_cmp_ge_u32 s34, 24
s_cselect_b32 s80, s74, s80
s_cselect_b32 s35, 4, s35
s_mul_i32 s80, s80, 1728
s_add_u32 s35, s35, s80
s_lshl_b32 s35, s35, 7
buffer_load_dword v252, v32, s[12:15], s35 offen
s_mov_b32 s16, s52
s_mov_b32 s17, s53
s_mov_b32 s18, 2359296
s_mov_b32 s19, 0x20000
s_mov_b32 s20, s46
s_mov_b32 s21, s47
s_mov_b32 s22, 4718592
s_mov_b32 s23, 0x20000
s_mov_b32 s12, s42
s_mov_b32 s13, s43
s_mov_b32 s14, 1990656
s_mov_b32 s15, 0x20000
s_mov_b32 s24, s44
s_mov_b32 s25, s45
s_mov_b32 s26, 663552
s_mov_b32 s27, 0x20000
s_add_u32 s28, s50, 0
s_addc_u32 s29, s51, 0
s_mov_b32 s30, 2899968
s_mov_b32 s31, 0x20000
s_mov_b32 s8, s48
s_mov_b32 s9, s49
s_mov_b32 s10, 256
s_mov_b32 s11, 0x20000
s_movk_i32 s87, 0x1000
s_lshl_b32 s34, s69, 2
s_add_u32 s34, s34, s68
s_mul_i32 s34, s34, 4096
s_add_u32 s34, s34, 1720320
v_add_u32 v224, s34, v27
v_mov_b32 v220, -1
v_mov_b32 v221, -1
v_mov_b32 v222, -1
v_mov_b32 v223, -1
v_mul_u32_u24 v244, 3456, v1
v_lshlrev_b32 v245, 7, v1
v_and_b32 v36, 15, v1
v_lshrrev_b32 v37, 4, v1
s_mul_i32 s74, s68, 16896
s_mov_b32 s78, s74
s_mov_b32 m0, s74
v_and_b32 v32, 31, v1
v_lshrrev_b32_e64 v33, 5, v1
v_mul_u32_u24 v34, 528, v32
v_lshl_add_u32 v34, v33, 4, v34
v_add_u32 v23, s74, v34
v_lshlrev_b32 v34, 4, v32
v_lshl_add_u32 v34, v33, 3, v34
v_sub_u32 v29, 568, v34
v_lshlrev_b32 v34, 1, v1
v_sub_u32 v30, 190, v34
v_and_b32 v34, 1, v32
v_mul_u32_u24 v34, 384, v34
v_and_b32 v35, 30, v32
v_add_u32 v34, v34, v35
v_lshl_add_u32 v34, v33, 6, v34
v_sub_u32 v31, 480, v34
v_and_b32 v32, 1, v36
v_add_u32 v33, v36, v32
v_lshlrev_b32 v34, 3, v37
v_sub_u32 v33, v34, v33
v_lshlrev_b32_e64 v33, 1, v33
v_mul_u32_u24 v34, 1216, v32
v_add3_u32 v112, v33, v34, 32
v_add_u32 v113, 1024, v112
v_mul_u32_u24 v34, 192, v32
v_add_u32 v34, 2976, v34
v_add_u32 v115, v33, v34
v_lshlrev_b32 v33, 3, v37
v_sub_u32 v115, v115, v33
v_lshlrev_b32 v34, 2, v36
v_sub_u32 v34, v33, v34
v_add_u32 v114, 2492, v34
v_lshlrev_b32 v33, 4, v37
v_lshl_add_u32 v34, v36, 5, v33
v_add_u32 v116, 67616, v34
v_lshrrev_b32 v34, 2, v36
v_and_b32 v35, 3, v36
v_lshl_add_u32 v117, v36, 4, v33
v_add_u32 v117, 68048, v117
v_lshl_add_u32 v118, v36, 5, v33
v_add_u32 v118, 68048, v118
v_lshlrev_b32_e64 v32, 3, v37
v_lshl_add_u32 v32, v36, 5, v32
v_add_u32 v119, 104704, v32
v_lshrrev_b32 v32, 2, v1
v_and_b32 v32, 4, v32
v_xor_b32_e64 v32, v32, v1
v_mul_u32_u24 v32, 1152, v32
s_mul_i32 s74, s68, 589824
s_lshl_b32 s75, s69, 4
s_add_u32 s74, s74, s75
v_add_u32 v196, s74, v32
v_lshrrev_b32 v32, 1, v37
v_lshlrev_b32 v32, 5, v32
v_lshl_add_u32 v32, v35, 3, v32
v_add_u32 v32, v32, v34
v_and_b32 v33, 2, v35
v_lshlrev_b32 v33, 1, v33
v_xor_b32 v197, v32, v33
v_xor_b32 v198, 4, v197
s_lshl_b32 s74, s68, 13
s_add_u32 s74, s74, 104704
v_and_b32 v33, 1, v37
v_lshl_add_u32 v32, v33, 3, s74
v_lshl_add_u32 v197, v197, 4, v32
v_lshl_add_u32 v198, v198, 4, v32
v_lshl_add_u32 v33, v33, 2, v35
v_mul_u32_u24 v33, 4640, v33
v_lshrrev_b32 v32, 1, v37
v_lshlrev_b32 v32, 6, v32
v_lshl_add_u32 v32, v34, 4, v32
s_lshl_b32 s74, s68, 10
s_nop 0
s_add_u32 s74, s74, 68096
v_add3_u32 v199, v32, v33, s74
v_mul_u32_u24 v32, 4160, v34
v_lshl_add_u32 v32, v37, 5, v32
v_lshl_add_u32 v32, v35, 3, v32
s_lshl_b32 s74, s68, 7
s_add_u32 s74, s74, 104704
v_add_u32 v200, s74, v32
s_mul_i32 s74, s68, 147456
s_lshl_b32 s75, s69, 4
s_add_u32 s74, s74, s75
v_mul_u32_u24 v32, 2304, v1
v_add_u32 v201, s74, v32
v_mov_b32 v192, 0
v_mov_b32 v193, 0
v_mov_b32 v194, 0
v_mov_b32 v195, 0
v_lshrrev_b32 v32, 5, v1
v_mul_u32_u24 v32, 4640, v32
v_and_b32_e64 v33, 31, v1
v_lshl_add_u32 v32, v33, 4, v32
s_mul_i32 s74, s68, 9280
v_add_u32_e64 v32, s74, v32
v_add_u32 v32, 67584, v32
ds_write_b128 v32, v[192:195]
s_mul_i32 s74, s68, 16896
s_add_u32 s74, s74, 0
s_waitcnt vmcnt(12)
v_add_u32 v24, s74, v14
s_waitcnt lgkmcnt(0)
s_lshl_b32 s79, s68, 13
s_add_u32 s79, s79, 104704
s_and_b32 s84, s71, 7
s_mov_b32 s85, s84
s_lshl_b32 s34, s84, 7
v_add_u32 v199, s34, v199
s_lshl_b32 s74, s72, 16
v_mov_b32 v56, s74
v_mul_f32 v56, 0x3fb8aa3b, v56
v_exp_f32 v56, v56
v_lshlrev_b32 v32, 16, v2
v_lshlrev_b32 v33, 16, v3
v_cvt_pk_bf16_f32 v56, v56, v56
v_lshlrev_b32 v56, 16, v56
v_lshlrev_b32 v52, 16, v4
v_lshlrev_b32 v53, 16, v5
v_lshlrev_b32 v50, 16, v6
v_lshlrev_b32_e64 v51, 16, v7
v_and_b32 v62, 0xffff0000, v2
v_and_b32 v63, 0xffff0000, v3
v_and_b32 v82, 0xffff0000, v4
v_and_b32 v83, 0xffff0000, v5
v_and_b32 v80, 0xffff0000, v6
v_and_b32 v81, 0xffff0000, v7
v_mul_f32 v32, v56, v32
v_mul_f32 v33, v56, v33
v_mul_f32 v32, 0x3fb8aa3b, v32
v_mul_f32 v33, 0x3e22f983, v33
v_mul_f32 v62, v56, v62
v_mul_f32 v63, v56, v63
v_mul_f32 v62, 0x3fb8aa3b, v62
v_mul_f32 v63, 0x3e22f983, v63
v_mul_f32 v48, 0x41000000, v32
v_mul_f32 v42, 0x41000000, v33
v_exp_f32 v48, v48
v_fract_f32 v42, v42
v_mul_f32 v78, 0x41000000, v62
v_mul_f32 v72, 0x41000000, v63
v_exp_f32 v78, v78
v_fract_f32 v72, v72
v_cos_f32 v36, v42
v_sin_f32 v37, v42
v_cos_f32 v66, v72
v_sin_f32 v67, v72
v_mul_f32 v52, v56, v52
v_mul_f32 v53, v56, v53
v_mul_f32 v40, v50, v52
v_mul_f32 v41, v50, v53
v_fma_f32 v40, -v51, v53, v40
v_fma_f32 v41, -v51, v52, -v41
v_mul_f32 v82, v56, v82
v_mul_f32 v83, v56, v83
v_mul_f32 v70, v80, v82
v_mul_f32 v71, v80, v83
v_fma_f32 v70, -v81, v83, v70
v_fma_f32 v71, -v81, v82, -v71
v_mul_f32 v36, v36, v48
v_mul_f32 v37, v37, v48
v_mul_f32 v66, v66, v78
v_mul_f32 v67, v67, v78
v_exp_f32 v48, v32
v_fract_f32 v42, v33
v_exp_f32 v78, v62
v_fract_f32 v72, v63
v_cos_f32 v34, v42
v_sin_f32 v35, v42
v_cos_f32 v64, v72
v_sin_f32 v65, v72
v_mul_f32 v34, v34, v48
v_mul_f32 v35, v35, v48
v_mul_f32 v64, v64, v78
v_mul_f32 v65, v65, v78
v_mul_f32 v48, 0x43800000, v32
v_mul_f32 v42, 0x43800000, v33
v_exp_f32 v48, v48
v_fract_f32 v42, v42
v_mul_f32 v78, 0x43800000, v62
v_mul_f32 v72, 0x43800000, v63
v_exp_f32 v78, v78
v_fract_f32 v72, v72
v_cos_f32 v38, v42
v_sin_f32 v39, v42
v_cos_f32 v68, v72
v_sin_f32 v69, v72
v_mul_f32 v38, v38, v48
v_mul_f32 v39, v39, v48
v_mul_f32 v68, v68, v78
v_mul_f32 v69, v69, v78
v_mov_b32 v92, 0x3f80
ds_write_addtid_b32 v92
ds_write_addtid_b32 v92 offset:256
v_cvt_pk_bf16_f32 v94, v36, v37
v_cvt_pk_bf16_f32 v95, v66, v67
ds_write_addtid_b32 v94 offset:528
ds_write_addtid_b32 v95 offset:784
v_pk_mul_f32 v[42:43], v[36:37], v[36:37] op_sel_hi:[1,0]
v_pk_mul_f32 v[72:73], v[66:67], v[66:67] op_sel_hi:[1,0]
v_pk_fma_f32 v[44:45], v[36:37], v[36:37], v[42:43] op_sel:[1,1,0] op_sel_hi:[0,1,1] neg_lo:[1,0,0]
v_pk_fma_f32 v[74:75], v[66:67], v[66:67], v[72:73] op_sel:[1,1,0] op_sel_hi:[0,1,1] neg_lo:[1,0,0]
v_cvt_pk_bf16_f32 v92, v44, v45
v_cvt_pk_bf16_f32 v93, v74, v75
ds_write_addtid_b32 v92 offset:1056
ds_write_addtid_b32 v93 offset:1312
v_pk_mul_f32 v[42:43], v[44:45], v[36:37] op_sel_hi:[1,0]
v_pk_mul_f32 v[72:73], v[74:75], v[66:67] op_sel_hi:[1,0]
v_pk_fma_f32 v[44:45], v[44:45], v[36:37], v[42:43] op_sel:[1,1,0] op_sel_hi:[0,1,1] neg_lo:[1,0,0]
v_pk_fma_f32 v[74:75], v[74:75], v[66:67], v[72:73] op_sel:[1,1,0] op_sel_hi:[0,1,1] neg_lo:[1,0,0]
v_cvt_pk_bf16_f32 v94, v44, v45
v_cvt_pk_bf16_f32 v95, v74, v75
ds_write_addtid_b32 v94 offset:1584
ds_write_addtid_b32 v95 offset:1840
v_pk_mul_f32 v[42:43], v[44:45], v[36:37] op_sel_hi:[1,0]
v_pk_mul_f32 v[72:73], v[74:75], v[66:67] op_sel_hi:[1,0]
v_pk_fma_f32 v[44:45], v[44:45], v[36:37], v[42:43] op_sel:[1,1,0] op_sel_hi:[0,1,1] neg_lo:[1,0,0]
v_pk_fma_f32 v[74:75], v[74:75], v[66:67], v[72:73] op_sel:[1,1,0] op_sel_hi:[0,1,1] neg_lo:[1,0,0]
v_cvt_pk_bf16_f32 v92, v44, v45
v_cvt_pk_bf16_f32 v93, v74, v75
ds_write_addtid_b32 v92 offset:2112
ds_write_addtid_b32 v93 offset:2368
v_pk_mul_f32 v[42:43], v[44:45], v[36:37] op_sel_hi:[1,0]
v_pk_mul_f32 v[72:73], v[74:75], v[66:67] op_sel_hi:[1,0]
v_pk_fma_f32 v[44:45], v[44:45], v[36:37], v[42:43] op_sel:[1,1,0] op_sel_hi:[0,1,1] neg_lo:[1,0,0]
v_pk_fma_f32 v[74:75], v[74:75], v[66:67], v[72:73] op_sel:[1,1,0] op_sel_hi:[0,1,1] neg_lo:[1,0,0]
v_cvt_pk_bf16_f32 v94, v44, v45
v_cvt_pk_bf16_f32 v95, v74, v75
ds_write_addtid_b32 v94 offset:2640
ds_write_addtid_b32 v95 offset:2896
v_pk_mul_f32 v[42:43], v[44:45], v[36:37] op_sel_hi:[1,0]
v_pk_mul_f32 v[72:73], v[74:75], v[66:67] op_sel_hi:[1,0]
v_pk_fma_f32 v[44:45], v[44:45], v[36:37], v[42:43] op_sel:[1,1,0] op_sel_hi:[0,1,1] neg_lo:[1,0,0]
v_pk_fma_f32 v[74:75], v[74:75], v[66:67], v[72:73] op_sel:[1,1,0] op_sel_hi:[0,1,1] neg_lo:[1,0,0]
v_cvt_pk_bf16_f32 v92, v44, v45
v_cvt_pk_bf16_f32 v93, v74, v75
ds_write_addtid_b32 v92 offset:3168
ds_write_addtid_b32 v93 offset:3424
v_pk_mul_f32 v[42:43], v[44:45], v[36:37] op_sel_hi:[1,0]
v_pk_mul_f32 v[72:73], v[74:75], v[66:67] op_sel_hi:[1,0]
v_pk_fma_f32 v[44:45], v[44:45], v[36:37], v[42:43] op_sel:[1,1,0] op_sel_hi:[0,1,1] neg_lo:[1,0,0]
v_pk_fma_f32 v[74:75], v[74:75], v[66:67], v[72:73] op_sel:[1,1,0] op_sel_hi:[0,1,1] neg_lo:[1,0,0]
v_cvt_pk_bf16_f32 v94, v44, v45
v_cvt_pk_bf16_f32 v95, v74, v75
ds_write_addtid_b32 v94 offset:3696
ds_write_addtid_b32 v95 offset:3952
v_pk_mul_f32 v[42:43], v[44:45], v[36:37] op_sel_hi:[1,0]
v_pk_mul_f32 v[72:73], v[74:75], v[66:67] op_sel_hi:[1,0]
v_pk_fma_f32 v[44:45], v[44:45], v[36:37], v[42:43] op_sel:[1,1,0] op_sel_hi:[0,1,1] neg_lo:[1,0,0]
v_pk_fma_f32 v[74:75], v[74:75], v[66:67], v[72:73] op_sel:[1,1,0] op_sel_hi:[0,1,1] neg_lo:[1,0,0]
v_cvt_pk_bf16_f32 v92, v44, v45
v_cvt_pk_bf16_f32 v93, v74, v75
ds_write_addtid_b32 v92 offset:4224
ds_write_addtid_b32 v93 offset:4480
v_pk_mul_f32 v[42:43], v[44:45], v[36:37] op_sel_hi:[1,0]
v_pk_mul_f32 v[72:73], v[74:75], v[66:67] op_sel_hi:[1,0]
v_pk_fma_f32 v[44:45], v[44:45], v[36:37], v[42:43] op_sel:[1,1,0] op_sel_hi:[0,1,1] neg_lo:[1,0,0]
v_pk_fma_f32 v[74:75], v[74:75], v[66:67], v[72:73] op_sel:[1,1,0] op_sel_hi:[0,1,1] neg_lo:[1,0,0]
v_cvt_pk_bf16_f32 v94, v44, v45
v_cvt_pk_bf16_f32 v95, v74, v75
ds_write_addtid_b32 v94 offset:4752
ds_write_addtid_b32 v95 offset:5008
v_pk_mul_f32 v[42:43], v[44:45], v[36:37] op_sel_hi:[1,0]
v_pk_mul_f32 v[72:73], v[74:75], v[66:67] op_sel_hi:[1,0]
v_pk_fma_f32 v[44:45], v[44:45], v[36:37], v[42:43] op_sel:[1,1,0] op_sel_hi:[0,1,1] neg_lo:[1,0,0]
v_pk_fma_f32 v[74:75], v[74:75], v[66:67], v[72:73] op_sel:[1,1,0] op_sel_hi:[0,1,1] neg_lo:[1,0,0]
v_cvt_pk_bf16_f32 v92, v44, v45
v_cvt_pk_bf16_f32 v93, v74, v75
ds_write_addtid_b32 v92 offset:5280
ds_write_addtid_b32 v93 offset:5536
v_pk_mul_f32 v[42:43], v[44:45], v[36:37] op_sel_hi:[1,0]
v_pk_mul_f32 v[72:73], v[74:75], v[66:67] op_sel_hi:[1,0]
v_pk_fma_f32 v[44:45], v[44:45], v[36:37], v[42:43] op_sel:[1,1,0] op_sel_hi:[0,1,1] neg_lo:[1,0,0]
v_pk_fma_f32 v[74:75], v[74:75], v[66:67], v[72:73] op_sel:[1,1,0] op_sel_hi:[0,1,1] neg_lo:[1,0,0]
v_cvt_pk_bf16_f32 v94, v44, v45
v_cvt_pk_bf16_f32 v95, v74, v75
ds_write_addtid_b32 v94 offset:5808
ds_write_addtid_b32 v95 offset:6064
v_pk_mul_f32 v[42:43], v[44:45], v[36:37] op_sel_hi:[1,0]
v_pk_mul_f32 v[72:73], v[74:75], v[66:67] op_sel_hi:[1,0]
v_pk_fma_f32 v[44:45], v[44:45], v[36:37], v[42:43] op_sel:[1,1,0] op_sel_hi:[0,1,1] neg_lo:[1,0,0]
v_pk_fma_f32 v[74:75], v[74:75], v[66:67], v[72:73] op_sel:[1,1,0] op_sel_hi:[0,1,1] neg_lo:[1,0,0]
v_cvt_pk_bf16_f32 v92, v44, v45
v_cvt_pk_bf16_f32 v93, v74, v75
ds_write_addtid_b32 v92 offset:6336
ds_write_addtid_b32 v93 offset:6592
v_pk_mul_f32 v[42:43], v[44:45], v[36:37] op_sel_hi:[1,0]
v_pk_mul_f32 v[72:73], v[74:75], v[66:67] op_sel_hi:[1,0]
v_pk_fma_f32 v[44:45], v[44:45], v[36:37], v[42:43] op_sel:[1,1,0] op_sel_hi:[0,1,1] neg_lo:[1,0,0]
v_pk_fma_f32 v[74:75], v[74:75], v[66:67], v[72:73] op_sel:[1,1,0] op_sel_hi:[0,1,1] neg_lo:[1,0,0]
v_cvt_pk_bf16_f32 v94, v44, v45
v_cvt_pk_bf16_f32 v95, v74, v75
ds_write_addtid_b32 v94 offset:6864
ds_write_addtid_b32 v95 offset:7120
v_pk_mul_f32 v[42:43], v[44:45], v[36:37] op_sel_hi:[1,0]
v_pk_mul_f32 v[72:73], v[74:75], v[66:67] op_sel_hi:[1,0]
v_pk_fma_f32 v[44:45], v[44:45], v[36:37], v[42:43] op_sel:[1,1,0] op_sel_hi:[0,1,1] neg_lo:[1,0,0]
v_pk_fma_f32 v[74:75], v[74:75], v[66:67], v[72:73] op_sel:[1,1,0] op_sel_hi:[0,1,1] neg_lo:[1,0,0]
v_cvt_pk_bf16_f32 v92, v44, v45
v_cvt_pk_bf16_f32 v93, v74, v75
ds_write_addtid_b32 v92 offset:7392
ds_write_addtid_b32 v93 offset:7648
v_pk_mul_f32 v[42:43], v[44:45], v[36:37] op_sel_hi:[1,0]
v_pk_mul_f32 v[72:73], v[74:75], v[66:67] op_sel_hi:[1,0]
v_pk_fma_f32 v[44:45], v[44:45], v[36:37], v[42:43] op_sel:[1,1,0] op_sel_hi:[0,1,1] neg_lo:[1,0,0]
v_pk_fma_f32 v[74:75], v[74:75], v[66:67], v[72:73] op_sel:[1,1,0] op_sel_hi:[0,1,1] neg_lo:[1,0,0]
v_cvt_pk_bf16_f32 v94, v44, v45
v_cvt_pk_bf16_f32 v95, v74, v75
ds_write_addtid_b32 v94 offset:7920
ds_write_addtid_b32 v95 offset:8176
v_pk_mul_f32 v[42:43], v[44:45], v[36:37] op_sel_hi:[1,0]
v_pk_mul_f32 v[72:73], v[74:75], v[66:67] op_sel_hi:[1,0]
v_pk_fma_f32 v[44:45], v[44:45], v[36:37], v[42:43] op_sel:[1,1,0] op_sel_hi:[0,1,1] neg_lo:[1,0,0]
v_pk_fma_f32 v[74:75], v[74:75], v[66:67], v[72:73] op_sel:[1,1,0] op_sel_hi:[0,1,1] neg_lo:[1,0,0]
v_cvt_pk_bf16_f32 v92, v44, v45
v_cvt_pk_bf16_f32 v93, v74, v75
ds_write_addtid_b32 v92 offset:8448
ds_write_addtid_b32 v93 offset:8704
v_pk_mul_f32 v[42:43], v[44:45], v[36:37] op_sel_hi:[1,0]
v_pk_mul_f32 v[72:73], v[74:75], v[66:67] op_sel_hi:[1,0]
v_pk_fma_f32 v[44:45], v[44:45], v[36:37], v[42:43] op_sel:[1,1,0] op_sel_hi:[0,1,1] neg_lo:[1,0,0]
v_pk_fma_f32 v[74:75], v[74:75], v[66:67], v[72:73] op_sel:[1,1,0] op_sel_hi:[0,1,1] neg_lo:[1,0,0]
v_cvt_pk_bf16_f32 v94, v44, v45
v_cvt_pk_bf16_f32 v95, v74, v75
ds_write_addtid_b32 v94 offset:8976
ds_write_addtid_b32 v95 offset:9232
v_pk_mul_f32 v[42:43], v[44:45], v[36:37] op_sel_hi:[1,0]
v_pk_mul_f32 v[72:73], v[74:75], v[66:67] op_sel_hi:[1,0]
v_pk_fma_f32 v[44:45], v[44:45], v[36:37], v[42:43] op_sel:[1,1,0] op_sel_hi:[0,1,1] neg_lo:[1,0,0]
v_pk_fma_f32 v[74:75], v[74:75], v[66:67], v[72:73] op_sel:[1,1,0] op_sel_hi:[0,1,1] neg_lo:[1,0,0]
v_cvt_pk_bf16_f32 v92, v44, v45
v_cvt_pk_bf16_f32 v93, v74, v75
ds_write_addtid_b32 v92 offset:9504
ds_write_addtid_b32 v93 offset:9760
v_pk_mul_f32 v[42:43], v[44:45], v[36:37] op_sel_hi:[1,0]
v_pk_mul_f32 v[72:73], v[74:75], v[66:67] op_sel_hi:[1,0]
v_pk_fma_f32 v[44:45], v[44:45], v[36:37], v[42:43] op_sel:[1,1,0] op_sel_hi:[0,1,1] neg_lo:[1,0,0]
v_pk_fma_f32 v[74:75], v[74:75], v[66:67], v[72:73] op_sel:[1,1,0] op_sel_hi:[0,1,1] neg_lo:[1,0,0]
v_cvt_pk_bf16_f32 v94, v44, v45
v_cvt_pk_bf16_f32 v95, v74, v75
ds_write_addtid_b32 v94 offset:10032
ds_write_addtid_b32 v95 offset:10288
s_add_u32 m0, s79, 0
s_mul_i32 s34, s84, 73728
buffer_load_dwordx4 v196, s[16:19], s34 offen lds
s_mov_b32 m0, s78
s_add_u32 s84, s84, 1
s_and_b32 s84, s84, 7
v_pk_mul_f32 v[42:43], v[44:45], v[36:37] op_sel_hi:[1,0]
v_pk_mul_f32 v[72:73], v[74:75], v[66:67] op_sel_hi:[1,0]
v_pk_fma_f32 v[44:45], v[44:45], v[36:37], v[42:43] op_sel:[1,1,0] op_sel_hi:[0,1,1] neg_lo:[1,0,0]
v_pk_fma_f32 v[74:75], v[74:75], v[66:67], v[72:73] op_sel:[1,1,0] op_sel_hi:[0,1,1] neg_lo:[1,0,0]
v_cvt_pk_bf16_f32 v92, v44, v45
v_cvt_pk_bf16_f32 v93, v74, v75
ds_write_addtid_b32 v92 offset:10560
ds_write_addtid_b32 v93 offset:10816
v_pk_mul_f32 v[42:43], v[44:45], v[36:37] op_sel_hi:[1,0]
v_pk_mul_f32 v[72:73], v[74:75], v[66:67] op_sel_hi:[1,0]
v_pk_fma_f32 v[44:45], v[44:45], v[36:37], v[42:43] op_sel:[1,1,0] op_sel_hi:[0,1,1] neg_lo:[1,0,0]
v_pk_fma_f32 v[74:75], v[74:75], v[66:67], v[72:73] op_sel:[1,1,0] op_sel_hi:[0,1,1] neg_lo:[1,0,0]
v_cvt_pk_bf16_f32 v94, v44, v45
v_cvt_pk_bf16_f32 v95, v74, v75
ds_write_addtid_b32 v94 offset:11088
ds_write_addtid_b32 v95 offset:11344
v_pk_mul_f32 v[42:43], v[44:45], v[36:37] op_sel_hi:[1,0]
v_pk_mul_f32 v[72:73], v[74:75], v[66:67] op_sel_hi:[1,0]
v_pk_fma_f32 v[44:45], v[44:45], v[36:37], v[42:43] op_sel:[1,1,0] op_sel_hi:[0,1,1] neg_lo:[1,0,0]
v_pk_fma_f32 v[74:75], v[74:75], v[66:67], v[72:73] op_sel:[1,1,0] op_sel_hi:[0,1,1] neg_lo:[1,0,0]
v_cvt_pk_bf16_f32 v92, v44, v45
v_cvt_pk_bf16_f32 v93, v74, v75
ds_write_addtid_b32 v92 offset:11616
ds_write_addtid_b32 v93 offset:11872
v_pk_mul_f32 v[42:43], v[44:45], v[36:37] op_sel_hi:[1,0]
v_pk_mul_f32 v[72:73], v[74:75], v[66:67] op_sel_hi:[1,0]
v_pk_fma_f32 v[44:45], v[44:45], v[36:37], v[42:43] op_sel:[1,1,0] op_sel_hi:[0,1,1] neg_lo:[1,0,0]
v_pk_fma_f32 v[74:75], v[74:75], v[66:67], v[72:73] op_sel:[1,1,0] op_sel_hi:[0,1,1] neg_lo:[1,0,0]
v_cvt_pk_bf16_f32 v94, v44, v45
v_cvt_pk_bf16_f32 v95, v74, v75
ds_write_addtid_b32 v94 offset:12144
ds_write_addtid_b32 v95 offset:12400
v_pk_mul_f32 v[42:43], v[44:45], v[36:37] op_sel_hi:[1,0]
v_pk_mul_f32 v[72:73], v[74:75], v[66:67] op_sel_hi:[1,0]
v_pk_fma_f32 v[44:45], v[44:45], v[36:37], v[42:43] op_sel:[1,1,0] op_sel_hi:[0,1,1] neg_lo:[1,0,0]
v_pk_fma_f32 v[74:75], v[74:75], v[66:67], v[72:73] op_sel:[1,1,0] op_sel_hi:[0,1,1] neg_lo:[1,0,0]
v_cvt_pk_bf16_f32 v92, v44, v45
v_cvt_pk_bf16_f32 v93, v74, v75
ds_write_addtid_b32 v92 offset:12672
ds_write_addtid_b32 v93 offset:12928
v_pk_mul_f32 v[42:43], v[44:45], v[36:37] op_sel_hi:[1,0]
v_pk_mul_f32 v[72:73], v[74:75], v[66:67] op_sel_hi:[1,0]
v_pk_fma_f32 v[44:45], v[44:45], v[36:37], v[42:43] op_sel:[1,1,0] op_sel_hi:[0,1,1] neg_lo:[1,0,0]
v_pk_fma_f32 v[74:75], v[74:75], v[66:67], v[72:73] op_sel:[1,1,0] op_sel_hi:[0,1,1] neg_lo:[1,0,0]
v_cvt_pk_bf16_f32 v94, v44, v45
v_cvt_pk_bf16_f32 v95, v74, v75
ds_write_addtid_b32 v94 offset:13200
ds_write_addtid_b32 v95 offset:13456
v_pk_mul_f32 v[42:43], v[44:45], v[36:37] op_sel_hi:[1,0]
v_pk_mul_f32 v[72:73], v[74:75], v[66:67] op_sel_hi:[1,0]
v_pk_fma_f32 v[44:45], v[44:45], v[36:37], v[42:43] op_sel:[1,1,0] op_sel_hi:[0,1,1] neg_lo:[1,0,0]
v_pk_fma_f32 v[74:75], v[74:75], v[66:67], v[72:73] op_sel:[1,1,0] op_sel_hi:[0,1,1] neg_lo:[1,0,0]
v_cvt_pk_bf16_f32 v92, v44, v45
v_cvt_pk_bf16_f32 v93, v74, v75
ds_write_addtid_b32 v92 offset:13728
ds_write_addtid_b32 v93 offset:13984
v_pk_mul_f32 v[42:43], v[44:45], v[36:37] op_sel_hi:[1,0]
v_pk_mul_f32 v[72:73], v[74:75], v[66:67] op_sel_hi:[1,0]
v_pk_fma_f32 v[44:45], v[44:45], v[36:37], v[42:43] op_sel:[1,1,0] op_sel_hi:[0,1,1] neg_lo:[1,0,0]
v_pk_fma_f32 v[74:75], v[74:75], v[66:67], v[72:73] op_sel:[1,1,0] op_sel_hi:[0,1,1] neg_lo:[1,0,0]
v_cvt_pk_bf16_f32 v94, v44, v45
v_cvt_pk_bf16_f32 v95, v74, v75
ds_write_addtid_b32 v94 offset:14256
ds_write_addtid_b32 v95 offset:14512
v_pk_mul_f32 v[42:43], v[44:45], v[36:37] op_sel_hi:[1,0]
v_pk_mul_f32 v[72:73], v[74:75], v[66:67] op_sel_hi:[1,0]
v_pk_fma_f32 v[44:45], v[44:45], v[36:37], v[42:43] op_sel:[1,1,0] op_sel_hi:[0,1,1] neg_lo:[1,0,0]
v_pk_fma_f32 v[74:75], v[74:75], v[66:67], v[72:73] op_sel:[1,1,0] op_sel_hi:[0,1,1] neg_lo:[1,0,0]
v_cvt_pk_bf16_f32 v92, v44, v45
v_cvt_pk_bf16_f32 v93, v74, v75
ds_write_addtid_b32 v92 offset:14784
ds_write_addtid_b32 v93 offset:15040
v_pk_mul_f32 v[42:43], v[44:45], v[36:37] op_sel_hi:[1,0]
v_pk_mul_f32 v[72:73], v[74:75], v[66:67] op_sel_hi:[1,0]
v_pk_fma_f32 v[44:45], v[44:45], v[36:37], v[42:43] op_sel:[1,1,0] op_sel_hi:[0,1,1] neg_lo:[1,0,0]
v_pk_fma_f32 v[74:75], v[74:75], v[66:67], v[72:73] op_sel:[1,1,0] op_sel_hi:[0,1,1] neg_lo:[1,0,0]
v_cvt_pk_bf16_f32 v94, v44, v45
v_cvt_pk_bf16_f32 v95, v74, v75
ds_write_addtid_b32 v94 offset:15312
ds_write_addtid_b32 v95 offset:15568
buffer_store_dwordx4 v[220:223], v224, s[28:31], 0 offen offset:0 sc1
v_pk_mul_f32 v[42:43], v[44:45], v[36:37] op_sel_hi:[1,0]
v_pk_mul_f32 v[72:73], v[74:75], v[66:67] op_sel_hi:[1,0]
v_pk_fma_f32 v[44:45], v[44:45], v[36:37], v[42:43] op_sel:[1,1,0] op_sel_hi:[0,1,1] neg_lo:[1,0,0]
v_pk_fma_f32 v[74:75], v[74:75], v[66:67], v[72:73] op_sel:[1,1,0] op_sel_hi:[0,1,1] neg_lo:[1,0,0]
v_cvt_pk_bf16_f32 v92, v44, v45
v_cvt_pk_bf16_f32 v93, v74, v75
ds_write_addtid_b32 v92 offset:15840
ds_write_addtid_b32 v93 offset:16096
v_pk_mul_f32 v[42:43], v[44:45], v[36:37] op_sel_hi:[1,0]
v_pk_mul_f32 v[72:73], v[74:75], v[66:67] op_sel_hi:[1,0]
v_pk_fma_f32 v[44:45], v[44:45], v[36:37], v[42:43] op_sel:[1,1,0] op_sel_hi:[0,1,1] neg_lo:[1,0,0]
v_pk_fma_f32 v[74:75], v[74:75], v[66:67], v[72:73] op_sel:[1,1,0] op_sel_hi:[0,1,1] neg_lo:[1,0,0]
v_cvt_pk_bf16_f32 v94, v44, v45
v_cvt_pk_bf16_f32 v95, v74, v75
ds_write_addtid_b32 v94 offset:16368
ds_write_addtid_b32 v95 offset:16624
ds_read_b128 a[16:19], v23 offset:0
ds_read_b128 a[20:23], v23 offset:32
ds_read_b128 a[24:27], v23 offset:64
ds_read_b128 a[28:31], v23 offset:96
ds_read_b128 a[32:35], v23 offset:128
ds_read_b128 a[36:39], v23 offset:160
ds_read_b128 a[40:43], v23 offset:192
ds_read_b128 a[44:47], v23 offset:224
v_pk_mul_f32 v[42:43], v[40:41], v[38:39] op_sel_hi:[1,0]
v_pk_mul_f32 v[72:73], v[70:71], v[68:69] op_sel_hi:[1,0]
v_pk_fma_f32 v[48:49], v[40:41], v[38:39], v[42:43] op_sel:[1,1,0] op_sel_hi:[0,1,1] neg_hi:[1,0,0]
v_pk_fma_f32 v[78:79], v[70:71], v[68:69], v[72:73] op_sel:[1,1,0] op_sel_hi:[0,1,1] neg_hi:[1,0,0]
ds_read_b128 a[48:51], v23 offset:256
ds_read_b128 a[52:55], v23 offset:288
ds_read_b128 a[56:59], v23 offset:320
ds_read_b128 a[60:63], v23 offset:352
ds_read_b128 a[64:67], v23 offset:384
ds_read_b128 a[68:71], v23 offset:416
ds_read_b128 a[72:75], v23 offset:448
ds_read_b128 a[76:79], v23 offset:480
v_cvt_pk_bf16_f32 v92, v40, v41
v_cvt_pk_bf16_f32 v93, v70, v71
ds_write_addtid_b32 v92 offset:0
ds_write_addtid_b32 v93 offset:256
v_cvt_pk_bf16_f32 v94, v48, v49
v_cvt_pk_bf16_f32 v95, v78, v79
ds_write_addtid_b32 v94 offset:4752
ds_write_addtid_b32 v95 offset:5008
v_pk_mul_f32 v[42:43], v[40:41], v[34:35] op_sel_hi:[1,0]
v_pk_mul_f32 v[72:73], v[70:71], v[64:65] op_sel_hi:[1,0]
v_pk_fma_f32 v[40:41], v[40:41], v[34:35], v[42:43] op_sel:[1,1,0] op_sel_hi:[0,1,1] neg_hi:[1,0,0]
v_pk_fma_f32 v[70:71], v[70:71], v[64:65], v[72:73] op_sel:[1,1,0] op_sel_hi:[0,1,1] neg_hi:[1,0,0]
v_cvt_pk_bf16_f32 v92, v40, v41
v_cvt_pk_bf16_f32 v93, v70, v71
ds_write_addtid_b32 v92 offset:528
ds_write_addtid_b32 v93 offset:784
v_pk_mul_f32 v[42:43], v[40:41], v[34:35] op_sel_hi:[1,0]
v_pk_mul_f32 v[72:73], v[70:71], v[64:65] op_sel_hi:[1,0]
v_pk_fma_f32 v[40:41], v[40:41], v[34:35], v[42:43] op_sel:[1,1,0] op_sel_hi:[0,1,1] neg_hi:[1,0,0]
v_pk_fma_f32 v[70:71], v[70:71], v[64:65], v[72:73] op_sel:[1,1,0] op_sel_hi:[0,1,1] neg_hi:[1,0,0]
v_cvt_pk_bf16_f32 v94, v40, v41
v_cvt_pk_bf16_f32 v95, v70, v71
ds_write_addtid_b32 v94 offset:1056
ds_write_addtid_b32 v95 offset:1312
v_pk_mul_f32 v[42:43], v[40:41], v[38:39] op_sel_hi:[1,0]
v_pk_mul_f32 v[72:73], v[70:71], v[68:69] op_sel_hi:[1,0]
v_pk_fma_f32 v[48:49], v[40:41], v[38:39], v[42:43] op_sel:[1,1,0] op_sel_hi:[0,1,1] neg_hi:[1,0,0]
v_pk_fma_f32 v[78:79], v[70:71], v[68:69], v[72:73] op_sel:[1,1,0] op_sel_hi:[0,1,1] neg_hi:[1,0,0]
v_cvt_pk_bf16_f32 v92, v48, v49
v_cvt_pk_bf16_f32 v93, v78, v79
ds_write_addtid_b32 v92 offset:5280
ds_write_addtid_b32 v93 offset:5536
v_pk_mul_f32 v[42:43], v[40:41], v[34:35] op_sel_hi:[1,0]
v_pk_mul_f32 v[72:73], v[70:71], v[64:65] op_sel_hi:[1,0]
v_pk_fma_f32 v[40:41], v[40:41], v[34:35], v[42:43] op_sel:[1,1,0] op_sel_hi:[0,1,1] neg_hi:[1,0,0]
v_pk_fma_f32 v[70:71], v[70:71], v[64:65], v[72:73] op_sel:[1,1,0] op_sel_hi:[0,1,1] neg_hi:[1,0,0]
v_cvt_pk_bf16_f32 v94, v40, v41
v_cvt_pk_bf16_f32 v95, v70, v71
ds_write_addtid_b32 v94 offset:1584
ds_write_addtid_b32 v95 offset:1840
v_pk_mul_f32 v[42:43], v[40:41], v[34:35] op_sel_hi:[1,0]
v_pk_mul_f32 v[72:73], v[70:71], v[64:65] op_sel_hi:[1,0]
v_pk_fma_f32 v[40:41], v[40:41], v[34:35], v[42:43] op_sel:[1,1,0] op_sel_hi:[0,1,1] neg_hi:[1,0,0]
v_pk_fma_f32 v[70:71], v[70:71], v[64:65], v[72:73] op_sel:[1,1,0] op_sel_hi:[0,1,1] neg_hi:[1,0,0]
v_cvt_pk_bf16_f32 v92, v40, v41
v_cvt_pk_bf16_f32 v93, v70, v71
ds_write_addtid_b32 v92 offset:2112
ds_write_addtid_b32 v93 offset:2368
v_pk_mul_f32 v[42:43], v[40:41], v[38:39] op_sel_hi:[1,0]
v_pk_mul_f32 v[72:73], v[70:71], v[68:69] op_sel_hi:[1,0]
v_pk_fma_f32 v[44:45], v[40:41], v[38:39], v[42:43] op_sel:[1,1,0] op_sel_hi:[0,1,1] neg_hi:[1,0,0]
v_pk_fma_f32 v[74:75], v[70:71], v[68:69], v[72:73] op_sel:[1,1,0] op_sel_hi:[0,1,1] neg_hi:[1,0,0]
v_cvt_pk_bf16_f32 v94, v44, v45
v_cvt_pk_bf16_f32 v95, v74, v75
ds_write_addtid_b32 v94 offset:5808
ds_write_addtid_b32 v95 offset:6064
v_pk_mul_f32 v[42:43], v[40:41], v[34:35] op_sel_hi:[1,0]
v_pk_mul_f32 v[72:73], v[70:71], v[64:65] op_sel_hi:[1,0]
v_pk_fma_f32 v[40:41], v[40:41], v[34:35], v[42:43] op_sel:[1,1,0] op_sel_hi:[0,1,1] neg_hi:[1,0,0]
v_pk_fma_f32 v[70:71], v[70:71], v[64:65], v[72:73] op_sel:[1,1,0] op_sel_hi:[0,1,1] neg_hi:[1,0,0]
v_cvt_pk_bf16_f32 v92, v40, v41
v_cvt_pk_bf16_f32 v93, v70, v71
ds_write_addtid_b32 v92 offset:2640
ds_write_addtid_b32 v93 offset:2896
v_pk_mul_f32 v[42:43], v[40:41], v[34:35] op_sel_hi:[1,0]
v_pk_mul_f32 v[72:73], v[70:71], v[64:65] op_sel_hi:[1,0]
v_pk_fma_f32 v[40:41], v[40:41], v[34:35], v[42:43] op_sel:[1,1,0] op_sel_hi:[0,1,1] neg_hi:[1,0,0]
v_pk_fma_f32 v[70:71], v[70:71], v[64:65], v[72:73] op_sel:[1,1,0] op_sel_hi:[0,1,1] neg_hi:[1,0,0]
v_cvt_pk_bf16_f32 v94, v40, v41
v_cvt_pk_bf16_f32 v95, v70, v71
ds_write_addtid_b32 v94 offset:3168
ds_write_addtid_b32 v95 offset:3424
v_pk_mul_f32 v[42:43], v[40:41], v[38:39] op_sel_hi:[1,0]
v_pk_mul_f32 v[72:73], v[70:71], v[68:69] op_sel_hi:[1,0]
v_pk_fma_f32 v[48:49], v[40:41], v[38:39], v[42:43] op_sel:[1,1,0] op_sel_hi:[0,1,1] neg_hi:[1,0,0]
v_pk_fma_f32 v[78:79], v[70:71], v[68:69], v[72:73] op_sel:[1,1,0] op_sel_hi:[0,1,1] neg_hi:[1,0,0]
v_cvt_pk_bf16_f32 v92, v48, v49
v_cvt_pk_bf16_f32 v93, v78, v79
ds_write_addtid_b32 v92 offset:6336
ds_write_addtid_b32 v93 offset:6592
v_pk_mul_f32 v[42:43], v[40:41], v[34:35] op_sel_hi:[1,0]
v_pk_mul_f32 v[72:73], v[70:71], v[64:65] op_sel_hi:[1,0]
v_pk_fma_f32 v[40:41], v[40:41], v[34:35], v[42:43] op_sel:[1,1,0] op_sel_hi:[0,1,1] neg_hi:[1,0,0]
v_pk_fma_f32 v[70:71], v[70:71], v[64:65], v[72:73] op_sel:[1,1,0] op_sel_hi:[0,1,1] neg_hi:[1,0,0]
v_cvt_pk_bf16_f32 v94, v40, v41
v_cvt_pk_bf16_f32 v95, v70, v71
ds_write_addtid_b32 v94 offset:3696
ds_write_addtid_b32 v95 offset:3952
v_pk_mul_f32 v[42:43], v[40:41], v[34:35] op_sel_hi:[1,0]
v_pk_mul_f32 v[72:73], v[70:71], v[64:65] op_sel_hi:[1,0]
v_pk_fma_f32 v[40:41], v[40:41], v[34:35], v[42:43] op_sel:[1,1,0] op_sel_hi:[0,1,1] neg_hi:[1,0,0]
v_pk_fma_f32 v[70:71], v[70:71], v[64:65], v[72:73] op_sel:[1,1,0] op_sel_hi:[0,1,1] neg_hi:[1,0,0]
v_cvt_pk_bf16_f32 v92, v40, v41
v_cvt_pk_bf16_f32 v93, v70, v71
ds_write_addtid_b32 v92 offset:4224
ds_write_addtid_b32 v93 offset:4480
v_pk_mul_f32 v[42:43], v[40:41], v[38:39] op_sel_hi:[1,0]
v_pk_mul_f32 v[72:73], v[70:71], v[68:69] op_sel_hi:[1,0]
v_pk_fma_f32 v[46:47], v[40:41], v[38:39], v[42:43] op_sel:[1,1,0] op_sel_hi:[0,1,1] neg_hi:[1,0,0]
v_pk_fma_f32 v[76:77], v[70:71], v[68:69], v[72:73] op_sel:[1,1,0] op_sel_hi:[0,1,1] neg_hi:[1,0,0]
v_cvt_pk_bf16_f32 v94, v46, v47
v_cvt_pk_bf16_f32 v95, v76, v77
ds_write_addtid_b32 v94 offset:6864
ds_write_addtid_b32 v95 offset:7120
buffer_store_dwordx4 v[220:223], v224, s[28:31], 0 offen offset:2048 sc1
v_pk_mul_f32 v[42:43], v[44:45], v[38:39] op_sel_hi:[1,0]
v_pk_mul_f32 v[72:73], v[74:75], v[68:69] op_sel_hi:[1,0]
v_pk_fma_f32 v[44:45], v[44:45], v[38:39], v[42:43] op_sel:[1,1,0] op_sel_hi:[0,1,1] neg_hi:[1,0,0]
v_pk_fma_f32 v[74:75], v[74:75], v[68:69], v[72:73] op_sel:[1,1,0] op_sel_hi:[0,1,1] neg_hi:[1,0,0]
v_cvt_pk_bf16_f32 v92, v44, v45
v_cvt_pk_bf16_f32 v93, v74, v75
ds_write_addtid_b32 v92 offset:7392
ds_write_addtid_b32 v93 offset:7648
v_pk_mul_f32 v[42:43], v[46:47], v[38:39] op_sel_hi:[1,0]
v_pk_mul_f32 v[72:73], v[76:77], v[68:69] op_sel_hi:[1,0]
v_pk_fma_f32 v[46:47], v[46:47], v[38:39], v[42:43] op_sel:[1,1,0] op_sel_hi:[0,1,1] neg_hi:[1,0,0]
v_pk_fma_f32 v[76:77], v[76:77], v[68:69], v[72:73] op_sel:[1,1,0] op_sel_hi:[0,1,1] neg_hi:[1,0,0]
v_cvt_pk_bf16_f32 v94, v46, v47
v_cvt_pk_bf16_f32 v95, v76, v77
ds_write_addtid_b32 v94 offset:7920
ds_write_addtid_b32 v95 offset:8176
v_pk_mul_f32 v[42:43], v[44:45], v[38:39] op_sel_hi:[1,0]
v_pk_mul_f32 v[72:73], v[74:75], v[68:69] op_sel_hi:[1,0]
v_pk_fma_f32 v[44:45], v[44:45], v[38:39], v[42:43] op_sel:[1,1,0] op_sel_hi:[0,1,1] neg_hi:[1,0,0]
v_pk_fma_f32 v[74:75], v[74:75], v[68:69], v[72:73] op_sel:[1,1,0] op_sel_hi:[0,1,1] neg_hi:[1,0,0]
v_cvt_pk_bf16_f32 v92, v44, v45
v_cvt_pk_bf16_f32 v93, v74, v75
ds_write_addtid_b32 v92 offset:8448
ds_write_addtid_b32 v93 offset:8704
v_pk_mul_f32 v[42:43], v[46:47], v[38:39] op_sel_hi:[1,0]
v_pk_mul_f32 v[72:73], v[76:77], v[68:69] op_sel_hi:[1,0]
v_pk_fma_f32 v[46:47], v[46:47], v[38:39], v[42:43] op_sel:[1,1,0] op_sel_hi:[0,1,1] neg_hi:[1,0,0]
v_pk_fma_f32 v[76:77], v[76:77], v[68:69], v[72:73] op_sel:[1,1,0] op_sel_hi:[0,1,1] neg_hi:[1,0,0]
v_cvt_pk_bf16_f32 v94, v46, v47
v_cvt_pk_bf16_f32 v95, v76, v77
ds_write_addtid_b32 v94 offset:8976
ds_write_addtid_b32 v95 offset:9232
v_pk_mul_f32 v[42:43], v[46:47], v[38:39] op_sel_hi:[1,0]
v_pk_mul_f32 v[72:73], v[76:77], v[68:69] op_sel_hi:[1,0]
v_pk_fma_f32 v[46:47], v[46:47], v[38:39], v[42:43] op_sel:[1,1,0] op_sel_hi:[0,1,1] neg_hi:[1,0,0]
v_pk_fma_f32 v[76:77], v[76:77], v[68:69], v[72:73] op_sel:[1,1,0] op_sel_hi:[0,1,1] neg_hi:[1,0,0]
v_cvt_pk_bf16_f32 v92, v46, v47
v_cvt_pk_bf16_f32 v93, v76, v77
ds_write_addtid_b32 v92 offset:9504
ds_write_addtid_b32 v93 offset:9760
v_pk_mul_f32 v[42:43], v[46:47], v[38:39] op_sel_hi:[1,0]
v_pk_mul_f32 v[72:73], v[76:77], v[68:69] op_sel_hi:[1,0]
v_pk_fma_f32 v[46:47], v[46:47], v[38:39], v[42:43] op_sel:[1,1,0] op_sel_hi:[0,1,1] neg_hi:[1,0,0]
v_pk_fma_f32 v[76:77], v[76:77], v[68:69], v[72:73] op_sel:[1,1,0] op_sel_hi:[0,1,1] neg_hi:[1,0,0]
v_cvt_pk_bf16_f32 v94, v46, v47
v_cvt_pk_bf16_f32 v95, v76, v77
ds_write_addtid_b32 v94 offset:10032
ds_write_addtid_b32 v95 offset:10288
v_pk_mul_f32 v[42:43], v[46:47], v[38:39] op_sel_hi:[1,0]
v_pk_mul_f32 v[72:73], v[76:77], v[68:69] op_sel_hi:[1,0]
v_pk_fma_f32 v[46:47], v[46:47], v[38:39], v[42:43] op_sel:[1,1,0] op_sel_hi:[0,1,1] neg_hi:[1,0,0]
v_pk_fma_f32 v[76:77], v[76:77], v[68:69], v[72:73] op_sel:[1,1,0] op_sel_hi:[0,1,1] neg_hi:[1,0,0]
v_cvt_pk_bf16_f32 v92, v46, v47
v_cvt_pk_bf16_f32 v93, v76, v77
ds_write_addtid_b32 v92 offset:10560
ds_write_addtid_b32 v93 offset:10816
v_pk_mul_f32 v[42:43], v[46:47], v[38:39] op_sel_hi:[1,0]
v_pk_mul_f32 v[72:73], v[76:77], v[68:69] op_sel_hi:[1,0]
v_pk_fma_f32 v[46:47], v[46:47], v[38:39], v[42:43] op_sel:[1,1,0] op_sel_hi:[0,1,1] neg_hi:[1,0,0]
v_pk_fma_f32 v[76:77], v[76:77], v[68:69], v[72:73] op_sel:[1,1,0] op_sel_hi:[0,1,1] neg_hi:[1,0,0]
v_cvt_pk_bf16_f32 v94, v46, v47
v_cvt_pk_bf16_f32 v95, v76, v77
ds_write_addtid_b32 v94 offset:11088
ds_write_addtid_b32 v95 offset:11344
ds_read_b128 a[80:83], v24 offset:0
ds_read_b128 a[84:87], v24 offset:32
ds_read_b128 a[88:91], v24 offset:64
ds_read_b128 a[92:95], v24 offset:96
s_mul_i32 s76, s68, 3712
s_add_u32 s76, s76, 137984
v_lshl_add_u32 v25, v1, 4, s76
v_add_u32 v26, s76, v29
v_add_u32 v27, s76, v30
v_add_u32 v28, s76, v31
s_lshl_b32 s75, s73, 16
s_waitcnt lgkmcnt(3)
v_mfma_f32_32x32x16_bf16 v[96:111], a[80:83], a[16:19], 0
ds_read_b128 a[96:99], v24 offset:128
s_and_b32 s74, s72, 0xffff0000
v_mov_b32 v56, s74
v_mul_f32 v56, 0x3fb8aa3b, v56
v_exp_f32 v56, v56
s_waitcnt vmcnt(14)
v_lshlrev_b32 v32, 16, v8
s_waitcnt vmcnt(13)
v_lshlrev_b32 v33, 16, v9
s_waitcnt lgkmcnt(3)
v_mfma_f32_32x32x16_bf16 v[96:111], a[84:87], a[20:23], v[96:111]
ds_read_b128 a[100:103], v24 offset:160
v_cvt_pk_bf16_f32 v56, v56, v56
v_lshlrev_b32 v56, 16, v56
s_waitcnt vmcnt(12)
v_lshlrev_b32 v52, 16, v10
s_waitcnt vmcnt(11)
v_lshlrev_b32 v53, 16, v11
s_waitcnt vmcnt(10)
v_lshlrev_b32 v50, 16, v12
s_waitcnt vmcnt(9)
v_lshlrev_b32 v51, 16, v13
s_waitcnt lgkmcnt(3)
v_mfma_f32_32x32x16_bf16 v[96:111], a[88:91], a[24:27], v[96:111]
ds_read_b128 a[104:107], v24 offset:192
v_and_b32 v62, 0xffff0000, v8
v_and_b32 v63, 0xffff0000, v9
v_and_b32 v82, 0xffff0000, v10
v_and_b32 v83, 0xffff0000, v11
v_and_b32 v80, 0xffff0000, v12
s_waitcnt lgkmcnt(3)
v_mfma_f32_32x32x16_bf16 v[96:111], a[92:95], a[28:31], v[96:111]
ds_read_b128 a[108:111], v24 offset:224
v_and_b32 v81, 0xffff0000, v13
v_mul_f32 v32, v56, v32
v_mul_f32 v33, v56, v33
v_mul_f32 v32, 0x3fb8aa3b, v32
v_mul_f32 v33, 0x3e22f983, v33
s_waitcnt lgkmcnt(3)
v_mfma_f32_32x32x16_bf16 v[96:111], a[96:99], a[32:35], v[96:111]
ds_read_b128 a[112:115], v24 offset:256
v_mul_f32 v62, v56, v62
v_mul_f32 v63, v56, v63
v_mul_f32 v62, 0x3fb8aa3b, v62
v_mul_f32 v63, 0x3e22f983, v63
v_mul_f32 v48, 0x41000000, v32
s_waitcnt lgkmcnt(3)
v_mfma_f32_32x32x16_bf16 v[96:111], a[100:103], a[36:39], v[96:111]
ds_read_b128 a[116:119], v24 offset:288
v_mul_f32 v42, 0x41000000, v33
v_exp_f32 v48, v48
v_fract_f32 v42, v42
v_mul_f32 v78, 0x41000000, v62
v_mul_f32 v72, 0x41000000, v63
s_waitcnt lgkmcnt(3)
v_mfma_f32_32x32x16_bf16 v[96:111], a[104:107], a[40:43], v[96:111]
ds_read_b128 a[120:123], v24 offset:320
v_exp_f32 v78, v78
v_fract_f32 v72, v72
v_cos_f32 v36, v42
v_sin_f32 v37, v42
v_cos_f32 v66, v72
s_waitcnt lgkmcnt(3)
v_mfma_f32_32x32x16_bf16 v[96:111], a[108:111], a[44:47], v[96:111]
ds_read_b128 a[124:127], v24 offset:352
v_sin_f32 v67, v72
v_mul_f32 v52, v56, v52
v_mul_f32 v53, v56, v53
v_mul_f32 v40, v50, v52
v_mul_f32 v41, v50, v53
s_waitcnt lgkmcnt(3)
v_mfma_f32_32x32x16_bf16 v[96:111], a[112:115], a[48:51], v[96:111]
ds_read_b128 a[128:131], v24 offset:384
v_fma_f32 v40, -v51, v53, v40
v_fma_f32 v41, -v51, v52, -v41
v_mul_f32 v82, v56, v82
v_mul_f32 v83, v56, v83
v_mul_f32 v70, v80, v82
s_waitcnt lgkmcnt(3)
v_mfma_f32_32x32x16_bf16 v[96:111], a[116:119], a[52:55], v[96:111]
ds_read_b128 a[132:135], v24 offset:416
v_mul_f32 v71, v80, v83
v_fma_f32 v70, -v81, v83, v70
v_fma_f32 v71, -v81, v82, -v71
v_mul_f32 v36, v36, v48
v_mul_f32 v37, v37, v48
s_waitcnt lgkmcnt(3)
v_mfma_f32_32x32x16_bf16 v[96:111], a[120:123], a[56:59], v[96:111]
ds_read_b128 a[136:139], v24 offset:448
v_mul_f32 v66, v66, v78
v_mul_f32 v67, v67, v78
v_exp_f32 v48, v32
v_fract_f32 v42, v33
v_exp_f32 v78, v62
s_waitcnt lgkmcnt(3)
v_mfma_f32_32x32x16_bf16 v[96:111], a[124:127], a[60:63], v[96:111]
ds_read_b128 a[140:143], v24 offset:480
v_fract_f32 v72, v63
v_cos_f32 v34, v42
v_sin_f32 v35, v42
v_cos_f32 v64, v72
v_sin_f32 v65, v72
s_waitcnt lgkmcnt(3)
v_mfma_f32_32x32x16_bf16 v[96:111], a[128:131], a[64:67], v[96:111]
ds_write_b128 v25, v[192:195] offset:0
v_mul_f32 v34, v34, v48
v_mul_f32 v35, v35, v48
v_mul_f32 v64, v64, v78
v_mul_f32 v65, v65, v78
v_mul_f32 v48, 0x43800000, v32
s_waitcnt lgkmcnt(3)
v_mfma_f32_32x32x16_bf16 v[96:111], a[132:135], a[68:71], v[96:111]
ds_write_b128 v25, v[192:195] offset:1024
v_mul_f32 v42, 0x43800000, v33
v_exp_f32 v48, v48
v_fract_f32 v42, v42
v_mul_f32 v78, 0x43800000, v62
v_mul_f32 v72, 0x43800000, v63
s_waitcnt lgkmcnt(3)
v_mfma_f32_32x32x16_bf16 v[96:111], a[136:139], a[72:75], v[96:111]
ds_write_b128 v25, v[192:195] offset:2048
v_exp_f32 v78, v78
v_fract_f32 v72, v72
v_cos_f32 v38, v42
v_sin_f32 v39, v42
v_cos_f32 v68, v72
s_waitcnt lgkmcnt(3)
v_mfma_f32_32x32x16_bf16 v[96:111], a[140:143], a[76:79], v[96:111]
v_sin_f32 v69, v72
v_mul_f32 v38, v38, v48
v_mul_f32 v39, v39, v48
v_mul_f32 v68, v68, v78
v_mul_f32 v69, v69, v78
s_mov_b32 exec_hi, 0xff
ds_write_b128 v25, v[192:195] offset:3072
s_mov_b64 exec, 1
s_nop 3
v_add_f32 v96, s75, v96
s_mov_b64 exec, -1
s_nop 0
v_cvt_pk_bf16_f32 v120, v99, v98
v_cvt_pk_bf16_f32 v121, v97, v96
v_cvt_pk_bf16_f32 v122, v100, v99
v_cvt_pk_bf16_f32 v123, v98, v97
ds_write_b64 v26, v[120:121] offset:1728
ds_write_b64 v26, v[122:123] offset:512
v_cvt_pk_bf16_f32 v124, v103, v102
v_cvt_pk_bf16_f32 v125, v101, v101
v_cvt_pk_bf16_f32 v126, v103, v103
v_cvt_pk_bf16_f32 v127, v102, v101
ds_write_b64 v26, v[124:125] offset:1216
ds_write_b64 v26, v[126:127] offset:0
v_cvt_pk_bf16_f32 v128, v104, v105
v_cvt_pk_bf16_f32 v129, v106, v107
ds_write_b16 v27, v128 offset:2688
ds_write_b16_d16_hi v27, v128 offset:2432
ds_write_b16 v28, v129 offset:2976
ds_write_b16 v28, v129 offset:3166
ds_write_b16_d16_hi v28, v129 offset:2944
ds_write_b16_d16_hi v28, v129 offset:3134
v_and_b32 v130, 0xffff0000, v126
v_mov_b32 v131, v126
v_lshrrev_b32 v132, 16, v121
v_mov_b32 v133, s76
s_mov_b32 exec_lo, 0
s_mov_b32 exec_hi, 0x80000000
ds_write_b32 v133, v126 offset:60
ds_write_b64 v133, v[130:131] offset:1272
s_mov_b64 exec, 1
ds_write_b32 v133, v132 offset:1088
s_mov_b64 exec, -1
v_readlane_b32 s82, v128, 63
s_mul_i32 s34, s68, 3712
s_add_u32 s34, s34, 137984
v_add_u32 v228, s34, v112
v_add_u32 v229, s34, v113
v_add_u32 v230, s34, v114
v_add_u32 v231, s34, v115
v_mov_b32 v92, 0x3f80
ds_write_addtid_b32 v92
ds_write_addtid_b32 v92 offset:256
v_cvt_pk_bf16_f32 v94, v36, v37
v_cvt_pk_bf16_f32 v95, v66, v67
ds_write_addtid_b32 v94 offset:528
ds_write_addtid_b32 v95 offset:784
ds_read2_b32 a[184:185], v229 offset0:0 offset1:1
v_pk_mul_f32 v[42:43], v[36:37], v[36:37] op_sel_hi:[1,0]
v_pk_mul_f32 v[72:73], v[66:67], v[66:67] op_sel_hi:[1,0]
v_pk_fma_f32 v[44:45], v[36:37], v[36:37], v[42:43] op_sel:[1,1,0] op_sel_hi:[0,1,1] neg_lo:[1,0,0]
v_pk_fma_f32 v[74:75], v[66:67], v[66:67], v[72:73] op_sel:[1,1,0] op_sel_hi:[0,1,1] neg_lo:[1,0,0]
v_cvt_pk_bf16_f32 v92, v44, v45
v_cvt_pk_bf16_f32 v93, v74, v75
ds_write_addtid_b32 v92 offset:1056
ds_write_addtid_b32 v93 offset:1312
ds_read2_b32 a[186:187], v229 offset0:2 offset1:3
v_pk_mul_f32 v[42:43], v[44:45], v[36:37] op_sel_hi:[1,0]
v_pk_mul_f32 v[72:73], v[74:75], v[66:67] op_sel_hi:[1,0]
v_pk_fma_f32 v[44:45], v[44:45], v[36:37], v[42:43] op_sel:[1,1,0] op_sel_hi:[0,1,1] neg_lo:[1,0,0]
v_pk_fma_f32 v[74:75], v[74:75], v[66:67], v[72:73] op_sel:[1,1,0] op_sel_hi:[0,1,1] neg_lo:[1,0,0]
v_cvt_pk_bf16_f32 v94, v44, v45
v_cvt_pk_bf16_f32 v95, v74, v75
ds_write_addtid_b32 v94 offset:1584
ds_write_addtid_b32 v95 offset:1840
ds_read2_b32 a[188:189], v228 offset0:240 offset1:241
v_pk_mul_f32 v[42:43], v[44:45], v[36:37] op_sel_hi:[1,0]
v_pk_mul_f32 v[72:73], v[74:75], v[66:67] op_sel_hi:[1,0]
v_pk_fma_f32 v[44:45], v[44:45], v[36:37], v[42:43] op_sel:[1,1,0] op_sel_hi:[0,1,1] neg_lo:[1,0,0]
v_pk_fma_f32 v[74:75], v[74:75], v[66:67], v[72:73] op_sel:[1,1,0] op_sel_hi:[0,1,1] neg_lo:[1,0,0]
v_cvt_pk_bf16_f32 v92, v44, v45
v_cvt_pk_bf16_f32 v93, v74, v75
ds_write_addtid_b32 v92 offset:2112
ds_write_addtid_b32 v93 offset:2368
ds_read2_b32 a[190:191], v228 offset0:242 offset1:243
v_pk_mul_f32 v[42:43], v[44:45], v[36:37] op_sel_hi:[1,0]
v_pk_mul_f32 v[72:73], v[74:75], v[66:67] op_sel_hi:[1,0]
v_pk_fma_f32 v[44:45], v[44:45], v[36:37], v[42:43] op_sel:[1,1,0] op_sel_hi:[0,1,1] neg_lo:[1,0,0]
v_pk_fma_f32 v[74:75], v[74:75], v[66:67], v[72:73] op_sel:[1,1,0] op_sel_hi:[0,1,1] neg_lo:[1,0,0]
v_cvt_pk_bf16_f32 v94, v44, v45
v_cvt_pk_bf16_f32 v95, v74, v75
ds_write_addtid_b32 v94 offset:2640
ds_write_addtid_b32 v95 offset:2896
ds_read2_b32 a[192:193], v228 offset0:224 offset1:225
v_pk_mul_f32 v[42:43], v[44:45], v[36:37] op_sel_hi:[1,0]
v_pk_mul_f32 v[72:73], v[74:75], v[66:67] op_sel_hi:[1,0]
v_pk_fma_f32 v[44:45], v[44:45], v[36:37], v[42:43] op_sel:[1,1,0] op_sel_hi:[0,1,1] neg_lo:[1,0,0]
v_pk_fma_f32 v[74:75], v[74:75], v[66:67], v[72:73] op_sel:[1,1,0] op_sel_hi:[0,1,1] neg_lo:[1,0,0]
v_cvt_pk_bf16_f32 v92, v44, v45
v_cvt_pk_bf16_f32 v93, v74, v75
ds_write_addtid_b32 v92 offset:3168
ds_write_addtid_b32 v93 offset:3424
ds_read2_b32 a[194:195], v228 offset0:226 offset1:227
v_pk_mul_f32 v[42:43], v[44:45], v[36:37] op_sel_hi:[1,0]
v_pk_mul_f32 v[72:73], v[74:75], v[66:67] op_sel_hi:[1,0]
v_pk_fma_f32 v[44:45], v[44:45], v[36:37], v[42:43] op_sel:[1,1,0] op_sel_hi:[0,1,1] neg_lo:[1,0,0]
v_pk_fma_f32 v[74:75], v[74:75], v[66:67], v[72:73] op_sel:[1,1,0] op_sel_hi:[0,1,1] neg_lo:[1,0,0]
v_cvt_pk_bf16_f32 v94, v44, v45
v_cvt_pk_bf16_f32 v95, v74, v75
ds_write_addtid_b32 v94 offset:3696
ds_write_addtid_b32 v95 offset:3952
buffer_store_dwordx4 v[220:223], v224, s[28:31], 0 offen offset:1024 sc1
ds_read2_b32 a[196:197], v228 offset0:208 offset1:209
v_pk_mul_f32 v[42:43], v[44:45], v[36:37] op_sel_hi:[1,0]
v_pk_mul_f32 v[72:73], v[74:75], v[66:67] op_sel_hi:[1,0]
v_pk_fma_f32 v[44:45], v[44:45], v[36:37], v[42:43] op_sel:[1,1,0] op_sel_hi:[0,1,1] neg_lo:[1,0,0]
v_pk_fma_f32 v[74:75], v[74:75], v[66:67], v[72:73] op_sel:[1,1,0] op_sel_hi:[0,1,1] neg_lo:[1,0,0]
v_cvt_pk_bf16_f32 v92, v44, v45
v_cvt_pk_bf16_f32 v93, v74, v75
ds_write_addtid_b32 v92 offset:4224
ds_write_addtid_b32 v93 offset:4480
ds_read2_b32 a[198:199], v228 offset0:210 offset1:211
v_pk_mul_f32 v[42:43], v[44:45], v[36:37] op_sel_hi:[1,0]
v_pk_mul_f32 v[72:73], v[74:75], v[66:67] op_sel_hi:[1,0]
v_pk_fma_f32 v[44:45], v[44:45], v[36:37], v[42:43] op_sel:[1,1,0] op_sel_hi:[0,1,1] neg_lo:[1,0,0]
v_pk_fma_f32 v[74:75], v[74:75], v[66:67], v[72:73] op_sel:[1,1,0] op_sel_hi:[0,1,1] neg_lo:[1,0,0]
v_cvt_pk_bf16_f32 v94, v44, v45
v_cvt_pk_bf16_f32 v95, v74, v75
ds_write_addtid_b32 v94 offset:4752
ds_write_addtid_b32 v95 offset:5008
ds_read2_b32 a[200:201], v228 offset0:192 offset1:193
v_pk_mul_f32 v[42:43], v[44:45], v[36:37] op_sel_hi:[1,0]
v_pk_mul_f32 v[72:73], v[74:75], v[66:67] op_sel_hi:[1,0]
v_pk_fma_f32 v[44:45], v[44:45], v[36:37], v[42:43] op_sel:[1,1,0] op_sel_hi:[0,1,1] neg_lo:[1,0,0]
v_pk_fma_f32 v[74:75], v[74:75], v[66:67], v[72:73] op_sel:[1,1,0] op_sel_hi:[0,1,1] neg_lo:[1,0,0]
v_cvt_pk_bf16_f32 v92, v44, v45
v_cvt_pk_bf16_f32 v93, v74, v75
ds_write_addtid_b32 v92 offset:5280
ds_write_addtid_b32 v93 offset:5536
ds_read2_b32 a[202:203], v228 offset0:194 offset1:195
v_pk_mul_f32 v[42:43], v[44:45], v[36:37] op_sel_hi:[1,0]
v_pk_mul_f32 v[72:73], v[74:75], v[66:67] op_sel_hi:[1,0]
v_pk_fma_f32 v[44:45], v[44:45], v[36:37], v[42:43] op_sel:[1,1,0] op_sel_hi:[0,1,1] neg_lo:[1,0,0]
v_pk_fma_f32 v[74:75], v[74:75], v[66:67], v[72:73] op_sel:[1,1,0] op_sel_hi:[0,1,1] neg_lo:[1,0,0]
v_cvt_pk_bf16_f32 v94, v44, v45
v_cvt_pk_bf16_f32 v95, v74, v75
ds_write_addtid_b32 v94 offset:5808
ds_write_addtid_b32 v95 offset:6064
ds_read2_b32 a[204:205], v228 offset0:176 offset1:177
v_pk_mul_f32 v[42:43], v[44:45], v[36:37] op_sel_hi:[1,0]
v_pk_mul_f32 v[72:73], v[74:75], v[66:67] op_sel_hi:[1,0]
v_pk_fma_f32 v[44:45], v[44:45], v[36:37], v[42:43] op_sel:[1,1,0] op_sel_hi:[0,1,1] neg_lo:[1,0,0]
v_pk_fma_f32 v[74:75], v[74:75], v[66:67], v[72:73] op_sel:[1,1,0] op_sel_hi:[0,1,1] neg_lo:[1,0,0]
v_cvt_pk_bf16_f32 v92, v44, v45
v_cvt_pk_bf16_f32 v93, v74, v75
ds_write_addtid_b32 v92 offset:6336
ds_write_addtid_b32 v93 offset:6592
ds_read2_b32 a[206:207], v228 offset0:178 offset1:179
v_pk_mul_f32 v[42:43], v[44:45], v[36:37] op_sel_hi:[1,0]
v_pk_mul_f32 v[72:73], v[74:75], v[66:67] op_sel_hi:[1,0]
v_pk_fma_f32 v[44:45], v[44:45], v[36:37], v[42:43] op_sel:[1,1,0] op_sel_hi:[0,1,1] neg_lo:[1,0,0]
v_pk_fma_f32 v[74:75], v[74:75], v[66:67], v[72:73] op_sel:[1,1,0] op_sel_hi:[0,1,1] neg_lo:[1,0,0]
v_cvt_pk_bf16_f32 v94, v44, v45
v_cvt_pk_bf16_f32 v95, v74, v75
ds_write_addtid_b32 v94 offset:6864
ds_write_addtid_b32 v95 offset:7120
ds_read2_b32 a[208:209], v228 offset0:160 offset1:161
v_pk_mul_f32 v[42:43], v[44:45], v[36:37] op_sel_hi:[1,0]
v_pk_mul_f32 v[72:73], v[74:75], v[66:67] op_sel_hi:[1,0]
v_pk_fma_f32 v[44:45], v[44:45], v[36:37], v[42:43] op_sel:[1,1,0] op_sel_hi:[0,1,1] neg_lo:[1,0,0]
v_pk_fma_f32 v[74:75], v[74:75], v[66:67], v[72:73] op_sel:[1,1,0] op_sel_hi:[0,1,1] neg_lo:[1,0,0]
v_cvt_pk_bf16_f32 v92, v44, v45
v_cvt_pk_bf16_f32 v93, v74, v75
ds_write_addtid_b32 v92 offset:7392
ds_write_addtid_b32 v93 offset:7648
ds_read2_b32 a[210:211], v228 offset0:162 offset1:163
v_pk_mul_f32 v[42:43], v[44:45], v[36:37] op_sel_hi:[1,0]
v_pk_mul_f32 v[72:73], v[74:75], v[66:67] op_sel_hi:[1,0]
v_pk_fma_f32 v[44:45], v[44:45], v[36:37], v[42:43] op_sel:[1,1,0] op_sel_hi:[0,1,1] neg_lo:[1,0,0]
v_pk_fma_f32 v[74:75], v[74:75], v[66:67], v[72:73] op_sel:[1,1,0] op_sel_hi:[0,1,1] neg_lo:[1,0,0]
v_cvt_pk_bf16_f32 v94, v44, v45
v_cvt_pk_bf16_f32 v95, v74, v75
ds_write_addtid_b32 v94 offset:7920
ds_write_addtid_b32 v95 offset:8176
ds_read2_b32 a[212:213], v228 offset0:144 offset1:145
v_pk_mul_f32 v[42:43], v[44:45], v[36:37] op_sel_hi:[1,0]
v_pk_mul_f32 v[72:73], v[74:75], v[66:67] op_sel_hi:[1,0]
v_pk_fma_f32 v[44:45], v[44:45], v[36:37], v[42:43] op_sel:[1,1,0] op_sel_hi:[0,1,1] neg_lo:[1,0,0]
v_pk_fma_f32 v[74:75], v[74:75], v[66:67], v[72:73] op_sel:[1,1,0] op_sel_hi:[0,1,1] neg_lo:[1,0,0]
v_cvt_pk_bf16_f32 v92, v44, v45
v_cvt_pk_bf16_f32 v93, v74, v75
ds_write_addtid_b32 v92 offset:8448
ds_write_addtid_b32 v93 offset:8704
ds_read2_b32 a[214:215], v228 offset0:146 offset1:147
v_pk_mul_f32 v[42:43], v[44:45], v[36:37] op_sel_hi:[1,0]
v_pk_mul_f32 v[72:73], v[74:75], v[66:67] op_sel_hi:[1,0]
v_pk_fma_f32 v[44:45], v[44:45], v[36:37], v[42:43] op_sel:[1,1,0] op_sel_hi:[0,1,1] neg_lo:[1,0,0]
v_pk_fma_f32 v[74:75], v[74:75], v[66:67], v[72:73] op_sel:[1,1,0] op_sel_hi:[0,1,1] neg_lo:[1,0,0]
v_cvt_pk_bf16_f32 v94, v44, v45
v_cvt_pk_bf16_f32 v95, v74, v75
ds_write_addtid_b32 v94 offset:8976
ds_write_addtid_b32 v95 offset:9232
ds_read2_b32 a[216:217], v228 offset0:128 offset1:129
v_pk_mul_f32 v[42:43], v[44:45], v[36:37] op_sel_hi:[1,0]
v_pk_mul_f32 v[72:73], v[74:75], v[66:67] op_sel_hi:[1,0]
v_pk_fma_f32 v[44:45], v[44:45], v[36:37], v[42:43] op_sel:[1,1,0] op_sel_hi:[0,1,1] neg_lo:[1,0,0]
v_pk_fma_f32 v[74:75], v[74:75], v[66:67], v[72:73] op_sel:[1,1,0] op_sel_hi:[0,1,1] neg_lo:[1,0,0]
v_cvt_pk_bf16_f32 v92, v44, v45
v_cvt_pk_bf16_f32 v93, v74, v75
ds_write_addtid_b32 v92 offset:9504
ds_write_addtid_b32 v93 offset:9760
ds_read2_b32 a[218:219], v228 offset0:130 offset1:131
v_pk_mul_f32 v[42:43], v[44:45], v[36:37] op_sel_hi:[1,0]
v_pk_mul_f32 v[72:73], v[74:75], v[66:67] op_sel_hi:[1,0]
v_pk_fma_f32 v[44:45], v[44:45], v[36:37], v[42:43] op_sel:[1,1,0] op_sel_hi:[0,1,1] neg_lo:[1,0,0]
v_pk_fma_f32 v[74:75], v[74:75], v[66:67], v[72:73] op_sel:[1,1,0] op_sel_hi:[0,1,1] neg_lo:[1,0,0]
v_cvt_pk_bf16_f32 v94, v44, v45
v_cvt_pk_bf16_f32 v95, v74, v75
ds_write_addtid_b32 v94 offset:10032
ds_write_addtid_b32 v95 offset:10288
ds_read2_b32 a[220:221], v228 offset0:112 offset1:113
v_pk_mul_f32 v[42:43], v[44:45], v[36:37] op_sel_hi:[1,0]
v_pk_mul_f32 v[72:73], v[74:75], v[66:67] op_sel_hi:[1,0]
v_pk_fma_f32 v[44:45], v[44:45], v[36:37], v[42:43] op_sel:[1,1,0] op_sel_hi:[0,1,1] neg_lo:[1,0,0]
v_pk_fma_f32 v[74:75], v[74:75], v[66:67], v[72:73] op_sel:[1,1,0] op_sel_hi:[0,1,1] neg_lo:[1,0,0]
v_cvt_pk_bf16_f32 v92, v44, v45
v_cvt_pk_bf16_f32 v93, v74, v75
ds_write_addtid_b32 v92 offset:10560
ds_write_addtid_b32 v93 offset:10816
ds_read2_b32 a[222:223], v228 offset0:114 offset1:115
v_pk_mul_f32 v[42:43], v[44:45], v[36:37] op_sel_hi:[1,0]
v_pk_mul_f32 v[72:73], v[74:75], v[66:67] op_sel_hi:[1,0]
v_pk_fma_f32 v[44:45], v[44:45], v[36:37], v[42:43] op_sel:[1,1,0] op_sel_hi:[0,1,1] neg_lo:[1,0,0]
v_pk_fma_f32 v[74:75], v[74:75], v[66:67], v[72:73] op_sel:[1,1,0] op_sel_hi:[0,1,1] neg_lo:[1,0,0]
v_cvt_pk_bf16_f32 v94, v44, v45
v_cvt_pk_bf16_f32 v95, v74, v75
ds_write_addtid_b32 v94 offset:11088
ds_write_addtid_b32 v95 offset:11344
buffer_store_dwordx4 v[220:223], v224, s[28:31], 0 offen offset:3072 sc1
ds_read2_b32 a[224:225], v228 offset0:96 offset1:97
v_pk_mul_f32 v[42:43], v[44:45], v[36:37] op_sel_hi:[1,0]
v_pk_mul_f32 v[72:73], v[74:75], v[66:67] op_sel_hi:[1,0]
v_pk_fma_f32 v[44:45], v[44:45], v[36:37], v[42:43] op_sel:[1,1,0] op_sel_hi:[0,1,1] neg_lo:[1,0,0]
v_pk_fma_f32 v[74:75], v[74:75], v[66:67], v[72:73] op_sel:[1,1,0] op_sel_hi:[0,1,1] neg_lo:[1,0,0]
v_cvt_pk_bf16_f32 v92, v44, v45
v_cvt_pk_bf16_f32 v93, v74, v75
ds_write_addtid_b32 v92 offset:11616
ds_write_addtid_b32 v93 offset:11872
ds_read2_b32 a[226:227], v228 offset0:98 offset1:99
v_pk_mul_f32 v[42:43], v[44:45], v[36:37] op_sel_hi:[1,0]
v_pk_mul_f32 v[72:73], v[74:75], v[66:67] op_sel_hi:[1,0]
v_pk_fma_f32 v[44:45], v[44:45], v[36:37], v[42:43] op_sel:[1,1,0] op_sel_hi:[0,1,1] neg_lo:[1,0,0]
v_pk_fma_f32 v[74:75], v[74:75], v[66:67], v[72:73] op_sel:[1,1,0] op_sel_hi:[0,1,1] neg_lo:[1,0,0]
v_cvt_pk_bf16_f32 v94, v44, v45
v_cvt_pk_bf16_f32 v95, v74, v75
ds_write_addtid_b32 v94 offset:12144
ds_write_addtid_b32 v95 offset:12400
ds_read2_b32 a[228:229], v228 offset0:80 offset1:81
v_pk_mul_f32 v[42:43], v[44:45], v[36:37] op_sel_hi:[1,0]
v_pk_mul_f32 v[72:73], v[74:75], v[66:67] op_sel_hi:[1,0]
v_pk_fma_f32 v[44:45], v[44:45], v[36:37], v[42:43] op_sel:[1,1,0] op_sel_hi:[0,1,1] neg_lo:[1,0,0]
v_pk_fma_f32 v[74:75], v[74:75], v[66:67], v[72:73] op_sel:[1,1,0] op_sel_hi:[0,1,1] neg_lo:[1,0,0]
v_cvt_pk_bf16_f32 v92, v44, v45
v_cvt_pk_bf16_f32 v93, v74, v75
ds_write_addtid_b32 v92 offset:12672
ds_write_addtid_b32 v93 offset:12928
ds_read2_b32 a[230:231], v228 offset0:82 offset1:83
v_pk_mul_f32 v[42:43], v[44:45], v[36:37] op_sel_hi:[1,0]
v_pk_mul_f32 v[72:73], v[74:75], v[66:67] op_sel_hi:[1,0]
v_pk_fma_f32 v[44:45], v[44:45], v[36:37], v[42:43] op_sel:[1,1,0] op_sel_hi:[0,1,1] neg_lo:[1,0,0]
v_pk_fma_f32 v[74:75], v[74:75], v[66:67], v[72:73] op_sel:[1,1,0] op_sel_hi:[0,1,1] neg_lo:[1,0,0]
v_cvt_pk_bf16_f32 v94, v44, v45
v_cvt_pk_bf16_f32 v95, v74, v75
ds_write_addtid_b32 v94 offset:13200
ds_write_addtid_b32 v95 offset:13456
ds_read2_b32 a[232:233], v228 offset0:64 offset1:65
v_pk_mul_f32 v[42:43], v[44:45], v[36:37] op_sel_hi:[1,0]
v_pk_mul_f32 v[72:73], v[74:75], v[66:67] op_sel_hi:[1,0]
v_pk_fma_f32 v[44:45], v[44:45], v[36:37], v[42:43] op_sel:[1,1,0] op_sel_hi:[0,1,1] neg_lo:[1,0,0]
v_pk_fma_f32 v[74:75], v[74:75], v[66:67], v[72:73] op_sel:[1,1,0] op_sel_hi:[0,1,1] neg_lo:[1,0,0]
v_cvt_pk_bf16_f32 v92, v44, v45
v_cvt_pk_bf16_f32 v93, v74, v75
ds_write_addtid_b32 v92 offset:13728
ds_write_addtid_b32 v93 offset:13984
ds_read2_b32 a[234:235], v228 offset0:66 offset1:67
v_pk_mul_f32 v[42:43], v[44:45], v[36:37] op_sel_hi:[1,0]
v_pk_mul_f32 v[72:73], v[74:75], v[66:67] op_sel_hi:[1,0]
v_pk_fma_f32 v[44:45], v[44:45], v[36:37], v[42:43] op_sel:[1,1,0] op_sel_hi:[0,1,1] neg_lo:[1,0,0]
v_pk_fma_f32 v[74:75], v[74:75], v[66:67], v[72:73] op_sel:[1,1,0] op_sel_hi:[0,1,1] neg_lo:[1,0,0]
v_cvt_pk_bf16_f32 v94, v44, v45
v_cvt_pk_bf16_f32 v95, v74, v75
ds_write_addtid_b32 v94 offset:14256
ds_write_addtid_b32 v95 offset:14512
ds_read2_b32 a[236:237], v228 offset0:48 offset1:49
v_pk_mul_f32 v[42:43], v[44:45], v[36:37] op_sel_hi:[1,0]
v_pk_mul_f32 v[72:73], v[74:75], v[66:67] op_sel_hi:[1,0]
v_pk_fma_f32 v[44:45], v[44:45], v[36:37], v[42:43] op_sel:[1,1,0] op_sel_hi:[0,1,1] neg_lo:[1,0,0]
v_pk_fma_f32 v[74:75], v[74:75], v[66:67], v[72:73] op_sel:[1,1,0] op_sel_hi:[0,1,1] neg_lo:[1,0,0]
v_cvt_pk_bf16_f32 v92, v44, v45
v_cvt_pk_bf16_f32 v93, v74, v75
ds_write_addtid_b32 v92 offset:14784
ds_write_addtid_b32 v93 offset:15040
ds_read2_b32 a[238:239], v228 offset0:50 offset1:51
v_pk_mul_f32 v[42:43], v[44:45], v[36:37] op_sel_hi:[1,0]
v_pk_mul_f32 v[72:73], v[74:75], v[66:67] op_sel_hi:[1,0]
v_pk_fma_f32 v[44:45], v[44:45], v[36:37], v[42:43] op_sel:[1,1,0] op_sel_hi:[0,1,1] neg_lo:[1,0,0]
v_pk_fma_f32 v[74:75], v[74:75], v[66:67], v[72:73] op_sel:[1,1,0] op_sel_hi:[0,1,1] neg_lo:[1,0,0]
v_cvt_pk_bf16_f32 v94, v44, v45
v_cvt_pk_bf16_f32 v95, v74, v75
ds_write_addtid_b32 v94 offset:15312
ds_write_addtid_b32 v95 offset:15568
ds_read2_b32 a[240:241], v228 offset0:32 offset1:33
v_pk_mul_f32 v[42:43], v[44:45], v[36:37] op_sel_hi:[1,0]
v_pk_mul_f32 v[72:73], v[74:75], v[66:67] op_sel_hi:[1,0]
v_pk_fma_f32 v[44:45], v[44:45], v[36:37], v[42:43] op_sel:[1,1,0] op_sel_hi:[0,1,1] neg_lo:[1,0,0]
v_pk_fma_f32 v[74:75], v[74:75], v[66:67], v[72:73] op_sel:[1,1,0] op_sel_hi:[0,1,1] neg_lo:[1,0,0]
v_cvt_pk_bf16_f32 v92, v44, v45
v_cvt_pk_bf16_f32 v93, v74, v75
ds_write_addtid_b32 v92 offset:15840
ds_write_addtid_b32 v93 offset:16096
ds_read2_b32 a[242:243], v228 offset0:34 offset1:35
v_pk_mul_f32 v[42:43], v[44:45], v[36:37] op_sel_hi:[1,0]
v_pk_mul_f32 v[72:73], v[74:75], v[66:67] op_sel_hi:[1,0]
v_pk_fma_f32 v[44:45], v[44:45], v[36:37], v[42:43] op_sel:[1,1,0] op_sel_hi:[0,1,1] neg_lo:[1,0,0]
v_pk_fma_f32 v[74:75], v[74:75], v[66:67], v[72:73] op_sel:[1,1,0] op_sel_hi:[0,1,1] neg_lo:[1,0,0]
v_cvt_pk_bf16_f32 v94, v44, v45
v_cvt_pk_bf16_f32 v95, v74, v75
ds_write_addtid_b32 v94 offset:16368
ds_write_addtid_b32 v95 offset:16624
ds_read2_b32 a[244:245], v228 offset0:16 offset1:17
ds_read_b128 a[16:19], v23 offset:0
ds_read_b128 a[20:23], v23 offset:32
ds_read_b128 a[24:27], v23 offset:64
ds_read_b128 a[28:31], v23 offset:96
ds_read_b128 a[32:35], v23 offset:128
ds_read_b128 a[36:39], v23 offset:160
ds_read_b128 a[40:43], v23 offset:192
ds_read_b128 a[44:47], v23 offset:224
v_pk_mul_f32 v[42:43], v[40:41], v[38:39] op_sel_hi:[1,0]
v_pk_mul_f32 v[72:73], v[70:71], v[68:69] op_sel_hi:[1,0]
v_pk_fma_f32 v[48:49], v[40:41], v[38:39], v[42:43] op_sel:[1,1,0] op_sel_hi:[0,1,1] neg_hi:[1,0,0]
v_pk_fma_f32 v[78:79], v[70:71], v[68:69], v[72:73] op_sel:[1,1,0] op_sel_hi:[0,1,1] neg_hi:[1,0,0]
ds_read_b128 a[48:51], v23 offset:256
ds_read_b128 a[52:55], v23 offset:288
ds_read_b128 a[56:59], v23 offset:320
ds_read_b128 a[60:63], v23 offset:352
ds_read_b128 a[64:67], v23 offset:384
ds_read_b128 a[68:71], v23 offset:416
ds_read_b128 a[72:75], v23 offset:448
ds_read_b128 a[76:79], v23 offset:480
v_cvt_pk_bf16_f32 v92, v40, v41
v_cvt_pk_bf16_f32 v93, v70, v71
ds_write_addtid_b32 v92 offset:0
ds_write_addtid_b32 v93 offset:256
ds_read2_b32 a[246:247], v228 offset0:18 offset1:19
v_cvt_pk_bf16_f32 v94, v48, v49
v_cvt_pk_bf16_f32 v95, v78, v79
ds_write_addtid_b32 v94 offset:4752
ds_write_addtid_b32 v95 offset:5008
ds_read2_b32 a[248:249], v228 offset0:0 offset1:1
v_pk_mul_f32 v[42:43], v[40:41], v[34:35] op_sel_hi:[1,0]
v_pk_mul_f32 v[72:73], v[70:71], v[64:65] op_sel_hi:[1,0]
v_pk_fma_f32 v[40:41], v[40:41], v[34:35], v[42:43] op_sel:[1,1,0] op_sel_hi:[0,1,1] neg_hi:[1,0,0]
v_pk_fma_f32 v[70:71], v[70:71], v[64:65], v[72:73] op_sel:[1,1,0] op_sel_hi:[0,1,1] neg_hi:[1,0,0]
v_cvt_pk_bf16_f32 v92, v40, v41
v_cvt_pk_bf16_f32 v93, v70, v71
ds_write_addtid_b32 v92 offset:528
ds_write_addtid_b32 v93 offset:784
ds_read2_b32 a[250:251], v228 offset0:2 offset1:3
v_pk_mul_f32 v[42:43], v[40:41], v[34:35] op_sel_hi:[1,0]
v_pk_mul_f32 v[72:73], v[70:71], v[64:65] op_sel_hi:[1,0]
v_pk_fma_f32 v[40:41], v[40:41], v[34:35], v[42:43] op_sel:[1,1,0] op_sel_hi:[0,1,1] neg_hi:[1,0,0]
v_pk_fma_f32 v[70:71], v[70:71], v[64:65], v[72:73] op_sel:[1,1,0] op_sel_hi:[0,1,1] neg_hi:[1,0,0]
v_cvt_pk_bf16_f32 v94, v40, v41
v_cvt_pk_bf16_f32 v95, v70, v71
ds_write_addtid_b32 v94 offset:1056
ds_write_addtid_b32 v95 offset:1312
s_waitcnt vmcnt(4)
s_nop 0
ds_read_b64_tr_b16 v[204:205], v197 offset:0
ds_read_b64_tr_b16 v[206:207], v198 offset:0
v_pk_mul_f32 v[42:43], v[40:41], v[38:39] op_sel_hi:[1,0]
v_pk_mul_f32 v[72:73], v[70:71], v[68:69] op_sel_hi:[1,0]
v_pk_fma_f32 v[48:49], v[40:41], v[38:39], v[42:43] op_sel:[1,1,0] op_sel_hi:[0,1,1] neg_hi:[1,0,0]
v_pk_fma_f32 v[78:79], v[70:71], v[68:69], v[72:73] op_sel:[1,1,0] op_sel_hi:[0,1,1] neg_hi:[1,0,0]
v_cvt_pk_bf16_f32 v92, v48, v49
v_cvt_pk_bf16_f32 v93, v78, v79
ds_write_addtid_b32 v92 offset:5280
ds_write_addtid_b32 v93 offset:5536
v_pk_mul_f32 v[42:43], v[40:41], v[34:35] op_sel_hi:[1,0]
v_pk_mul_f32 v[72:73], v[70:71], v[64:65] op_sel_hi:[1,0]
v_pk_fma_f32 v[40:41], v[40:41], v[34:35], v[42:43] op_sel:[1,1,0] op_sel_hi:[0,1,1] neg_hi:[1,0,0]
v_pk_fma_f32 v[70:71], v[70:71], v[64:65], v[72:73] op_sel:[1,1,0] op_sel_hi:[0,1,1] neg_hi:[1,0,0]
v_cvt_pk_bf16_f32 v94, v40, v41
v_cvt_pk_bf16_f32 v95, v70, v71
ds_write_addtid_b32 v94 offset:1584
ds_write_addtid_b32 v95 offset:1840
s_waitcnt lgkmcnt(4)
ds_write_b128 v199, v[204:207]
s_cmp_eq_u32 s85, 7
s_cselect_b32 s34, 0x400, 0
s_sub_u32 s34, 0x80, s34
s_add_u32 s85, s85, 1
v_add_u32 v199, s34, v199
v_pk_mul_f32 v[42:43], v[40:41], v[34:35] op_sel_hi:[1,0]
v_pk_mul_f32 v[72:73], v[70:71], v[64:65] op_sel_hi:[1,0]
v_pk_fma_f32 v[40:41], v[40:41], v[34:35], v[42:43] op_sel:[1,1,0] op_sel_hi:[0,1,1] neg_hi:[1,0,0]
v_pk_fma_f32 v[70:71], v[70:71], v[64:65], v[72:73] op_sel:[1,1,0] op_sel_hi:[0,1,1] neg_hi:[1,0,0]
v_cvt_pk_bf16_f32 v92, v40, v41
v_cvt_pk_bf16_f32 v93, v70, v71
ds_write_addtid_b32 v92 offset:2112
ds_write_addtid_b32 v93 offset:2368
v_pk_mul_f32 v[42:43], v[40:41], v[38:39] op_sel_hi:[1,0]
v_pk_mul_f32 v[72:73], v[70:71], v[68:69] op_sel_hi:[1,0]
v_pk_fma_f32 v[44:45], v[40:41], v[38:39], v[42:43] op_sel:[1,1,0] op_sel_hi:[0,1,1] neg_hi:[1,0,0]
v_pk_fma_f32 v[74:75], v[70:71], v[68:69], v[72:73] op_sel:[1,1,0] op_sel_hi:[0,1,1] neg_hi:[1,0,0]
v_cvt_pk_bf16_f32 v94, v44, v45
v_cvt_pk_bf16_f32 v95, v74, v75
ds_write_addtid_b32 v94 offset:5808
ds_write_addtid_b32 v95 offset:6064
s_add_u32 m0, s79, 1024
s_mul_i32 s34, s84, 73728
buffer_load_dwordx4 v196, s[16:19], s34 offen lds
s_mov_b32 m0, s78
s_add_u32 s84, s84, 1
s_and_b32 s84, s84, 7
s_nop 0
v_pk_mul_f32 v[42:43], v[40:41], v[34:35] op_sel_hi:[1,0]
v_pk_mul_f32 v[72:73], v[70:71], v[64:65] op_sel_hi:[1,0]
v_pk_fma_f32 v[40:41], v[40:41], v[34:35], v[42:43] op_sel:[1,1,0] op_sel_hi:[0,1,1] neg_hi:[1,0,0]
v_pk_fma_f32 v[70:71], v[70:71], v[64:65], v[72:73] op_sel:[1,1,0] op_sel_hi:[0,1,1] neg_hi:[1,0,0]
v_cvt_pk_bf16_f32 v92, v40, v41
v_cvt_pk_bf16_f32 v93, v70, v71
ds_write_addtid_b32 v92 offset:2640
ds_write_addtid_b32 v93 offset:2896
v_pk_mul_f32 v[42:43], v[40:41], v[34:35] op_sel_hi:[1,0]
v_pk_mul_f32 v[72:73], v[70:71], v[64:65] op_sel_hi:[1,0]
v_pk_fma_f32 v[40:41], v[40:41], v[34:35], v[42:43] op_sel:[1,1,0] op_sel_hi:[0,1,1] neg_hi:[1,0,0]
v_pk_fma_f32 v[70:71], v[70:71], v[64:65], v[72:73] op_sel:[1,1,0] op_sel_hi:[0,1,1] neg_hi:[1,0,0]
v_cvt_pk_bf16_f32 v94, v40, v41
v_cvt_pk_bf16_f32 v95, v70, v71
ds_write_addtid_b32 v94 offset:3168
ds_write_addtid_b32 v95 offset:3424
v_pk_mul_f32 v[42:43], v[40:41], v[38:39] op_sel_hi:[1,0]
v_pk_mul_f32 v[72:73], v[70:71], v[68:69] op_sel_hi:[1,0]
v_pk_fma_f32 v[48:49], v[40:41], v[38:39], v[42:43] op_sel:[1,1,0] op_sel_hi:[0,1,1] neg_hi:[1,0,0]
v_pk_fma_f32 v[78:79], v[70:71], v[68:69], v[72:73] op_sel:[1,1,0] op_sel_hi:[0,1,1] neg_hi:[1,0,0]
v_cvt_pk_bf16_f32 v92, v48, v49
v_cvt_pk_bf16_f32 v93, v78, v79
ds_write_addtid_b32 v92 offset:6336
ds_write_addtid_b32 v93 offset:6592
v_pk_mul_f32 v[42:43], v[40:41], v[34:35] op_sel_hi:[1,0]
v_pk_mul_f32 v[72:73], v[70:71], v[64:65] op_sel_hi:[1,0]
v_pk_fma_f32 v[40:41], v[40:41], v[34:35], v[42:43] op_sel:[1,1,0] op_sel_hi:[0,1,1] neg_hi:[1,0,0]
v_pk_fma_f32 v[70:71], v[70:71], v[64:65], v[72:73] op_sel:[1,1,0] op_sel_hi:[0,1,1] neg_hi:[1,0,0]
v_cvt_pk_bf16_f32 v94, v40, v41
v_cvt_pk_bf16_f32 v95, v70, v71
ds_write_addtid_b32 v94 offset:3696
ds_write_addtid_b32 v95 offset:3952
s_add_u32 m0, s79, 2048
s_mul_i32 s34, s84, 73728
buffer_load_dwordx4 v196, s[16:19], s34 offen lds
s_mov_b32 m0, s78
s_add_u32 s84, s84, 1
s_and_b32 s84, s84, 7
s_nop 0
v_pk_mul_f32 v[42:43], v[40:41], v[34:35] op_sel_hi:[1,0]
v_pk_mul_f32 v[72:73], v[70:71], v[64:65] op_sel_hi:[1,0]
v_pk_fma_f32 v[40:41], v[40:41], v[34:35], v[42:43] op_sel:[1,1,0] op_sel_hi:[0,1,1] neg_hi:[1,0,0]
v_pk_fma_f32 v[70:71], v[70:71], v[64:65], v[72:73] op_sel:[1,1,0] op_sel_hi:[0,1,1] neg_hi:[1,0,0]
v_cvt_pk_bf16_f32 v92, v40, v41
v_cvt_pk_bf16_f32 v93, v70, v71
ds_write_addtid_b32 v92 offset:4224
ds_write_addtid_b32 v93 offset:4480
v_pk_mul_f32 v[42:43], v[40:41], v[38:39] op_sel_hi:[1,0]
v_pk_mul_f32 v[72:73], v[70:71], v[68:69] op_sel_hi:[1,0]
v_pk_fma_f32 v[46:47], v[40:41], v[38:39], v[42:43] op_sel:[1,1,0] op_sel_hi:[0,1,1] neg_hi:[1,0,0]
v_pk_fma_f32 v[76:77], v[70:71], v[68:69], v[72:73] op_sel:[1,1,0] op_sel_hi:[0,1,1] neg_hi:[1,0,0]
v_cvt_pk_bf16_f32 v94, v46, v47
v_cvt_pk_bf16_f32 v95, v76, v77
ds_write_addtid_b32 v94 offset:6864
ds_write_addtid_b32 v95 offset:7120
v_pk_mul_f32 v[42:43], v[44:45], v[38:39] op_sel_hi:[1,0]
v_pk_mul_f32 v[72:73], v[74:75], v[68:69] op_sel_hi:[1,0]
v_pk_fma_f32 v[44:45], v[44:45], v[38:39], v[42:43] op_sel:[1,1,0] op_sel_hi:[0,1,1] neg_hi:[1,0,0]
v_pk_fma_f32 v[74:75], v[74:75], v[68:69], v[72:73] op_sel:[1,1,0] op_sel_hi:[0,1,1] neg_hi:[1,0,0]
v_cvt_pk_bf16_f32 v92, v44, v45
v_cvt_pk_bf16_f32 v93, v74, v75
ds_write_addtid_b32 v92 offset:7392
ds_write_addtid_b32 v93 offset:7648
v_pk_mul_f32 v[42:43], v[46:47], v[38:39] op_sel_hi:[1,0]
v_pk_mul_f32 v[72:73], v[76:77], v[68:69] op_sel_hi:[1,0]
v_pk_fma_f32 v[46:47], v[46:47], v[38:39], v[42:43] op_sel:[1,1,0] op_sel_hi:[0,1,1] neg_hi:[1,0,0]
v_pk_fma_f32 v[76:77], v[76:77], v[68:69], v[72:73] op_sel:[1,1,0] op_sel_hi:[0,1,1] neg_hi:[1,0,0]
v_cvt_pk_bf16_f32 v94, v46, v47
v_cvt_pk_bf16_f32 v95, v76, v77
ds_write_addtid_b32 v94 offset:7920
ds_write_addtid_b32 v95 offset:8176
s_add_u32 m0, s79, 3072
s_mul_i32 s34, s84, 73728
buffer_load_dwordx4 v196, s[16:19], s34 offen lds
s_mov_b32 m0, s78
s_add_u32 s84, s84, 1
s_and_b32 s84, s84, 7
s_nop 0
v_pk_mul_f32 v[42:43], v[44:45], v[38:39] op_sel_hi:[1,0]
v_pk_mul_f32 v[72:73], v[74:75], v[68:69] op_sel_hi:[1,0]
v_pk_fma_f32 v[44:45], v[44:45], v[38:39], v[42:43] op_sel:[1,1,0] op_sel_hi:[0,1,1] neg_hi:[1,0,0]
v_pk_fma_f32 v[74:75], v[74:75], v[68:69], v[72:73] op_sel:[1,1,0] op_sel_hi:[0,1,1] neg_hi:[1,0,0]
v_cvt_pk_bf16_f32 v92, v44, v45
v_cvt_pk_bf16_f32 v93, v74, v75
ds_write_addtid_b32 v92 offset:8448
ds_write_addtid_b32 v93 offset:8704
v_pk_mul_f32 v[42:43], v[46:47], v[38:39] op_sel_hi:[1,0]
v_pk_mul_f32 v[72:73], v[76:77], v[68:69] op_sel_hi:[1,0]
v_pk_fma_f32 v[46:47], v[46:47], v[38:39], v[42:43] op_sel:[1,1,0] op_sel_hi:[0,1,1] neg_hi:[1,0,0]
v_pk_fma_f32 v[76:77], v[76:77], v[68:69], v[72:73] op_sel:[1,1,0] op_sel_hi:[0,1,1] neg_hi:[1,0,0]
v_cvt_pk_bf16_f32 v94, v46, v47
v_cvt_pk_bf16_f32 v95, v76, v77
ds_write_addtid_b32 v94 offset:8976
ds_write_addtid_b32 v95 offset:9232
s_waitcnt vmcnt(2)
s_nop 0
ds_read_b64_tr_b16 v[204:205], v197 offset:1024
ds_read_b64_tr_b16 v[206:207], v198 offset:1024
v_pk_mul_f32 v[42:43], v[46:47], v[38:39] op_sel_hi:[1,0]
v_pk_mul_f32 v[72:73], v[76:77], v[68:69] op_sel_hi:[1,0]
v_pk_fma_f32 v[46:47], v[46:47], v[38:39], v[42:43] op_sel:[1,1,0] op_sel_hi:[0,1,1] neg_hi:[1,0,0]
v_pk_fma_f32 v[76:77], v[76:77], v[68:69], v[72:73] op_sel:[1,1,0] op_sel_hi:[0,1,1] neg_hi:[1,0,0]
v_cvt_pk_bf16_f32 v92, v46, v47
v_cvt_pk_bf16_f32 v93, v76, v77
ds_write_addtid_b32 v92 offset:9504
ds_write_addtid_b32 v93 offset:9760
v_pk_mul_f32 v[42:43], v[46:47], v[38:39] op_sel_hi:[1,0]
v_pk_mul_f32 v[72:73], v[76:77], v[68:69] op_sel_hi:[1,0]
v_pk_fma_f32 v[46:47], v[46:47], v[38:39], v[42:43] op_sel:[1,1,0] op_sel_hi:[0,1,1] neg_hi:[1,0,0]
v_pk_fma_f32 v[76:77], v[76:77], v[68:69], v[72:73] op_sel:[1,1,0] op_sel_hi:[0,1,1] neg_hi:[1,0,0]
v_cvt_pk_bf16_f32 v94, v46, v47
v_cvt_pk_bf16_f32 v95, v76, v77
ds_write_addtid_b32 v94 offset:10032
ds_write_addtid_b32 v95 offset:10288
s_add_u32 m0, s79, 4096
s_mul_i32 s34, s84, 73728
buffer_load_dwordx4 v196, s[16:19], s34 offen lds
s_mov_b32 m0, s78
s_add_u32 s84, s84, 1
s_and_b32 s84, s84, 7
s_waitcnt lgkmcnt(4)
ds_write_b128 v199, v[204:207]
s_cmp_eq_u32 s85, 7
s_cselect_b32 s34, 0x400, 0
s_sub_u32 s34, 0x80, s34
s_add_u32 s85, s85, 1
v_add_u32_e64 v199, s34, v199
v_pk_mul_f32 v[42:43], v[46:47], v[38:39] op_sel_hi:[1,0]
v_pk_mul_f32 v[72:73], v[76:77], v[68:69] op_sel_hi:[1,0]
v_pk_fma_f32 v[46:47], v[46:47], v[38:39], v[42:43] op_sel:[1,1,0] op_sel_hi:[0,1,1] neg_hi:[1,0,0]
v_pk_fma_f32 v[76:77], v[76:77], v[68:69], v[72:73] op_sel:[1,1,0] op_sel_hi:[0,1,1] neg_hi:[1,0,0]
v_cvt_pk_bf16_f32 v92, v46, v47
v_cvt_pk_bf16_f32 v93, v76, v77
ds_write_addtid_b32 v92 offset:10560
ds_write_addtid_b32 v93 offset:10816
v_pk_mul_f32 v[42:43], v[46:47], v[38:39] op_sel_hi:[1,0]
v_pk_mul_f32 v[72:73], v[76:77], v[68:69] op_sel_hi:[1,0]
v_pk_fma_f32 v[46:47], v[46:47], v[38:39], v[42:43] op_sel:[1,1,0] op_sel_hi:[0,1,1] neg_hi:[1,0,0]
v_pk_fma_f32 v[76:77], v[76:77], v[68:69], v[72:73] op_sel:[1,1,0] op_sel_hi:[0,1,1] neg_hi:[1,0,0]
v_cvt_pk_bf16_f32 v94, v46, v47
v_cvt_pk_bf16_f32 v95, v76, v77
ds_write_addtid_b32 v94 offset:11088
ds_write_addtid_b32 v95 offset:11344
ds_read_b128 a[80:83], v24 offset:0
ds_read_b128 a[84:87], v24 offset:32
ds_read_b128 a[88:91], v24 offset:64
ds_read_b128 a[92:95], v24 offset:96
s_mul_i32 s76, s68, 16896
s_add_u32 s76, s76, 0
v_lshl_add_u32 v25, v1, 4, s76
v_add_u32 v26, s76, v29
v_add_u32 v27, s76, v30
v_add_u32 v28, s76, v31
s_and_b32 s75, s73, 0xffff0000
s_waitcnt lgkmcnt(3)
v_mfma_f32_32x32x16_bf16 v[96:111], a[80:83], a[16:19], 0
ds_read_b128 a[96:99], v24 offset:128
s_lshl_b32 s34, s68, 1
s_add_u32 s34, s34, 0
s_waitcnt lgkmcnt(3)
v_mfma_f32_32x32x16_bf16 v[96:111], a[84:87], a[20:23], v[96:111]
ds_read_b128 a[100:103], v24 offset:160
s_mul_i32 s35, s34, 4160
s_mul_i32 s34, s34, 4640
s_waitcnt lgkmcnt(3)
v_mfma_f32_32x32x16_bf16 v[96:111], a[88:91], a[24:27], v[96:111]
ds_read_b128 a[104:107], v24 offset:192
v_add_u32 v232, s34, v116
v_add_u32 v233, s34, v117
s_waitcnt lgkmcnt(3)
v_mfma_f32_32x32x16_bf16 v[96:111], a[92:95], a[28:31], v[96:111]
ds_read_b128 a[108:111], v24 offset:224
v_add_u32 v234, s34, v118
v_add_u32 v235, s35, v119
s_waitcnt lgkmcnt(3)
v_mfma_f32_32x32x16_bf16 v[96:111], a[96:99], a[32:35], v[96:111]
ds_read_b128 a[112:115], v24 offset:256
s_mul_i32 s34, s68, 16896
v_add_u32 v236, s34, v112
s_waitcnt lgkmcnt(3)
v_mfma_f32_32x32x16_bf16 v[96:111], a[100:103], a[36:39], v[96:111]
ds_read_b128 a[116:119], v24 offset:288
v_add_u32 v237, s34, v113
s_waitcnt lgkmcnt(3)
v_mfma_f32_32x32x16_bf16 v[96:111], a[104:107], a[40:43], v[96:111]
ds_read_b128 a[120:123], v24 offset:320
v_add_u32 v238, s34, v114
s_waitcnt lgkmcnt(3)
v_mfma_f32_32x32x16_bf16 v[96:111], a[108:111], a[44:47], v[96:111]
ds_read_b128 a[124:127], v24 offset:352
v_add_u32 v239, s34, v115
s_waitcnt lgkmcnt(3)
v_mfma_f32_32x32x16_bf16 v[96:111], a[112:115], a[48:51], v[96:111]
ds_read_b128 a[128:131], v24 offset:384
s_lshl_b32 s34, s68, 1
s_waitcnt lgkmcnt(3)
v_mfma_f32_32x32x16_bf16 v[96:111], a[116:119], a[52:55], v[96:111]
ds_read_b128 a[132:135], v24 offset:416
s_add_u32 s34, s34, 1
s_waitcnt lgkmcnt(3)
v_mfma_f32_32x32x16_bf16 v[96:111], a[120:123], a[56:59], v[96:111]
ds_read_b128 a[136:139], v24 offset:448
s_mul_i32 s35, s34, 4160
s_waitcnt lgkmcnt(3)
v_mfma_f32_32x32x16_bf16 v[96:111], a[124:127], a[60:63], v[96:111]
ds_read_b128 a[140:143], v24 offset:480
s_mul_i32 s34, s34, 4640
s_waitcnt lgkmcnt(3)
v_mfma_f32_32x32x16_bf16 v[96:111], a[128:131], a[64:67], v[96:111]
ds_write_b128 v25, v[192:195] offset:0
v_add_u32 v240, s34, v116
s_waitcnt lgkmcnt(3)
v_mfma_f32_32x32x16_bf16 v[96:111], a[132:135], a[68:71], v[96:111]
ds_write_b128 v25, v[192:195] offset:1024
v_add_u32 v241, s34, v117
s_waitcnt lgkmcnt(3)
v_mfma_f32_32x32x16_bf16 v[96:111], a[136:139], a[72:75], v[96:111]
ds_write_b128 v25, v[192:195] offset:2048
v_add_u32 v242, s34, v118
s_waitcnt lgkmcnt(3)
v_mfma_f32_32x32x16_bf16 v[96:111], a[140:143], a[76:79], v[96:111]
v_add_u32 v243, s35, v119
s_add_u32 m0, s79, 5120
s_mul_i32 s34, s84, 73728
buffer_load_dwordx4 v196, s[16:19], s34 offen lds
s_mov_b32 m0, s78
s_add_u32 s84, s84, 1
s_and_b32 s84, s84, 7
s_waitcnt vmcnt(3)
ds_read_b64_tr_b16 v[204:205], v197 offset:2048
ds_read_b64_tr_b16 v[206:207], v198 offset:2048
s_mov_b32 exec_hi, 0xff
ds_write_b128 v25, v[192:195] offset:3072
s_mov_b64 exec, 1
v_add_f32 v96, s75, v96
s_mov_b64 exec, -1
s_nop 0
v_cvt_pk_bf16_f32 v120, v99, v98
v_cvt_pk_bf16_f32 v121, v97, v96
v_cvt_pk_bf16_f32 v122, v100, v99
v_cvt_pk_bf16_f32 v123, v98, v97
ds_write_b64 v26, v[120:121] offset:1728
ds_write_b64 v26, v[122:123] offset:512
v_cvt_pk_bf16_f32 v124, v103, v102
v_cvt_pk_bf16_f32 v125, v101, v101
v_cvt_pk_bf16_f32 v126, v103, v103
v_cvt_pk_bf16_f32 v127, v102, v101
ds_write_b64 v26, v[124:125] offset:1216
ds_write_b64 v26, v[126:127] offset:0
v_cvt_pk_bf16_f32 v128, v104, v105
v_cvt_pk_bf16_f32 v129, v106, v107
ds_write_b16 v27, v128 offset:2688
ds_write_b16_d16_hi v27, v128 offset:2432
ds_write_b16 v28, v129 offset:2976
ds_write_b16 v28, v129 offset:3166
ds_write_b16_d16_hi v28, v129 offset:2944
ds_write_b16_d16_hi v28, v129 offset:3134
v_and_b32 v130, 0xffff0000, v126
v_mov_b32 v131, v126
v_lshrrev_b32 v132, 16, v121
v_mov_b32 v133, s76
s_mov_b32 exec_lo, 0
s_mov_b32 exec_hi, 0x80000000
ds_write_b32 v133, v126 offset:60
ds_write_b64 v133, v[130:131] offset:1272
s_mov_b64 exec, 1
ds_write_b32 v133, v132 offset:1088
s_mov_b64 exec, -1
v_readlane_b32 s83, v128, 63
s_add_u32 m0, s79, 6144
s_mul_i32 s34, s84, 73728
buffer_load_dwordx4 v196, s[16:19], s34 offen lds
s_mov_b32 m0, s78
s_add_u32 s84, s84, 1
s_and_b32 s84, s84, 7
s_waitcnt lgkmcnt(14)
ds_write_b128 v199, v[204:207]
s_cmp_eq_u32 s85, 7
s_cselect_b32 s34, 0x400, 0
s_sub_u32 s34, 0x80, s34
s_add_u32 s85, s85, 1
v_add_u32 v199, s34, v199
s_waitcnt vmcnt(3)
ds_read_b64_tr_b16 v[204:205], v197 offset:3072
ds_read_b64_tr_b16 v[206:207], v198 offset:3072
ds_read2_b32 a[16:17], v237 offset0:0 offset1:1
ds_read2_b32 a[18:19], v237 offset0:2 offset1:3
ds_read2_b32 a[20:21], v236 offset0:240 offset1:241
ds_read2_b32 a[22:23], v236 offset0:242 offset1:243
ds_read2_b32 a[24:25], v236 offset0:224 offset1:225
ds_read2_b32 a[26:27], v236 offset0:226 offset1:227
s_add_u32 m0, s79, 7168
s_mul_i32 s34, s84, 73728
buffer_load_dwordx4 v196, s[16:19], s34 offen lds
s_mov_b32 m0, s78
s_add_u32 s84, s84, 1
s_and_b32 s84, s84, 7
s_waitcnt lgkmcnt(6)
ds_write_b128 v199, v[204:207]
s_cmp_eq_u32 s85, 7
s_cselect_b32 s34, 0x400, 0
s_sub_u32 s34, 0x80, s34
s_add_u32 s85, s85, 1
v_add_u32_e64 v199, s34, v199
ds_read2_b32 a[28:29], v236 offset0:208 offset1:209
ds_read2_b32 a[30:31], v236 offset0:210 offset1:211
ds_read2_b32 a[32:33], v236 offset0:192 offset1:193
s_waitcnt vmcnt(3)
s_nop 0
ds_read_b64_tr_b16 v[204:205], v197 offset:4096
ds_read_b64_tr_b16 v[206:207], v198 offset:4096
ds_read2_b32 a[34:35], v236 offset0:194 offset1:195
ds_read2_b32 a[36:37], v236 offset0:176 offset1:177
ds_read2_b32 a[38:39], v236 offset0:178 offset1:179
ds_read2_b32 a[40:41], v236 offset0:160 offset1:161
ds_read2_b32 a[42:43], v236 offset0:162 offset1:163
ds_read2_b32 a[44:45], v236 offset0:144 offset1:145
s_waitcnt lgkmcnt(6)
ds_write_b128 v199, v[204:207]
s_cmp_eq_u32 s85, 7
s_cselect_b32 s34, 0x400, 0
s_sub_u32 s34, 0x80, s34
s_add_u32 s85, s85, 1
v_add_u32 v199, s34, v199
ds_read2_b32 a[46:47], v236 offset0:146 offset1:147
ds_read2_b32 a[48:49], v236 offset0:128 offset1:129
ds_read2_b32 a[50:51], v236 offset0:130 offset1:131
s_waitcnt vmcnt(2)
s_nop 0
ds_read_b64_tr_b16 v[204:205], v197 offset:5120
ds_read_b64_tr_b16 v[206:207], v198 offset:5120
ds_read2_b32 a[52:53], v236 offset0:112 offset1:113
ds_read2_b32 a[54:55], v236 offset0:114 offset1:115
ds_read2_b32 a[56:57], v236 offset0:96 offset1:97
ds_read2_b32 a[58:59], v236 offset0:98 offset1:99
ds_read2_b32 a[60:61], v236 offset0:80 offset1:81
ds_read2_b32 a[62:63], v236 offset0:82 offset1:83
s_waitcnt lgkmcnt(6)
ds_write_b128 v199, v[204:207]
s_cmp_eq_u32 s85, 7
s_cselect_b32 s34, 0x400, 0
s_sub_u32 s34, 0x80, s34
s_add_u32 s85, s85, 1
v_add_u32 v199, s34, v199
ds_read2_b32 a[64:65], v236 offset0:64 offset1:65
ds_read2_b32 a[66:67], v236 offset0:66 offset1:67
ds_read2_b32 a[68:69], v236 offset0:48 offset1:49
s_waitcnt vmcnt(1)
s_nop 0
ds_read_b64_tr_b16 v[204:205], v197 offset:6144
ds_read_b64_tr_b16 v[206:207], v198 offset:6144
ds_read2_b32 a[70:71], v236 offset0:50 offset1:51
ds_read2_b32 a[72:73], v236 offset0:32 offset1:33
ds_read2_b32 a[74:75], v236 offset0:34 offset1:35
ds_read2_b32 a[76:77], v236 offset0:16 offset1:17
ds_read2_b32 a[78:79], v236 offset0:18 offset1:19
s_waitcnt lgkmcnt(5)
ds_write_b128 v199, v[204:207]
s_cmp_eq_u32 s85, 7
s_cselect_b32 s34, 0x400, 0
s_sub_u32 s34, 0x80, s34
s_add_u32 s85, s85, 1
v_add_u32 v199, s34, v199
ds_read2_b32 a[80:81], v236 offset0:0 offset1:1
ds_read2_b32 a[82:83], v236 offset0:2 offset1:3
s_waitcnt vmcnt(0)
ds_read_b64_tr_b16 v[204:205], v197 offset:7168
ds_read_b64_tr_b16 v[206:207], v198 offset:7168
s_waitcnt lgkmcnt(0)
ds_write_b128 v199, v[204:207]
s_cmp_eq_u32 s85, 7
s_cselect_b32 s34, 0x400, 0
s_sub_u32 s34, 0x80, s34
s_add_u32 s85, s85, 1
v_add_u32 v199, s34, v199
s_lshl_b32 s34, s69, 2
s_add_u32 s34, s34, s68
s_add_u32 s34, s34, 64
s_cmp_ge_u32 s34, 81
s_cbranch_scc1 L_FP38710
s_mul_i32 s35, s34, 7282
s_lshr_b32 s35, s35, 16
s_mul_i32 s35, s35, 1719
s_add_u32 s35, s35, s34
s_lshl_b32 s35, s35, 7
buffer_load_dword v252, v244, s[12:15], s35 offen
s_branch L_FQ38710
L_FP38710:
s_sub_u32 s35, s34, 81
s_lshl_b32 s35, s35, 13
buffer_load_dword v252, v245, s[24:27], s35 offen
L_FQ38710:
s_waitcnt lgkmcnt(0)
s_barrier
s_cmp_lg_u32 s68, 0
s_cbranch_scc1 L_A_NOSIG
v_mov_b32 v220, 1
v_mov_b32 v221, 0
s_mov_b64 exec, 1
buffer_atomic_add v220, v221, s[8:11], 0 offen offset:128 sc1
s_mov_b64 exec, -1
L_A_NOSIG:
ds_read_b128 a[140:143], v232 offset:0
ds_read_b128 a[144:147], v232 offset:64
ds_read_b128 a[148:151], v232 offset:128
ds_read_b128 a[160:163], v240 offset:0
ds_read_b128 a[164:167], v240 offset:64
ds_read_b128 a[168:171], v240 offset:128
s_waitcnt lgkmcnt(5)
v_mfma_f32_16x16x32_bf16 v[120:123], a[212:215], a[140:143], 0
ds_read_b128 a[152:155], v232 offset:192
v_mfma_f32_16x16x32_bf16 v[124:127], a[244:247], a[140:143], 0
ds_read_b128 a[172:175], v240 offset:192
s_waitcnt lgkmcnt(4)
v_mfma_f32_16x16x32_bf16 v[88:91], a[44:47], a[160:163], 0
ds_read_b128 a[156:159], v232 offset:256
v_mfma_f32_16x16x32_bf16 v[92:95], a[76:79], a[160:163], 0
ds_read_b128 a[176:179], v240 offset:256
v_mfma_f32_16x16x32_bf16 v[120:123], a[208:211], a[144:147], v[120:123]
ds_read_b128 a[140:143], v232 offset:320
v_mfma_f32_16x16x32_bf16 v[124:127], a[240:243], a[144:147], v[124:127]
ds_read_b128 a[160:163], v240 offset:320
s_waitcnt lgkmcnt(7)
v_mfma_f32_16x16x32_bf16 v[88:91], a[40:43], a[164:167], v[88:91]
ds_read_b128 a[144:147], v232 offset:384
v_mfma_f32_16x16x32_bf16 v[92:95], a[72:75], a[164:167], v[92:95]
v_mfma_f32_16x16x32_bf16 v[120:123], a[204:207], a[148:151], v[120:123]
ds_read_b128 a[164:167], v240 offset:384
v_mfma_f32_16x16x32_bf16 v[124:127], a[236:239], a[148:151], v[124:127]
s_waitcnt lgkmcnt(8)
v_mfma_f32_16x16x32_bf16 v[88:91], a[36:39], a[168:171], v[88:91]
ds_read_b128 a[148:151], v232 offset:448
v_mfma_f32_16x16x32_bf16 v[92:95], a[68:71], a[168:171], v[92:95]
s_waitcnt lgkmcnt(8)
v_mfma_f32_16x16x32_bf16 v[120:123], a[200:203], a[152:155], v[120:123]
ds_read_b128 a[168:171], v240 offset:448
v_mfma_f32_16x16x32_bf16 v[124:127], a[232:235], a[152:155], v[124:127]
s_waitcnt lgkmcnt(8)
v_mfma_f32_16x16x32_bf16 v[88:91], a[32:35], a[172:175], v[88:91]
ds_read_b128 a[152:155], v232 offset:512
v_mfma_f32_16x16x32_bf16 v[92:95], a[64:67], a[172:175], v[92:95]
s_lshr_b32 s34, s82, 16
s_and_b32 s35, s82, 0xffff0000
s_or_b32 s34, s34, s35
v_and_b32 v184, s34, v18
v_and_b32 v185, s34, v19
v_and_b32 v186, s34, v20
v_and_b32 v187, s34, v21
s_lshr_b32 s34, s83, 16
s_and_b32 s35, s83, 0xffff0000
s_or_b32 s34, s34, s35
v_and_b32 v220, s34, v18
v_and_b32 v221, s34, v19
v_and_b32 v222, s34, v20
v_and_b32 v223, s34, v21
s_waitcnt lgkmcnt(8)
v_mfma_f32_16x16x32_bf16 v[120:123], a[196:199], a[156:159], v[120:123]
ds_read_b128 a[172:175], v240 offset:512
v_mfma_f32_16x16x32_bf16 v[124:127], a[228:231], a[156:159], v[124:127]
ds_read2_b32 a[84:85], v230 offset0:32 offset1:33
s_waitcnt lgkmcnt(9)
v_mfma_f32_16x16x32_bf16 v[88:91], a[28:31], a[176:179], v[88:91]
ds_read_b128 a[156:159], v232 offset:576
v_mfma_f32_16x16x32_bf16 v[92:95], a[60:63], a[176:179], v[92:95]
ds_read2_b32 a[86:87], v230 offset0:40 offset1:41
s_waitcnt lgkmcnt(10)
v_mfma_f32_16x16x32_bf16 v[120:123], a[192:195], a[140:143], v[120:123]
ds_read_b128 a[176:179], v240 offset:576
v_mfma_f32_16x16x32_bf16 v[124:127], a[224:227], a[140:143], v[124:127]
ds_read2_b32 a[88:89], v230 offset0:16 offset1:17
s_waitcnt lgkmcnt(11)
v_mfma_f32_16x16x32_bf16 v[88:91], a[24:27], a[160:163], v[88:91]
ds_read_b128 a[140:143], v232 offset:640
v_mfma_f32_16x16x32_bf16 v[92:95], a[56:59], a[160:163], v[92:95]
ds_read2_b32 a[90:91], v230 offset0:24 offset1:25
s_waitcnt lgkmcnt(12)
v_mfma_f32_16x16x32_bf16 v[120:123], a[188:191], a[144:147], v[120:123]
ds_read_b128 v[212:215], v233 offset:0
v_mfma_f32_16x16x32_bf16 v[124:127], a[220:223], a[144:147], v[124:127]
ds_read_b128 v[216:219], v233 offset:256
s_waitcnt lgkmcnt(13)
v_mfma_f32_16x16x32_bf16 v[88:91], a[20:23], a[164:167], v[88:91]
ds_read_b128 a[160:163], v240 offset:640
v_mfma_f32_16x16x32_bf16 v[92:95], a[52:55], a[164:167], v[92:95]
ds_read_b128 a[144:147], v232 offset:704
s_waitcnt lgkmcnt(14)
v_mfma_f32_16x16x32_bf16 v[120:123], a[184:187], a[148:151], v[120:123]
ds_read_b128 a[164:167], v240 offset:704
v_mfma_f32_16x16x32_bf16 v[124:127], a[216:219], a[148:151], v[124:127]
ds_read2_b32 a[92:93], v230 offset0:0 offset1:1
v_mfma_f32_16x16x32_bf16 v[128:131], a[248:251], a[148:151], 0
ds_read2_b32 a[94:95], v230 offset0:8 offset1:9
v_mfma_f32_16x16x32_bf16 v[136:139], v[184:187], a[148:151], 0
ds_read2_b32 a[96:97], v230 offset0:96 offset1:97
s_waitcnt lgkmcnt(15)
v_mfma_f32_16x16x32_bf16 v[88:91], a[16:19], a[168:171], v[88:91]
ds_read_b128 a[148:151], v232 offset:768
v_mfma_f32_16x16x32_bf16 v[92:95], a[48:51], a[168:171], v[92:95]
ds_read2_b32 a[98:99], v230 offset0:104 offset1:105
v_mfma_f32_16x16x32_bf16 v[96:99], a[80:83], a[168:171], 0
ds_read2_b32 a[100:101], v230 offset0:80 offset1:81
v_mfma_f32_16x16x32_bf16 v[104:107], v[220:223], a[168:171], 0
ds_read2_b32 a[102:103], v230 offset0:88 offset1:89
v_mfma_f32_16x16x32_bf16 v[124:127], a[212:215], a[152:155], v[124:127]
ds_read_b128 a[168:171], v240 offset:768
v_mfma_f32_16x16x32_bf16 v[128:131], a[244:247], a[152:155], v[128:131]
ds_read2_b32 a[104:105], v230 offset0:64 offset1:65
v_mfma_f32_16x16x32_bf16 v[92:95], a[44:47], a[172:175], v[92:95]
v_cvt_pk_bf16_f32 v188, v120, v121
v_cvt_pk_bf16_f32 v189, v122, v123
v_mfma_f32_16x16x32_bf16 v[96:99], a[76:79], a[172:175], v[96:99]
ds_write_b64 v235, v[188:189] offset:0
s_waitcnt lgkmcnt(15)
v_mfma_f32_16x16x32_bf16 v[124:127], a[208:211], a[156:159], v[124:127]
v_cvt_pk_bf16_f32 v190, v88, v89
v_cvt_pk_bf16_f32 v191, v90, v91
v_mfma_f32_16x16x32_bf16 v[128:131], a[240:243], a[156:159], v[128:131]
ds_write_b64 v243, v[190:191] offset:0
v_mfma_f32_16x16x32_bf16 v[92:95], a[40:43], a[176:179], v[92:95]
ds_read_b128 a[152:155], v232 offset:832
v_mfma_f32_16x16x32_bf16 v[96:99], a[72:75], a[176:179], v[96:99]
ds_read2_b32 a[106:107], v230 offset0:72 offset1:73
v_mfma_f32_16x16x32_bf16 v[124:127], a[204:207], a[140:143], v[124:127]
ds_read_b128 a[180:183], v241 offset:0
v_mfma_f32_16x16x32_bf16 v[128:131], a[236:239], a[140:143], v[128:131]
ds_read_b128 a[252:255], v241 offset:256
s_waitcnt lgkmcnt(15)
v_mfma_f32_16x16x32_bf16 v[152:155], v[212:215], a[0:3], 0
ds_read_b128 a[172:175], v240 offset:832
v_mfma_f32_16x16x32_bf16 v[156:159], v[216:219], a[0:3], 0
ds_read_b128 a[156:159], v232 offset:896
v_mfma_f32_16x16x32_bf16 v[160:163], v[212:215], a[4:7], 0
ds_read_b128 a[176:179], v240 offset:896
v_mfma_f32_16x16x32_bf16 v[164:167], v[216:219], a[4:7], 0
ds_read_b128 a[140:143], v232 offset:960
v_mfma_f32_16x16x32_bf16 v[92:95], a[36:39], a[160:163], v[92:95]
ds_read2_b32 v[32:33], v238 offset0:32 offset1:33
v_mfma_f32_16x16x32_bf16 v[96:99], a[68:71], a[160:163], v[96:99]
ds_read2_b32 v[34:35], v238 offset0:40 offset1:41
v_mfma_f32_16x16x32_bf16 v[124:127], a[200:203], a[144:147], v[124:127]
v_cvt_pk_bf16_f32 v168, v152, v153
v_cvt_pk_bf16_f32 v169, v154, v155
v_mfma_f32_16x16x32_bf16 v[128:131], a[232:235], a[144:147], v[128:131]
v_cvt_pk_bf16_f32 v170, v156, v157
v_cvt_pk_bf16_f32 v171, v158, v159
v_mfma_f32_16x16x32_bf16 v[92:95], a[32:35], a[164:167], v[92:95]
v_cvt_pk_bf16_f32 v172, v160, v161
v_cvt_pk_bf16_f32 v173, v162, v163
v_mfma_f32_16x16x32_bf16 v[96:99], a[64:67], a[164:167], v[96:99]
v_cvt_pk_bf16_f32 v174, v164, v165
v_cvt_pk_bf16_f32 v175, v166, v167
s_waitcnt lgkmcnt(15)
v_mfma_f32_16x16x32_bf16 v[124:127], a[196:199], a[148:151], v[124:127]
s_waitcnt lgkmcnt(10)
s_barrier
ds_read_b64_tr_b16 v[204:205], v200 offset:0
ds_read_b64_tr_b16 v[206:207], v200 offset:16640
v_mfma_f32_16x16x32_bf16 v[128:131], a[228:231], a[148:151], v[128:131]
ds_read2_b32 v[36:37], v238 offset0:16 offset1:17
v_mfma_f32_16x16x32_bf16 v[128:131], v[168:171], a[84:87], v[128:131]
ds_read2_b32 v[38:39], v238 offset0:24 offset1:25
v_mfma_f32_16x16x32_bf16 v[132:135], v[168:171], a[88:91], 0
ds_read2_b32 v[40:41], v238 offset0:0 offset1:1
v_mfma_f32_16x16x32_bf16 v[136:139], v[168:171], a[92:95], v[136:139]
ds_read2_b32 v[42:43], v238 offset0:8 offset1:9
v_mfma_f32_16x16x32_bf16 v[128:131], v[172:175], a[96:99], v[128:131]
ds_read_b128 v[212:215], v233 offset:512
v_mfma_f32_16x16x32_bf16 v[132:135], v[172:175], a[100:103], v[132:135]
ds_read_b128 v[216:219], v233 offset:768
s_waitcnt lgkmcnt(15)
v_mfma_f32_16x16x32_bf16 v[136:139], v[172:175], a[104:107], v[136:139]
ds_read_b128 a[160:163], v240 offset:960
v_mfma_f32_16x16x32_bf16 v[92:95], a[28:31], a[168:171], v[92:95]
ds_read2_b32 v[44:45], v238 offset0:96 offset1:97
v_mfma_f32_16x16x32_bf16 v[96:99], a[60:63], a[168:171], v[96:99]
ds_read2_b32 v[46:47], v238 offset0:104 offset1:105
v_mfma_f32_16x16x32_bf16 v[152:155], a[180:183], a[0:3], 0
ds_read2_b32 v[48:49], v238 offset0:80 offset1:81
s_waitcnt lgkmcnt(15)
v_mfma_f32_16x16x32_bf16 v[156:159], a[252:255], a[0:3], 0
ds_read2_b32 v[50:51], v238 offset0:88 offset1:89
v_mfma_f32_16x16x32_bf16 v[124:127], a[192:195], a[152:155], v[124:127]
ds_read2_b32 v[52:53], v238 offset0:64 offset1:65
v_mfma_f32_16x16x32_bf16 v[128:131], a[224:227], a[152:155], v[128:131]
ds_read2_b32 v[54:55], v238 offset0:72 offset1:73
v_mfma_f32_16x16x32_bf16 v[160:163], a[180:183], a[4:7], 0
ds_read_b128 a[144:147], v232 offset:1024
v_mfma_f32_16x16x32_bf16 v[164:167], a[252:255], a[4:7], 0
s_mov_b32 s74, 0
s_waitcnt lgkmcnt(14)
buffer_store_dwordx4 v[204:207], v201, s[20:23], s74 offen
v_mfma_f32_16x16x32_bf16 v[92:95], a[24:27], a[172:175], v[92:95]
ds_read_b128 a[164:167], v240 offset:1024
v_cvt_pk_bf16_f32 v176, v152, v153
v_mfma_f32_16x16x32_bf16 v[96:99], a[56:59], a[172:175], v[96:99]
v_cvt_pk_bf16_f32 v177, v154, v155
v_cvt_pk_bf16_f32 v178, v156, v157
v_mfma_f32_16x16x32_bf16 v[124:127], a[188:191], a[156:159], v[124:127]
v_cvt_pk_bf16_f32 v179, v158, v159
ds_read_b128 a[148:151], v232 offset:1088
v_mfma_f32_16x16x32_bf16 v[128:131], a[220:223], a[156:159], v[128:131]
v_cvt_pk_bf16_f32 v180, v160, v161
v_cvt_pk_bf16_f32 v181, v162, v163
v_mfma_f32_16x16x32_bf16 v[92:95], a[20:23], a[176:179], v[92:95]
v_cvt_pk_bf16_f32 v182, v164, v165
v_cvt_pk_bf16_f32 v183, v166, v167
v_mfma_f32_16x16x32_bf16 v[96:99], a[52:55], a[176:179], v[96:99]
ds_read_b128 a[168:171], v240 offset:1088
v_mfma_f32_16x16x32_bf16 v[96:99], v[176:179], v[32:35], v[96:99]
ds_read_b128 a[152:155], v232 offset:1152
s_waitcnt lgkmcnt(15)
v_mfma_f32_16x16x32_bf16 v[100:103], v[176:179], v[36:39], 0
ds_read_b128 a[180:183], v241 offset:512
s_waitcnt lgkmcnt(15)
v_mfma_f32_16x16x32_bf16 v[104:107], v[176:179], v[40:43], v[104:107]
ds_read_b128 a[252:255], v241 offset:768
v_mfma_f32_16x16x32_bf16 v[124:127], a[184:187], a[140:143], v[124:127]
ds_read_b128 a[172:175], v240 offset:1152
v_mfma_f32_16x16x32_bf16 v[128:131], a[216:219], a[140:143], v[128:131]
ds_read_b128 a[156:159], v232 offset:1216
v_mfma_f32_16x16x32_bf16 v[132:135], a[248:251], a[140:143], v[132:135]
ds_read_b128 a[176:179], v240 offset:1216
v_mfma_f32_16x16x32_bf16 v[140:143], v[184:187], a[140:143], 0
ds_read2_b32 a[108:109], v231 offset0:24 offset1:25
s_waitcnt lgkmcnt(15)
v_mfma_f32_16x16x32_bf16 v[152:155], v[212:215], a[0:3], 0
ds_read2_b32 a[110:111], v231 offset0:32 offset1:33
v_mfma_f32_16x16x32_bf16 v[156:159], v[216:219], a[0:3], 0
ds_read2_b32 a[112:113], v231 offset0:16 offset1:17
v_mfma_f32_16x16x32_bf16 v[96:99], v[180:183], v[44:47], v[96:99]
ds_read2_b32 a[114:115], v231 offset0:24 offset1:25
s_waitcnt lgkmcnt(15)
v_mfma_f32_16x16x32_bf16 v[100:103], v[180:183], v[48:51], v[100:103]
ds_read2_b32 a[116:117], v231 offset0:8 offset1:9
s_waitcnt lgkmcnt(15)
v_mfma_f32_16x16x32_bf16 v[104:107], v[180:183], v[52:55], v[104:107]
ds_read2_b32 a[118:119], v231 offset0:16 offset1:17
v_mfma_f32_16x16x32_bf16 v[160:163], v[212:215], a[4:7], 0
ds_read_b128 a[140:143], v232 offset:1280
v_mfma_f32_16x16x32_bf16 v[164:167], v[216:219], a[4:7], 0
ds_read2_b32 a[120:121], v231 offset0:0 offset1:1
v_mfma_f32_16x16x32_bf16 v[92:95], a[16:19], a[160:163], v[92:95]
ds_read2_b32 a[122:123], v231 offset0:8 offset1:9
v_mfma_f32_16x16x32_bf16 v[96:99], a[48:51], a[160:163], v[96:99]
ds_read2_b32 v[56:57], v239 offset0:24 offset1:25
v_mfma_f32_16x16x32_bf16 v[100:103], a[80:83], a[160:163], v[100:103]
ds_read2_b32 v[58:59], v239 offset0:32 offset1:33
v_mfma_f32_16x16x32_bf16 v[108:111], v[220:223], a[160:163], 0
ds_read2_b32 v[60:61], v239 offset0:16 offset1:17
s_waitcnt lgkmcnt(15)
v_mfma_f32_16x16x32_bf16 v[128:131], a[212:215], a[144:147], v[128:131]
v_cvt_pk_bf16_f32 v168, v152, v153
v_cvt_pk_bf16_f32 v169, v154, v155
v_mfma_f32_16x16x32_bf16 v[132:135], a[244:247], a[144:147], v[132:135]
v_cvt_pk_bf16_f32 v170, v156, v157
v_cvt_pk_bf16_f32 v171, v158, v159
v_mfma_f32_16x16x32_bf16 v[96:99], a[44:47], a[164:167], v[96:99]
v_cvt_pk_bf16_f32 v172, v160, v161
v_cvt_pk_bf16_f32 v173, v162, v163
v_mfma_f32_16x16x32_bf16 v[100:103], a[76:79], a[164:167], v[100:103]
v_cvt_pk_bf16_f32 v174, v164, v165
v_cvt_pk_bf16_f32 v175, v166, v167
v_mfma_f32_16x16x32_bf16 v[128:131], a[208:211], a[148:151], v[128:131]
v_cvt_pk_bf16_f32 v188, v124, v125
v_cvt_pk_bf16_f32 v189, v126, v127
v_mfma_f32_16x16x32_bf16 v[132:135], a[240:243], a[148:151], v[132:135]
ds_write_b64 v235, v[188:189] offset:512
v_mfma_f32_16x16x32_bf16 v[132:135], v[168:171], a[84:87], v[132:135]
ds_read_b128 v[212:215], v234 offset:0
v_cvt_pk_bf16_f32 v190, v92, v93
v_mfma_f32_16x16x32_bf16 v[136:139], v[168:171], a[88:91], v[136:139]
ds_read_b128 v[216:219], v234 offset:512
v_cvt_pk_bf16_f32 v191, v94, v95
v_mfma_f32_16x16x32_bf16 v[140:143], v[168:171], a[92:95], v[140:143]
ds_read_b128 a[160:163], v240 offset:1280
v_mfma_f32_16x16x32_bf16 v[132:135], v[172:175], a[96:99], v[132:135]
ds_write_b64 v243, v[190:191] offset:512
v_mfma_f32_16x16x32_bf16 v[136:139], v[172:175], a[100:103], v[136:139]
ds_read_b128 a[144:147], v232 offset:1344
v_mfma_f32_16x16x32_bf16 v[140:143], v[172:175], a[104:107], v[140:143]
ds_read_b128 a[164:167], v240 offset:1344
v_mfma_f32_16x16x32_bf16 v[96:99], a[40:43], a[168:171], v[96:99]
ds_read_b128 a[148:151], v232 offset:1408
v_mfma_f32_16x16x32_bf16 v[100:103], a[72:75], a[168:171], v[100:103]
ds_read2_b32 v[62:63], v239 offset0:24 offset1:25
v_mfma_f32_16x16x32_bf16 v[152:155], a[180:183], a[0:3], 0
ds_read2_b32 v[64:65], v239 offset0:8 offset1:9
v_mfma_f32_16x16x32_bf16 v[156:159], a[252:255], a[0:3], 0
ds_read2_b32 v[66:67], v239 offset0:16 offset1:17
v_mfma_f32_16x16x32_bf16 v[128:131], a[204:207], a[152:155], v[128:131]
ds_read_b128 a[168:171], v240 offset:1408
v_mfma_f32_16x16x32_bf16 v[132:135], a[236:239], a[152:155], v[132:135]
ds_read2_b32 v[68:69], v239 offset0:0 offset1:1
v_mfma_f32_16x16x32_bf16 v[160:163], a[180:183], a[4:7], 0
ds_read2_b32 v[70:71], v239 offset0:8 offset1:9
v_mfma_f32_16x16x32_bf16 v[164:167], a[252:255], a[4:7], 0
ds_read2_b32 a[124:125], v231 offset0:120 offset1:121
s_waitcnt lgkmcnt(15)
v_mfma_f32_16x16x32_bf16 v[96:99], a[36:39], a[172:175], v[96:99]
v_cvt_pk_bf16_f32 v176, v152, v153
v_cvt_pk_bf16_f32 v177, v154, v155
v_mfma_f32_16x16x32_bf16 v[100:103], a[68:71], a[172:175], v[100:103]
v_cvt_pk_bf16_f32 v178, v156, v157
v_cvt_pk_bf16_f32 v179, v158, v159
v_mfma_f32_16x16x32_bf16 v[128:131], a[200:203], a[156:159], v[128:131]
v_cvt_pk_bf16_f32 v180, v160, v161
v_cvt_pk_bf16_f32 v181, v162, v163
v_mfma_f32_16x16x32_bf16 v[132:135], a[232:235], a[156:159], v[132:135]
v_cvt_pk_bf16_f32 v182, v164, v165
v_cvt_pk_bf16_f32 v183, v166, v167
v_mfma_f32_16x16x32_bf16 v[96:99], a[32:35], a[176:179], v[96:99]
s_waitcnt lgkmcnt(10)
s_barrier
ds_read_b64_tr_b16 v[208:209], v200 offset:512
ds_read_b64_tr_b16 v[210:211], v200 offset:17152
v_mfma_f32_16x16x32_bf16 v[100:103], a[64:67], a[176:179], v[100:103]
ds_read_b128 a[152:155], v232 offset:1472
v_mfma_f32_16x16x32_bf16 v[100:103], v[176:179], v[32:35], v[100:103]
ds_read_b128 a[180:183], v242 offset:0
v_mfma_f32_16x16x32_bf16 v[104:107], v[176:179], v[36:39], v[104:107]
ds_read_b128 a[252:255], v242 offset:512
v_mfma_f32_16x16x32_bf16 v[108:111], v[176:179], v[40:43], v[108:111]
ds_read_b128 a[172:175], v240 offset:1472
v_mfma_f32_16x16x32_bf16 v[128:131], a[196:199], a[140:143], v[128:131]
ds_read_b128 a[156:159], v232 offset:1536
v_mfma_f32_16x16x32_bf16 v[132:135], a[228:231], a[140:143], v[132:135]
ds_read_b128 a[176:179], v240 offset:1536
v_mfma_f32_16x16x32_bf16 v[152:155], v[212:215], a[8:11], 0
ds_read2_b32 a[126:127], v231 offset0:128 offset1:129
v_mfma_f32_16x16x32_bf16 v[156:159], v[216:219], a[8:11], 0
ds_read2_b32 a[128:129], v231 offset0:112 offset1:113
v_mfma_f32_16x16x32_bf16 v[100:103], v[180:183], v[44:47], v[100:103]
ds_read2_b32 a[130:131], v231 offset0:120 offset1:121
v_mfma_f32_16x16x32_bf16 v[104:107], v[180:183], v[48:51], v[104:107]
ds_read2_b32 a[132:133], v231 offset0:104 offset1:105
v_mfma_f32_16x16x32_bf16 v[108:111], v[180:183], v[52:55], v[108:111]
ds_read2_b32 a[134:135], v231 offset0:112 offset1:113
v_mfma_f32_16x16x32_bf16 v[96:99], a[28:31], a[160:163], v[96:99]
ds_read_b128 a[140:143], v232 offset:1600
v_mfma_f32_16x16x32_bf16 v[100:103], a[60:63], a[160:163], v[100:103]
ds_read2_b32 a[136:137], v231 offset0:96 offset1:97
s_waitcnt lgkmcnt(15)
v_mfma_f32_16x16x32_bf16 v[128:131], a[192:195], a[144:147], v[128:131]
v_cvt_pk_bf16_f32 v168, v152, v153
v_cvt_pk_bf16_f32 v169, v154, v155
v_mfma_f32_16x16x32_bf16 v[132:135], a[224:227], a[144:147], v[132:135]
v_cvt_pk_bf16_f32 v170, v156, v157
v_cvt_pk_bf16_f32 v171, v158, v159
v_mfma_f32_16x16x32_bf16 v[96:99], a[24:27], a[164:167], v[96:99]
s_mov_b32 s74, 589824
s_waitcnt lgkmcnt(13)
buffer_store_dwordx4 v[208:211], v201, s[20:23], s74 offen
v_mfma_f32_16x16x32_bf16 v[100:103], a[56:59], a[164:167], v[100:103]
ds_read_b128 v[212:215], v234 offset:16
v_mfma_f32_16x16x32_bf16 v[128:131], a[188:191], a[148:151], v[128:131]
ds_read_b128 v[216:219], v234 offset:528
v_mfma_f32_16x16x32_bf16 v[132:135], a[220:223], a[148:151], v[132:135]
ds_read_b128 a[160:163], v240 offset:1600
v_mfma_f32_16x16x32_bf16 v[136:139], v[168:171], a[108:111], v[136:139]
ds_read_b128 a[144:147], v232 offset:1664
v_mfma_f32_16x16x32_bf16 v[140:143], v[168:171], a[112:115], v[140:143]
ds_read_b128 a[164:167], v240 offset:1664
v_mfma_f32_16x16x32_bf16 v[144:147], v[168:171], a[116:119], 0
ds_read2_b32 a[138:139], v231 offset0:104 offset1:105
v_mfma_f32_16x16x32_bf16 v[148:151], v[168:171], a[120:123], 0
ds_read2_b32 v[72:73], v239 offset0:120 offset1:121
v_mfma_f32_16x16x32_bf16 v[96:99], a[20:23], a[168:171], v[96:99]
ds_read_b128 a[148:151], v232 offset:1728
v_mfma_f32_16x16x32_bf16 v[100:103], a[52:55], a[168:171], v[100:103]
ds_read2_b32 v[74:75], v239 offset0:128 offset1:129
s_waitcnt lgkmcnt(15)
v_mfma_f32_16x16x32_bf16 v[152:155], a[180:183], a[8:11], 0
ds_read2_b32 v[76:77], v239 offset0:112 offset1:113
v_mfma_f32_16x16x32_bf16 v[156:159], a[252:255], a[8:11], 0
ds_read2_b32 v[78:79], v239 offset0:120 offset1:121
v_mfma_f32_16x16x32_bf16 v[128:131], a[184:187], a[152:155], v[128:131]
ds_read_b128 a[168:171], v240 offset:1728
v_mfma_f32_16x16x32_bf16 v[132:135], a[216:219], a[152:155], v[132:135]
ds_read2_b32 v[80:81], v239 offset0:104 offset1:105
v_mfma_f32_16x16x32_bf16 v[136:139], a[248:251], a[152:155], v[136:139]
ds_read2_b32 v[82:83], v239 offset0:112 offset1:113
v_mfma_f32_16x16x32_bf16 v[144:147], v[184:187], a[152:155], v[144:147]
ds_read2_b32 v[84:85], v239 offset0:96 offset1:97
v_mfma_f32_16x16x32_bf16 v[96:99], a[16:19], a[172:175], v[96:99]
v_cvt_pk_bf16_f32 v176, v152, v153
v_cvt_pk_bf16_f32 v177, v154, v155
v_mfma_f32_16x16x32_bf16 v[100:103], a[48:51], a[172:175], v[100:103]
v_cvt_pk_bf16_f32 v178, v156, v157
v_cvt_pk_bf16_f32 v179, v158, v159
v_mfma_f32_16x16x32_bf16 v[104:107], a[80:83], a[172:175], v[104:107]
ds_read_b128 a[152:155], v232 offset:1792
v_mfma_f32_16x16x32_bf16 v[4:7], v[220:223], a[172:175], 0
ds_read_b128 a[180:183], v242 offset:16
v_mfma_f32_16x16x32_bf16 v[132:135], a[212:215], a[156:159], v[132:135]
ds_read_b128 a[252:255], v242 offset:528
v_mfma_f32_16x16x32_bf16 v[136:139], a[244:247], a[156:159], v[136:139]
ds_read_b128 a[172:175], v240 offset:1792
v_mfma_f32_16x16x32_bf16 v[100:103], a[44:47], a[176:179], v[100:103]
v_cvt_pk_bf16_f32 v188, v128, v129
v_cvt_pk_bf16_f32 v189, v130, v131
v_mfma_f32_16x16x32_bf16 v[104:107], a[76:79], a[176:179], v[104:107]
ds_write_b64 v235, v[188:189] offset:1024
v_mfma_f32_16x16x32_bf16 v[104:107], v[176:179], v[56:59], v[104:107]
ds_read_b128 a[156:159], v232 offset:1856
v_mfma_f32_16x16x32_bf16 v[108:111], v[176:179], v[60:63], v[108:111]
ds_read2_b32 v[86:87], v239 offset0:104 offset1:105
v_mfma_f32_16x16x32_bf16 v[4:7], v[176:179], v[64:67], v[4:7]
v_mfma_f32_16x16x32_bf16 v[8:11], v[176:179], v[68:71], 0
s_waitcnt lgkmcnt(15)
v_mfma_f32_16x16x32_bf16 v[132:135], a[208:211], a[140:143], v[132:135]
v_cvt_pk_bf16_f32 v190, v96, v97
v_cvt_pk_bf16_f32 v191, v98, v99
v_mfma_f32_16x16x32_bf16 v[136:139], a[240:243], a[140:143], v[136:139]
ds_write_b64 v243, v[190:191] offset:1024
v_mfma_f32_16x16x32_bf16 v[152:155], v[212:215], a[12:15], 0
ds_read_b128 a[176:179], v240 offset:1856
v_mfma_f32_16x16x32_bf16 v[156:159], v[216:219], a[12:15], 0
v_mfma_f32_16x16x32_bf16 v[100:103], a[40:43], a[160:163], v[100:103]
ds_read_b128 a[140:143], v232 offset:1920
v_mfma_f32_16x16x32_bf16 v[104:107], a[72:75], a[160:163], v[104:107]
v_mfma_f32_16x16x32_bf16 v[132:135], a[204:207], a[144:147], v[132:135]
s_nop 1
v_cvt_pk_bf16_f32 v168, v152, v153
v_cvt_pk_bf16_f32 v169, v154, v155
v_mfma_f32_16x16x32_bf16 v[136:139], a[236:239], a[144:147], v[136:139]
v_cvt_pk_bf16_f32 v170, v156, v157
v_cvt_pk_bf16_f32 v171, v158, v159
v_mfma_f32_16x16x32_bf16 v[100:103], a[36:39], a[164:167], v[100:103]
ds_read_b128 v[212:215], v233 offset:1024
v_mfma_f32_16x16x32_bf16 v[104:107], a[68:71], a[164:167], v[104:107]
ds_read_b128 v[216:219], v233 offset:1280
s_waitcnt lgkmcnt(15)
v_mfma_f32_16x16x32_bf16 v[132:135], a[200:203], a[148:151], v[132:135]
ds_read_b128 a[160:163], v240 offset:1920
v_mfma_f32_16x16x32_bf16 v[136:139], a[232:235], a[148:151], v[136:139]
ds_read_b128 a[144:147], v232 offset:1984
v_mfma_f32_16x16x32_bf16 v[136:139], v[168:171], a[124:127], v[136:139]
ds_read_b128 a[164:167], v240 offset:1984
v_mfma_f32_16x16x32_bf16 v[140:143], v[168:171], a[128:131], v[140:143]
v_mfma_f32_16x16x32_bf16 v[144:147], v[168:171], a[132:135], v[144:147]
v_mfma_f32_16x16x32_bf16 v[148:151], v[168:171], a[136:139], v[148:151]
v_mfma_f32_16x16x32_bf16 v[100:103], a[32:35], a[168:171], v[100:103]
s_waitcnt lgkmcnt(7)
s_barrier
ds_read_b64_tr_b16 v[204:205], v200 offset:1024
ds_read_b64_tr_b16 v[206:207], v200 offset:17664
v_mfma_f32_16x16x32_bf16 v[104:107], a[64:67], a[168:171], v[104:107]
ds_read_b128 a[148:151], v232 offset:2048
v_mfma_f32_16x16x32_bf16 v[152:155], a[180:183], a[12:15], 0
v_mfma_f32_16x16x32_bf16 v[156:159], a[252:255], a[12:15], 0
v_mfma_f32_16x16x32_bf16 v[132:135], a[196:199], a[152:155], v[132:135]
ds_read_b128 a[168:171], v240 offset:2048
v_mfma_f32_16x16x32_bf16 v[136:139], a[228:231], a[152:155], v[136:139]
v_mfma_f32_16x16x32_bf16 v[100:103], a[28:31], a[172:175], v[100:103]
s_nop 2
v_cvt_pk_bf16_f32 v176, v152, v153
v_cvt_pk_bf16_f32 v177, v154, v155
v_mfma_f32_16x16x32_bf16 v[104:107], a[60:63], a[172:175], v[104:107]
v_cvt_pk_bf16_f32 v178, v156, v157
v_cvt_pk_bf16_f32 v179, v158, v159
v_mfma_f32_16x16x32_bf16 v[132:135], a[192:195], a[156:159], v[132:135]
s_mov_b32 s74, 1179648
s_waitcnt lgkmcnt(2)
buffer_store_dwordx4 v[204:207], v201, s[20:23], s74 offen
v_mfma_f32_16x16x32_bf16 v[136:139], a[224:227], a[156:159], v[136:139]
ds_read_b128 a[152:155], v232 offset:2112
v_mfma_f32_16x16x32_bf16 v[100:103], a[24:27], a[176:179], v[100:103]
ds_read_b128 a[180:183], v241 offset:1024
v_mfma_f32_16x16x32_bf16 v[104:107], a[56:59], a[176:179], v[104:107]
ds_read_b128 a[252:255], v241 offset:1280
v_mfma_f32_16x16x32_bf16 v[104:107], v[176:179], v[72:75], v[104:107]
ds_read_b128 a[172:175], v240 offset:2112
v_mfma_f32_16x16x32_bf16 v[108:111], v[176:179], v[76:79], v[108:111]
ds_read_b128 a[156:159], v232 offset:2176
v_mfma_f32_16x16x32_bf16 v[4:7], v[176:179], v[80:83], v[4:7]
v_mfma_f32_16x16x32_bf16 v[8:11], v[176:179], v[84:87], v[8:11]
v_mfma_f32_16x16x32_bf16 v[132:135], a[188:191], a[140:143], v[132:135]
ds_read_b128 a[176:179], v240 offset:2176
v_mfma_f32_16x16x32_bf16 v[136:139], a[220:223], a[140:143], v[136:139]
v_mfma_f32_16x16x32_bf16 v[152:155], v[212:215], a[0:3], 0
v_mfma_f32_16x16x32_bf16 v[156:159], v[216:219], a[0:3], 0
v_mfma_f32_16x16x32_bf16 v[160:163], v[212:215], a[4:7], 0
ds_read_b128 a[140:143], v232 offset:2240
v_mfma_f32_16x16x32_bf16 v[164:167], v[216:219], a[4:7], 0
v_mfma_f32_16x16x32_bf16 v[100:103], a[20:23], a[160:163], v[100:103]
v_mfma_f32_16x16x32_bf16 v[104:107], a[52:55], a[160:163], v[104:107]
v_mfma_f32_16x16x32_bf16 v[132:135], a[184:187], a[144:147], v[132:135]
s_nop 0
v_cvt_pk_bf16_f32 v168, v152, v153
v_cvt_pk_bf16_f32 v169, v154, v155
v_mfma_f32_16x16x32_bf16 v[136:139], a[216:219], a[144:147], v[136:139]
v_cvt_pk_bf16_f32 v170, v156, v157
v_cvt_pk_bf16_f32 v171, v158, v159
v_mfma_f32_16x16x32_bf16 v[140:143], a[248:251], a[144:147], v[140:143]
ds_read_b128 v[212:215], v233 offset:1536
v_mfma_f32_16x16x32_bf16 v[148:151], v[184:187], a[144:147], v[148:151]
ds_read_b128 v[216:219], v233 offset:1792
v_mfma_f32_16x16x32_bf16 v[100:103], a[16:19], a[164:167], v[100:103]
v_cvt_pk_bf16_f32 v172, v160, v161
v_cvt_pk_bf16_f32 v173, v162, v163
v_mfma_f32_16x16x32_bf16 v[104:107], a[48:51], a[164:167], v[104:107]
v_cvt_pk_bf16_f32 v174, v164, v165
v_cvt_pk_bf16_f32 v175, v166, v167
v_mfma_f32_16x16x32_bf16 v[108:111], a[80:83], a[164:167], v[108:111]
ds_read_b128 a[160:163], v240 offset:2240
v_mfma_f32_16x16x32_bf16 v[8:11], v[220:223], a[164:167], v[8:11]
ds_read_b128 a[144:147], v232 offset:2304
s_waitcnt lgkmcnt(12)
v_mfma_f32_16x16x32_bf16 v[136:139], a[212:215], a[148:151], v[136:139]
ds_read_b128 a[164:167], v240 offset:2304
v_mfma_f32_16x16x32_bf16 v[140:143], a[244:247], a[148:151], v[140:143]
v_mfma_f32_16x16x32_bf16 v[136:139], v[168:171], a[84:87], v[136:139]
v_mfma_f32_16x16x32_bf16 v[140:143], v[168:171], a[88:91], v[140:143]
v_mfma_f32_16x16x32_bf16 v[144:147], v[168:171], a[92:95], v[144:147]
v_mfma_f32_16x16x32_bf16 v[136:139], v[172:175], a[96:99], v[136:139]
v_cvt_pk_bf16_f32 v188, v132, v133
v_cvt_pk_bf16_f32 v189, v134, v135
v_mfma_f32_16x16x32_bf16 v[140:143], v[172:175], a[100:103], v[140:143]
ds_write_b64 v235, v[188:189] offset:1536
v_mfma_f32_16x16x32_bf16 v[144:147], v[172:175], a[104:107], v[144:147]
ds_read_b128 a[148:151], v232 offset:2368
s_waitcnt lgkmcnt(14)
v_mfma_f32_16x16x32_bf16 v[104:107], a[44:47], a[168:171], v[104:107]
v_mfma_f32_16x16x32_bf16 v[108:111], a[76:79], a[168:171], v[108:111]
s_waitcnt lgkmcnt(12)
v_mfma_f32_16x16x32_bf16 v[152:155], a[180:183], a[0:3], 0
s_waitcnt lgkmcnt(11)
v_mfma_f32_16x16x32_bf16 v[156:159], a[252:255], a[0:3], 0
v_mfma_f32_16x16x32_bf16 v[136:139], a[208:211], a[152:155], v[136:139]
v_cvt_pk_bf16_f32 v190, v100, v101
v_cvt_pk_bf16_f32 v191, v102, v103
v_mfma_f32_16x16x32_bf16 v[140:143], a[240:243], a[152:155], v[140:143]
ds_write_b64 v243, v[190:191] offset:1536
v_mfma_f32_16x16x32_bf16 v[160:163], a[180:183], a[4:7], 0
ds_read_b128 a[168:171], v240 offset:2368
v_mfma_f32_16x16x32_bf16 v[164:167], a[252:255], a[4:7], 0
s_waitcnt lgkmcnt(12)
v_mfma_f32_16x16x32_bf16 v[104:107], a[40:43], a[172:175], v[104:107]
v_cvt_pk_bf16_f32 v176, v152, v153
v_cvt_pk_bf16_f32 v177, v154, v155
v_mfma_f32_16x16x32_bf16 v[108:111], a[72:75], a[172:175], v[108:111]
v_cvt_pk_bf16_f32 v178, v156, v157
v_cvt_pk_bf16_f32 v179, v158, v159
s_waitcnt lgkmcnt(11)
v_mfma_f32_16x16x32_bf16 v[136:139], a[204:207], a[156:159], v[136:139]
v_cvt_pk_bf16_f32 v180, v160, v161
v_cvt_pk_bf16_f32 v181, v162, v163
v_mfma_f32_16x16x32_bf16 v[140:143], a[236:239], a[156:159], v[140:143]
v_cvt_pk_bf16_f32 v182, v164, v165
v_cvt_pk_bf16_f32 v183, v166, v167
s_waitcnt lgkmcnt(10)
v_mfma_f32_16x16x32_bf16 v[104:107], a[36:39], a[176:179], v[104:107]
ds_read_b128 a[152:155], v232 offset:2432
v_mfma_f32_16x16x32_bf16 v[108:111], a[68:71], a[176:179], v[108:111]
ds_read_b128 a[180:183], v241 offset:1536
v_mfma_f32_16x16x32_bf16 v[104:107], v[176:179], v[32:35], v[104:107]
ds_read_b128 a[252:255], v241 offset:1792
v_mfma_f32_16x16x32_bf16 v[108:111], v[176:179], v[36:39], v[108:111]
ds_read_b128 a[172:175], v240 offset:2432
v_mfma_f32_16x16x32_bf16 v[4:7], v[176:179], v[40:43], v[4:7]
ds_read_b128 a[156:159], v232 offset:2496
s_waitcnt lgkmcnt(14)
v_mfma_f32_16x16x32_bf16 v[136:139], a[200:203], a[140:143], v[136:139]
ds_read_b128 a[176:179], v240 offset:2496
v_mfma_f32_16x16x32_bf16 v[140:143], a[232:235], a[140:143], v[140:143]
s_waitcnt lgkmcnt(14)
v_mfma_f32_16x16x32_bf16 v[152:155], v[212:215], a[0:3], 0
s_waitcnt lgkmcnt(13)
v_mfma_f32_16x16x32_bf16 v[156:159], v[216:219], a[0:3], 0
v_mfma_f32_16x16x32_bf16 v[104:107], v[180:183], v[44:47], v[104:107]
v_mfma_f32_16x16x32_bf16 v[108:111], v[180:183], v[48:51], v[108:111]
v_mfma_f32_16x16x32_bf16 v[4:7], v[180:183], v[52:55], v[4:7]
v_mfma_f32_16x16x32_bf16 v[160:163], v[212:215], a[4:7], 0
s_waitcnt lgkmcnt(7)
s_barrier
ds_read_b64_tr_b16 v[208:209], v200 offset:1536
ds_read_b64_tr_b16 v[210:211], v200 offset:18176
v_mfma_f32_16x16x32_bf16 v[164:167], v[216:219], a[4:7], 0
ds_read_b128 a[140:143], v232 offset:2560
v_mfma_f32_16x16x32_bf16 v[104:107], a[32:35], a[160:163], v[104:107]
v_mfma_f32_16x16x32_bf16 v[108:111], a[64:67], a[160:163], v[108:111]
v_mfma_f32_16x16x32_bf16 v[136:139], a[196:199], a[144:147], v[136:139]
v_cvt_pk_bf16_f32 v168, v152, v153
v_cvt_pk_bf16_f32 v169, v154, v155
v_mfma_f32_16x16x32_bf16 v[140:143], a[228:231], a[144:147], v[140:143]
v_cvt_pk_bf16_f32 v170, v156, v157
v_cvt_pk_bf16_f32 v171, v158, v159
v_mfma_f32_16x16x32_bf16 v[104:107], a[28:31], a[164:167], v[104:107]
v_cvt_pk_bf16_f32 v172, v160, v161
v_cvt_pk_bf16_f32 v173, v162, v163
v_mfma_f32_16x16x32_bf16 v[108:111], a[60:63], a[164:167], v[108:111]
v_cvt_pk_bf16_f32 v174, v164, v165
v_cvt_pk_bf16_f32 v175, v166, v167
v_mfma_f32_16x16x32_bf16 v[136:139], a[192:195], a[148:151], v[136:139]
s_mov_b32 s74, 1769472
s_waitcnt lgkmcnt(1)
buffer_store_dwordx4 v[208:211], v201, s[20:23], s74 offen
v_mfma_f32_16x16x32_bf16 v[140:143], a[224:227], a[148:151], v[140:143]
ds_read_b128 v[212:215], v234 offset:1024
v_mfma_f32_16x16x32_bf16 v[140:143], v[168:171], a[84:87], v[140:143]
ds_read_b128 v[216:219], v234 offset:1536
v_mfma_f32_16x16x32_bf16 v[144:147], v[168:171], a[88:91], v[144:147]
ds_read_b128 a[160:163], v240 offset:2560
v_mfma_f32_16x16x32_bf16 v[148:151], v[168:171], a[92:95], v[148:151]
ds_read_b128 a[144:147], v232 offset:2624
v_mfma_f32_16x16x32_bf16 v[140:143], v[172:175], a[96:99], v[140:143]
ds_read_b128 a[164:167], v240 offset:2624
v_mfma_f32_16x16x32_bf16 v[144:147], v[172:175], a[100:103], v[144:147]
ds_read_b128 a[148:151], v232 offset:2688
v_mfma_f32_16x16x32_bf16 v[148:151], v[172:175], a[104:107], v[148:151]
v_mfma_f32_16x16x32_bf16 v[104:107], a[24:27], a[168:171], v[104:107]
v_mfma_f32_16x16x32_bf16 v[108:111], a[56:59], a[168:171], v[108:111]
v_mfma_f32_16x16x32_bf16 v[152:155], a[180:183], a[0:3], 0
v_mfma_f32_16x16x32_bf16 v[156:159], a[252:255], a[0:3], 0
v_mfma_f32_16x16x32_bf16 v[136:139], a[188:191], a[152:155], v[136:139]
ds_read_b128 a[168:171], v240 offset:2688
v_mfma_f32_16x16x32_bf16 v[140:143], a[220:223], a[152:155], v[140:143]
v_mfma_f32_16x16x32_bf16 v[160:163], a[180:183], a[4:7], 0
v_mfma_f32_16x16x32_bf16 v[164:167], a[252:255], a[4:7], 0
v_mfma_f32_16x16x32_bf16 v[104:107], a[20:23], a[172:175], v[104:107]
s_nop 0
v_cvt_pk_bf16_f32 v176, v152, v153
v_cvt_pk_bf16_f32 v177, v154, v155
v_mfma_f32_16x16x32_bf16 v[108:111], a[52:55], a[172:175], v[108:111]
v_cvt_pk_bf16_f32 v178, v156, v157
v_cvt_pk_bf16_f32 v179, v158, v159
v_mfma_f32_16x16x32_bf16 v[136:139], a[184:187], a[156:159], v[136:139]
v_cvt_pk_bf16_f32 v180, v160, v161
v_cvt_pk_bf16_f32 v181, v162, v163
v_mfma_f32_16x16x32_bf16 v[140:143], a[216:219], a[156:159], v[140:143]
v_cvt_pk_bf16_f32 v182, v164, v165
v_cvt_pk_bf16_f32 v183, v166, v167
v_mfma_f32_16x16x32_bf16 v[144:147], a[248:251], a[156:159], v[144:147]
ds_read_b128 a[152:155], v232 offset:2752
v_mfma_f32_16x16x32_bf16 v[104:107], a[16:19], a[176:179], v[104:107]
ds_read_b128 a[180:183], v242 offset:1024
v_mfma_f32_16x16x32_bf16 v[108:111], a[48:51], a[176:179], v[108:111]
ds_read_b128 a[252:255], v242 offset:1536
v_mfma_f32_16x16x32_bf16 v[4:7], a[80:83], a[176:179], v[4:7]
ds_read_b128 a[172:175], v240 offset:2752
v_mfma_f32_16x16x32_bf16 v[108:111], v[176:179], v[32:35], v[108:111]
ds_read_b128 a[156:159], v232 offset:2816
v_mfma_f32_16x16x32_bf16 v[4:7], v[176:179], v[36:39], v[4:7]
v_mfma_f32_16x16x32_bf16 v[8:11], v[176:179], v[40:43], v[8:11]
s_waitcnt lgkmcnt(12)
v_mfma_f32_16x16x32_bf16 v[140:143], a[212:215], a[140:143], v[140:143]
ds_read_b128 a[176:179], v240 offset:2816
v_mfma_f32_16x16x32_bf16 v[144:147], a[244:247], a[140:143], v[144:147]
s_waitcnt lgkmcnt(12)
v_mfma_f32_16x16x32_bf16 v[152:155], v[212:215], a[8:11], 0
s_waitcnt lgkmcnt(11)
v_mfma_f32_16x16x32_bf16 v[156:159], v[216:219], a[8:11], 0
v_mfma_f32_16x16x32_bf16 v[108:111], v[180:183], v[44:47], v[108:111]
v_mfma_f32_16x16x32_bf16 v[4:7], v[180:183], v[48:51], v[4:7]
v_mfma_f32_16x16x32_bf16 v[8:11], v[180:183], v[52:55], v[8:11]
s_waitcnt lgkmcnt(10)
v_mfma_f32_16x16x32_bf16 v[108:111], a[44:47], a[160:163], v[108:111]
v_cvt_pk_bf16_f32 v188, v136, v137
v_cvt_pk_bf16_f32 v189, v138, v139
v_mfma_f32_16x16x32_bf16 v[4:7], a[76:79], a[160:163], v[4:7]
ds_write_b64 v235, v[188:189] offset:2048
s_waitcnt lgkmcnt(10)
v_mfma_f32_16x16x32_bf16 v[140:143], a[208:211], a[144:147], v[140:143]
v_cvt_pk_bf16_f32 v168, v152, v153
v_cvt_pk_bf16_f32 v169, v154, v155
v_mfma_f32_16x16x32_bf16 v[144:147], a[240:243], a[144:147], v[144:147]
v_cvt_pk_bf16_f32 v170, v156, v157
v_cvt_pk_bf16_f32 v171, v158, v159
s_waitcnt lgkmcnt(9)
v_mfma_f32_16x16x32_bf16 v[108:111], a[40:43], a[164:167], v[108:111]
v_cvt_pk_bf16_f32 v190, v104, v105
v_cvt_pk_bf16_f32 v191, v106, v107
v_mfma_f32_16x16x32_bf16 v[4:7], a[72:75], a[164:167], v[4:7]
ds_write_b64 v243, v[190:191] offset:2048
s_waitcnt lgkmcnt(9)
v_mfma_f32_16x16x32_bf16 v[140:143], a[204:207], a[148:151], v[140:143]
ds_read_b128 a[140:143], v232 offset:2880
v_mfma_f32_16x16x32_bf16 v[144:147], a[236:239], a[148:151], v[144:147]
ds_read_b128 v[212:215], v234 offset:1040
v_mfma_f32_16x16x32_bf16 v[144:147], v[168:171], a[108:111], v[144:147]
ds_read_b128 v[216:219], v234 offset:1552
v_mfma_f32_16x16x32_bf16 v[148:151], v[168:171], a[112:115], v[148:151]
ds_read_b128 a[160:163], v240 offset:2880
s_waitcnt lgkmcnt(12)
v_mfma_f32_16x16x32_bf16 v[108:111], a[36:39], a[168:171], v[108:111]
ds_read_b128 a[144:147], v232 offset:2944
v_mfma_f32_16x16x32_bf16 v[4:7], a[68:71], a[168:171], v[4:7]
ds_read_b128 a[164:167], v240 offset:2944
s_waitcnt lgkmcnt(12)
v_mfma_f32_16x16x32_bf16 v[152:155], a[180:183], a[8:11], 0
ds_read_b128 a[148:151], v232 offset:3008
s_waitcnt lgkmcnt(12)
v_mfma_f32_16x16x32_bf16 v[156:159], a[252:255], a[8:11], 0
v_mfma_f32_16x16x32_bf16 v[140:143], a[200:203], a[152:155], v[140:143]
ds_read_b128 a[168:171], v240 offset:3008
v_mfma_f32_16x16x32_bf16 v[144:147], a[232:235], a[152:155], v[144:147]
s_waitcnt lgkmcnt(12)
v_mfma_f32_16x16x32_bf16 v[108:111], a[32:35], a[172:175], v[108:111]
v_cvt_pk_bf16_f32 v176, v152, v153
v_cvt_pk_bf16_f32 v177, v154, v155
v_mfma_f32_16x16x32_bf16 v[4:7], a[64:67], a[172:175], v[4:7]
v_cvt_pk_bf16_f32 v178, v156, v157
v_cvt_pk_bf16_f32 v179, v158, v159
s_waitcnt lgkmcnt(11)
v_mfma_f32_16x16x32_bf16 v[140:143], a[196:199], a[156:159], v[140:143]
s_waitcnt lgkmcnt(8)
s_barrier
ds_read_b64_tr_b16 v[204:205], v200 offset:2048
ds_read_b64_tr_b16 v[206:207], v200 offset:18688
v_mfma_f32_16x16x32_bf16 v[144:147], a[228:231], a[156:159], v[144:147]
ds_read_b128 a[152:155], v232 offset:3072
v_mfma_f32_16x16x32_bf16 v[108:111], a[28:31], a[176:179], v[108:111]
ds_read_b128 a[180:183], v242 offset:1040
v_mfma_f32_16x16x32_bf16 v[4:7], a[60:63], a[176:179], v[4:7]
ds_read_b128 a[252:255], v242 offset:1552
v_mfma_f32_16x16x32_bf16 v[4:7], v[176:179], v[56:59], v[4:7]
ds_read_b128 a[172:175], v240 offset:3072
v_mfma_f32_16x16x32_bf16 v[8:11], v[176:179], v[60:63], v[8:11]
ds_read_b128 a[156:159], v232 offset:3136
s_waitcnt lgkmcnt(14)
v_mfma_f32_16x16x32_bf16 v[140:143], a[192:195], a[140:143], v[140:143]
s_mov_b32 s74, 2359296
s_waitcnt lgkmcnt(5)
buffer_store_dwordx4 v[204:207], v201, s[20:23], s74 offen
v_mfma_f32_16x16x32_bf16 v[144:147], a[224:227], a[140:143], v[144:147]
ds_read_b128 a[176:179], v240 offset:3136
v_mfma_f32_16x16x32_bf16 v[152:155], v[212:215], a[12:15], 0
v_mfma_f32_16x16x32_bf16 v[156:159], v[216:219], a[12:15], 0
v_mfma_f32_16x16x32_bf16 v[108:111], a[24:27], a[160:163], v[108:111]
ds_read_b128 a[140:143], v232 offset:3200
v_mfma_f32_16x16x32_bf16 v[4:7], a[56:59], a[160:163], v[4:7]
v_mfma_f32_16x16x32_bf16 v[140:143], a[188:191], a[144:147], v[140:143]
s_nop 2
v_cvt_pk_bf16_f32 v168, v152, v153
v_cvt_pk_bf16_f32 v169, v154, v155
v_mfma_f32_16x16x32_bf16 v[144:147], a[220:223], a[144:147], v[144:147]
v_cvt_pk_bf16_f32 v170, v156, v157
v_cvt_pk_bf16_f32 v171, v158, v159
v_mfma_f32_16x16x32_bf16 v[108:111], a[20:23], a[164:167], v[108:111]
ds_read_b128 v[212:215], v233 offset:2048
v_mfma_f32_16x16x32_bf16 v[4:7], a[52:55], a[164:167], v[4:7]
ds_read_b128 v[216:219], v233 offset:2304
v_mfma_f32_16x16x32_bf16 v[140:143], a[184:187], a[148:151], v[140:143]
ds_read_b128 a[160:163], v240 offset:3200
v_mfma_f32_16x16x32_bf16 v[144:147], a[216:219], a[148:151], v[144:147]
ds_read_b128 a[144:147], v232 offset:3264
v_mfma_f32_16x16x32_bf16 v[148:151], a[248:251], a[148:151], v[148:151]
ds_read_b128 a[164:167], v240 offset:3264
v_mfma_f32_16x16x32_bf16 v[144:147], v[168:171], a[124:127], v[144:147]
v_mfma_f32_16x16x32_bf16 v[148:151], v[168:171], a[128:131], v[148:151]
v_mfma_f32_16x16x32_bf16 v[108:111], a[16:19], a[168:171], v[108:111]
ds_read_b128 a[148:151], v232 offset:3328
v_mfma_f32_16x16x32_bf16 v[4:7], a[48:51], a[168:171], v[4:7]
v_mfma_f32_16x16x32_bf16 v[8:11], a[80:83], a[168:171], v[8:11]
s_waitcnt lgkmcnt(11)
v_mfma_f32_16x16x32_bf16 v[152:155], a[180:183], a[12:15], 0
s_waitcnt lgkmcnt(10)
v_mfma_f32_16x16x32_bf16 v[156:159], a[252:255], a[12:15], 0
v_mfma_f32_16x16x32_bf16 v[144:147], a[212:215], a[152:155], v[144:147]
ds_read_b128 a[168:171], v240 offset:3328
v_mfma_f32_16x16x32_bf16 v[148:151], a[244:247], a[152:155], v[148:151]
s_waitcnt lgkmcnt(10)
v_mfma_f32_16x16x32_bf16 v[4:7], a[44:47], a[172:175], v[4:7]
s_nop 0
v_cvt_pk_bf16_f32 v176, v152, v153
v_cvt_pk_bf16_f32 v177, v154, v155
v_mfma_f32_16x16x32_bf16 v[8:11], a[76:79], a[172:175], v[8:11]
v_cvt_pk_bf16_f32 v178, v156, v157
v_cvt_pk_bf16_f32 v179, v158, v159
s_waitcnt lgkmcnt(9)
v_mfma_f32_16x16x32_bf16 v[144:147], a[208:211], a[156:159], v[144:147]
v_cvt_pk_bf16_f32 v188, v140, v141
v_cvt_pk_bf16_f32 v189, v142, v143
v_mfma_f32_16x16x32_bf16 v[148:151], a[240:243], a[156:159], v[148:151]
ds_write_b64 v235, v[188:189] offset:2560
s_waitcnt lgkmcnt(9)
v_mfma_f32_16x16x32_bf16 v[4:7], a[40:43], a[176:179], v[4:7]
v_cvt_pk_bf16_f32 v190, v108, v109
v_cvt_pk_bf16_f32 v191, v110, v111
v_mfma_f32_16x16x32_bf16 v[8:11], a[72:75], a[176:179], v[8:11]
ds_write_b64 v243, v[190:191] offset:2560
v_mfma_f32_16x16x32_bf16 v[4:7], v[176:179], v[72:75], v[4:7]
ds_read_b128 a[152:155], v232 offset:3392
v_mfma_f32_16x16x32_bf16 v[8:11], v[176:179], v[76:79], v[8:11]
ds_read_b128 a[180:183], v241 offset:2048
s_waitcnt lgkmcnt(11)
v_mfma_f32_16x16x32_bf16 v[144:147], a[204:207], a[140:143], v[144:147]
ds_read_b128 a[252:255], v241 offset:2304
v_mfma_f32_16x16x32_bf16 v[148:151], a[236:239], a[140:143], v[148:151]
ds_read_b128 a[172:175], v240 offset:3392
s_waitcnt lgkmcnt(12)
v_mfma_f32_16x16x32_bf16 v[152:155], v[212:215], a[0:3], 0
ds_read_b128 a[156:159], v232 offset:3456
s_waitcnt lgkmcnt(12)
v_mfma_f32_16x16x32_bf16 v[156:159], v[216:219], a[0:3], 0
ds_read_b128 a[176:179], v240 offset:3456
v_mfma_f32_16x16x32_bf16 v[160:163], v[212:215], a[4:7], 0
ds_read_b128 a[140:143], v232 offset:3520
v_mfma_f32_16x16x32_bf16 v[164:167], v[216:219], a[4:7], 0
s_waitcnt lgkmcnt(13)
v_mfma_f32_16x16x32_bf16 v[4:7], a[36:39], a[160:163], v[4:7]
v_mfma_f32_16x16x32_bf16 v[8:11], a[68:71], a[160:163], v[8:11]
s_waitcnt lgkmcnt(12)
v_mfma_f32_16x16x32_bf16 v[144:147], a[200:203], a[144:147], v[144:147]
v_cvt_pk_bf16_f32 v168, v152, v153
v_cvt_pk_bf16_f32 v169, v154, v155
v_mfma_f32_16x16x32_bf16 v[148:151], a[232:235], a[144:147], v[148:151]
v_cvt_pk_bf16_f32 v170, v156, v157
v_cvt_pk_bf16_f32 v171, v158, v159
s_waitcnt lgkmcnt(11)
v_mfma_f32_16x16x32_bf16 v[4:7], a[32:35], a[164:167], v[4:7]
v_cvt_pk_bf16_f32 v172, v160, v161
v_cvt_pk_bf16_f32 v173, v162, v163
v_mfma_f32_16x16x32_bf16 v[8:11], a[64:67], a[164:167], v[8:11]
v_cvt_pk_bf16_f32 v174, v164, v165
v_cvt_pk_bf16_f32 v175, v166, v167
s_waitcnt lgkmcnt(10)
v_mfma_f32_16x16x32_bf16 v[144:147], a[196:199], a[148:151], v[144:147]
s_waitcnt lgkmcnt(7)
s_barrier
ds_read_b64_tr_b16 v[208:209], v200 offset:2560
ds_read_b64_tr_b16 v[210:211], v200 offset:19200
v_mfma_f32_16x16x32_bf16 v[148:151], a[228:231], a[148:151], v[148:151]
ds_read_b128 v[212:215], v233 offset:2560
v_mfma_f32_16x16x32_bf16 v[144:147], v[168:171], a[84:87], v[144:147]
ds_read_b128 v[216:219], v233 offset:2816
v_mfma_f32_16x16x32_bf16 v[148:151], v[168:171], a[88:91], v[148:151]
ds_read_b128 a[160:163], v240 offset:3520
v_mfma_f32_16x16x32_bf16 v[144:147], v[172:175], a[96:99], v[144:147]
ds_read_b128 a[144:147], v232 offset:3584
v_mfma_f32_16x16x32_bf16 v[148:151], v[172:175], a[100:103], v[148:151]
ds_read_b128 a[164:167], v240 offset:3584
v_mfma_f32_16x16x32_bf16 v[4:7], a[28:31], a[168:171], v[4:7]
ds_read_b128 a[148:151], v232 offset:3648
v_mfma_f32_16x16x32_bf16 v[8:11], a[60:63], a[168:171], v[8:11]
s_waitcnt lgkmcnt(13)
v_mfma_f32_16x16x32_bf16 v[152:155], a[180:183], a[0:3], 0
s_waitcnt lgkmcnt(12)
v_mfma_f32_16x16x32_bf16 v[156:159], a[252:255], a[0:3], 0
v_mfma_f32_16x16x32_bf16 v[144:147], a[192:195], a[152:155], v[144:147]
s_mov_b32 s74, 2949120
s_waitcnt lgkmcnt(6)
buffer_store_dwordx4 v[208:211], v201, s[20:23], s74 offen
v_mfma_f32_16x16x32_bf16 v[148:151], a[224:227], a[152:155], v[148:151]
ds_read_b128 a[168:171], v240 offset:3648
v_mfma_f32_16x16x32_bf16 v[160:163], a[180:183], a[4:7], 0
v_mfma_f32_16x16x32_bf16 v[164:167], a[252:255], a[4:7], 0
v_mfma_f32_16x16x32_bf16 v[4:7], a[24:27], a[172:175], v[4:7]
v_cvt_pk_bf16_f32 v176, v152, v153
v_cvt_pk_bf16_f32 v177, v154, v155
v_mfma_f32_16x16x32_bf16 v[8:11], a[56:59], a[172:175], v[8:11]
v_cvt_pk_bf16_f32 v178, v156, v157
v_cvt_pk_bf16_f32 v179, v158, v159
v_mfma_f32_16x16x32_bf16 v[144:147], a[188:191], a[156:159], v[144:147]
v_cvt_pk_bf16_f32 v180, v160, v161
v_cvt_pk_bf16_f32 v181, v162, v163
v_mfma_f32_16x16x32_bf16 v[148:151], a[220:223], a[156:159], v[148:151]
v_cvt_pk_bf16_f32 v182, v164, v165
v_cvt_pk_bf16_f32 v183, v166, v167
v_mfma_f32_16x16x32_bf16 v[4:7], a[20:23], a[176:179], v[4:7]
ds_read_b128 a[152:155], v232 offset:3712
v_mfma_f32_16x16x32_bf16 v[8:11], a[52:55], a[176:179], v[8:11]
ds_read_b128 a[180:183], v241 offset:2560
v_mfma_f32_16x16x32_bf16 v[4:7], v[176:179], v[32:35], v[4:7]
ds_read_b128 a[252:255], v241 offset:2816
v_mfma_f32_16x16x32_bf16 v[8:11], v[176:179], v[36:39], v[8:11]
ds_read_b128 a[172:175], v240 offset:3712
v_mfma_f32_16x16x32_bf16 v[144:147], a[184:187], a[140:143], v[144:147]
ds_read_b128 a[156:159], v232 offset:3776
v_mfma_f32_16x16x32_bf16 v[148:151], a[216:219], a[140:143], v[148:151]
ds_read_b128 a[176:179], v240 offset:3776
s_waitcnt lgkmcnt(12)
v_mfma_f32_16x16x32_bf16 v[152:155], v[212:215], a[0:3], 0
s_waitcnt lgkmcnt(11)
v_mfma_f32_16x16x32_bf16 v[156:159], v[216:219], a[0:3], 0
v_mfma_f32_16x16x32_bf16 v[4:7], v[180:183], v[44:47], v[4:7]
v_mfma_f32_16x16x32_bf16 v[8:11], v[180:183], v[48:51], v[8:11]
v_mfma_f32_16x16x32_bf16 v[160:163], v[212:215], a[4:7], 0
ds_read_b128 a[140:143], v232 offset:3840
v_mfma_f32_16x16x32_bf16 v[164:167], v[216:219], a[4:7], 0
s_waitcnt lgkmcnt(11)
v_mfma_f32_16x16x32_bf16 v[4:7], a[16:19], a[160:163], v[4:7]
v_mfma_f32_16x16x32_bf16 v[8:11], a[48:51], a[160:163], v[8:11]
s_waitcnt lgkmcnt(10)
v_mfma_f32_16x16x32_bf16 v[148:151], a[212:215], a[144:147], v[148:151]
v_cvt_pk_bf16_f32 v168, v152, v153
v_cvt_pk_bf16_f32 v169, v154, v155
s_waitcnt lgkmcnt(9)
v_mfma_f32_16x16x32_bf16 v[8:11], a[44:47], a[164:167], v[8:11]
v_cvt_pk_bf16_f32 v170, v156, v157
v_cvt_pk_bf16_f32 v171, v158, v159
s_waitcnt lgkmcnt(8)
v_mfma_f32_16x16x32_bf16 v[148:151], a[208:211], a[148:151], v[148:151]
v_cvt_pk_bf16_f32 v172, v160, v161
v_cvt_pk_bf16_f32 v173, v162, v163
v_mfma_f32_16x16x32_bf16 v[148:151], v[168:171], a[84:87], v[148:151]
v_cvt_pk_bf16_f32 v174, v164, v165
v_cvt_pk_bf16_f32 v175, v166, v167
s_nop 1
v_mfma_f32_16x16x32_bf16 v[148:151], v[172:175], a[96:99], v[148:151]
v_cvt_pk_bf16_f32 v188, v144, v145
v_cvt_pk_bf16_f32 v189, v146, v147
s_waitcnt lgkmcnt(7)
v_mfma_f32_16x16x32_bf16 v[8:11], a[40:43], a[168:171], v[8:11]
ds_write_b64 v235, v[188:189] offset:3072
s_waitcnt lgkmcnt(6)
v_mfma_f32_16x16x32_bf16 v[152:155], a[180:183], a[0:3], 0
ds_read_b128 a[160:163], v240 offset:3840
v_cvt_pk_bf16_f32 v190, v4, v5
s_waitcnt lgkmcnt(6)
v_mfma_f32_16x16x32_bf16 v[156:159], a[252:255], a[0:3], 0
v_cvt_pk_bf16_f32 v191, v6, v7
ds_read_b128 a[144:147], v232 offset:3904
v_mfma_f32_16x16x32_bf16 v[148:151], a[204:207], a[152:155], v[148:151]
ds_write_b64 v243, v[190:191] offset:3072
v_mfma_f32_16x16x32_bf16 v[160:163], a[180:183], a[4:7], 0
ds_read_b128 a[164:167], v240 offset:3904
v_mfma_f32_16x16x32_bf16 v[164:167], a[252:255], a[4:7], 0
ds_read_b128 a[148:151], v232 offset:3968
s_waitcnt lgkmcnt(9)
v_mfma_f32_16x16x32_bf16 v[8:11], a[36:39], a[172:175], v[8:11]
v_cvt_pk_bf16_f32 v176, v152, v153
v_cvt_pk_bf16_f32 v177, v154, v155
s_waitcnt lgkmcnt(8)
v_mfma_f32_16x16x32_bf16 v[148:151], a[200:203], a[156:159], v[148:151]
v_cvt_pk_bf16_f32 v178, v156, v157
v_cvt_pk_bf16_f32 v179, v158, v159
s_waitcnt lgkmcnt(7)
v_mfma_f32_16x16x32_bf16 v[8:11], a[32:35], a[176:179], v[8:11]
v_cvt_pk_bf16_f32 v180, v160, v161
v_cvt_pk_bf16_f32 v181, v162, v163
v_mfma_f32_16x16x32_bf16 v[8:11], v[176:179], v[32:35], v[8:11]
v_cvt_pk_bf16_f32 v182, v164, v165
v_cvt_pk_bf16_f32 v183, v166, v167
s_waitcnt lgkmcnt(6)
v_mfma_f32_16x16x32_bf16 v[148:151], a[196:199], a[140:143], v[148:151]
ds_read_b128 a[168:171], v240 offset:3968
v_mfma_f32_16x16x32_bf16 v[8:11], v[180:183], v[44:47], v[8:11]
s_waitcnt lgkmcnt(3)
s_barrier
ds_read_b64_tr_b16 v[204:205], v200 offset:3072
ds_read_b64_tr_b16 v[206:207], v200 offset:19712
v_mfma_f32_16x16x32_bf16 v[8:11], a[28:31], a[160:163], v[8:11]
ds_read_b128 a[152:155], v232 offset:4032
v_mfma_f32_16x16x32_bf16 v[148:151], a[192:195], a[144:147], v[148:151]
ds_read_b128 a[172:175], v240 offset:4032
s_waitcnt lgkmcnt(6)
v_mfma_f32_16x16x32_bf16 v[8:11], a[24:27], a[164:167], v[8:11]
s_mov_b32 s74, 3538944
s_waitcnt lgkmcnt(2)
buffer_store_dwordx4 v[204:207], v201, s[20:23], s74 offen
v_mfma_f32_16x16x32_bf16 v[148:151], a[188:191], a[148:151], v[148:151]
v_mfma_f32_16x16x32_bf16 v[8:11], a[20:23], a[168:171], v[8:11]
s_waitcnt lgkmcnt(1)
v_mfma_f32_16x16x32_bf16 v[148:151], a[184:187], a[152:155], v[148:151]
s_waitcnt lgkmcnt(0)
v_mfma_f32_16x16x32_bf16 v[8:11], a[16:19], a[172:175], v[8:11]
s_nop 5
v_cvt_pk_bf16_f32 v188, v148, v149
v_cvt_pk_bf16_f32 v189, v150, v151
ds_write_b64 v235, v[188:189] offset:3584
v_cvt_pk_bf16_f32 v190, v8, v9
v_cvt_pk_bf16_f32 v191, v10, v11
ds_write_b64 v243, v[190:191] offset:3584
s_waitcnt lgkmcnt(0)
s_barrier
ds_read_b64_tr_b16 v[208:209], v200 offset:3584
ds_read_b64_tr_b16 v[210:211], v200 offset:20224
s_mov_b32 s74, 4128768
s_waitcnt lgkmcnt(0)
buffer_store_dwordx4 v[208:211], v201, s[20:23], s74 offen
s_endpgm
L_SPARE:
s_lshl_b32 s70, s74, 2
s_add_u32 s70, s70, s33
s_sub_u32 s70, s70, 12
s_mov_b32 s12, s42
s_mov_b32 s13, s43
s_mov_b32 s14, 1990656
s_mov_b32 s15, 0x20000
s_mov_b32 s24, s44
s_mov_b32 s25, s45
s_mov_b32 s26, 663552
s_mov_b32 s27, 0x20000
v_mul_u32_u24 v244, 3456, v1
v_lshlrev_b32 v245, 7, v1
s_lshl_b32 s34, s70, 2
s_add_u32 s34, s34, s68
s_add_u32 s34, s34, 0
s_cmp_ge_u32 s34, 81
s_cbranch_scc1 L_FP15889
s_mul_i32 s35, s34, 7282
s_lshr_b32 s35, s35, 16
s_mul_i32 s35, s35, 1719
s_add_u32 s35, s35, s34
s_lshl_b32 s35, s35, 7
buffer_load_dword v252, v244, s[12:15], s35 offen
s_branch L_FQ15889
L_FP15889:
s_sub_u32 s35, s34, 81
s_lshl_b32 s35, s35, 13
buffer_load_dword v252, v245, s[24:27], s35 offen
L_FQ15889:
s_waitcnt vmcnt(0)
s_lshl_b32 s34, s70, 2
s_add_u32 s34, s34, s68
s_add_u32 s34, s34, 32
s_cmp_ge_u32 s34, 81
s_cbranch_scc1 L_FP15907
s_mul_i32 s35, s34, 7282
s_lshr_b32 s35, s35, 16
s_mul_i32 s35, s35, 1719
s_add_u32 s35, s35, s34
s_lshl_b32 s35, s35, 7
buffer_load_dword v252, v244, s[12:15], s35 offen
s_branch L_FQ15907
L_FP15907:
s_sub_u32 s35, s34, 81
s_lshl_b32 s35, s35, 13
buffer_load_dword v252, v245, s[24:27], s35 offen
L_FQ15907:
s_waitcnt vmcnt(0)
s_add_u32 s16, s50, 0
s_addc_u32 s17, s51, 0
s_mov_b32 s18, 540672
s_mov_b32 s19, 0x20000
s_add_u32 s20, s50, 0
s_addc_u32 s21, s51, 0
s_mov_b32 s22, 2899968
s_mov_b32 s23, 0x20000
s_mov_b32 s24, s48
s_mov_b32 s25, s49
s_mov_b32 s26, 256
s_mov_b32 s27, 0x20000
v_mov_b32 v192, -1
v_mov_b32 v193, -1
v_mov_b32 v194, -1
v_mov_b32 v195, -1
v_mov_b32 v25, 1
v_mov_b32 v26, 0
s_lshl_b32 s76, s70, 2
s_add_u32 s76, s76, s68
s_mul_i32 s74, s76, 17408
s_add_u32 s74, s74, 0
s_add_u32 s75, s74, 17408
L_FILL0:
buffer_store_dwordx4 v[192:195], v27, s[16:19], s74 offen sc1
s_add_u32 s74, s74, 1024
s_cmp_lt_u32 s74, s75
s_cbranch_scc1 L_FILL0
s_waitcnt vmcnt(0)
s_barrier
s_cmp_lg_u32 s68, 0
s_cbranch_scc1 L_FILLED0
s_mov_b64 exec, 1
buffer_atomic_add v25, v26, s[24:27], 0 offen offset:0 sc1
s_mov_b64 exec, -1
L_FILLED0:
s_mul_i32 s74, s76, 36864
s_add_u32 s74, s74, 540672
s_add_u32 s75, s74, 36864
L_FILL1:
buffer_store_dwordx4 v[192:195], v27, s[20:23], s74 offen sc1
s_add_u32 s74, s74, 1024
s_cmp_lt_u32 s74, s75
s_cbranch_scc1 L_FILL1
s_waitcnt vmcnt(0)
s_barrier
s_cmp_lg_u32 s68, 0
s_cbranch_scc1 L_FILLED1
s_mov_b64 exec, 1
buffer_atomic_add v25, v26, s[24:27], 0 offen offset:128 sc1
s_mov_b64 exec, -1
L_FILLED1:
s_endpgm
L_END:
s_endpgm
.p2align 7
.type L_TABB,@object
L_TABB:
.long 0x40000000, 0x300, 0x24000, 0x3, 0x40000000, 0x310, 0x24060, 0x3
.long 0x40000000, 0x320, 0x240c0, 0x3, 0x40000000, 0x330, 0x24120, 0x3
.long 0x0, 0x340, 0x24180, 0x3, 0x10, 0x350, 0x241e0, 0x3
.long 0x20, 0x40000000, 0x24240, 0x3, 0x30, 0x40000000, 0x242a0, 0x3
.long 0x40, 0x40000000, 0x24300, 0x3, 0x50, 0x40000000, 0x24360, 0x3
.long 0x60, 0x40000000, 0x243c0, 0x3, 0x70, 0x40000000, 0x24420, 0x3
.long 0x80, 0x40000000, 0x24008, 0x3, 0x90, 0x40000000, 0x24068, 0x3
.long 0xa0, 0x40000000, 0x240c8, 0x3, 0xb0, 0x40000000, 0x24128, 0x3
.long 0x40000000, 0x360, 0x24188, 0x3, 0x40000000, 0x370, 0x241e8, 0x3
.long 0x40000000, 0x380, 0x24248, 0x3, 0x40000000, 0x390, 0x242a8, 0x3
.long 0xc0, 0x3a0, 0x24308, 0x3, 0xd0, 0x3b0, 0x24368, 0x3
.long 0xe0, 0x40000000, 0x243c8, 0x3, 0xf0, 0x40000000, 0x24428, 0x3
.long 0x100, 0x40000000, 0x24010, 0x3, 0x110, 0x40000000, 0x24070, 0x3
.long 0x120, 0x40000000, 0x240d0, 0x3, 0x130, 0x40000000, 0x24130, 0x3
.long 0x140, 0x40000000, 0x24190, 0x3, 0x150, 0x40000000, 0x241f0, 0x3
.long 0x160, 0x40000000, 0x24250, 0x3, 0x170, 0x40000000, 0x242b0, 0x3
.long 0x40000000, 0x3c0, 0x24310, 0x3, 0x40000000, 0x3d0, 0x24370, 0x3
.long 0x40000000, 0x3e0, 0x243d0, 0x3, 0x40000000, 0x3f0, 0x24430, 0x3
.long 0x180, 0x400, 0x24018, 0x3, 0x190, 0x410, 0x24078, 0x3
.long 0x1a0, 0x40000000, 0x240d8, 0x3, 0x1b0, 0x40000000, 0x24138, 0x3
.long 0x1c0, 0x40000000, 0x24198, 0x3, 0x1d0, 0x40000000, 0x241f8, 0x3
.long 0x1e0, 0x40000000, 0x24258, 0x3, 0x1f0, 0x40000000, 0x242b8, 0x3
.long 0x200, 0x40000000, 0x24318, 0x3, 0x210, 0x40000000, 0x24378, 0x3
.long 0x220, 0x40000000, 0x243d8, 0x3, 0x230, 0x40000000, 0x24438, 0x3
.long 0x40000000, 0x420, 0x24480, 0x3, 0x40000000, 0x430, 0x244e0, 0x3
.long 0x40000000, 0x440, 0x24540, 0x3, 0x40000000, 0x450, 0x245a0, 0x3
.long 0x240, 0x460, 0x24600, 0x3, 0x250, 0x470, 0x24660, 0x3
.long 0x260, 0x40000000, 0x24488, 0x3, 0x270, 0x40000000, 0x244e8, 0x3
.long 0x280, 0x40000000, 0x24548, 0x3, 0x290, 0x40000000, 0x245a8, 0x3
.long 0x2a0, 0x40000000, 0x24608, 0x3, 0x2b0, 0x40000000, 0x24668, 0x3
.long 0x2c0, 0x40000000, 0x24490, 0x3, 0x2d0, 0x40000000, 0x244f0, 0x3
.long 0x2e0, 0x40000000, 0x24550, 0x3, 0x2f0, 0x40000000, 0x245b0, 0x3
.long 0x40000000, 0x4c0, 0x24610, 0x3, 0x40000000, 0x4d0, 0x24670, 0x3
.long 0x40000000, 0x4e0, 0x24498, 0x3, 0x40000000, 0x4f0, 0x244f8, 0x3
.long 0x40000000, 0x500, 0x24558, 0x3, 0x40000000, 0x510, 0x245b8, 0x3
.long 0x40000000, 0x520, 0x24618, 0x3, 0x40000000, 0x530, 0x24678, 0x3
.long 0x480, 0x540, 0x24d80, 0x3, 0x40000000, 0x550, 0x24d88, 0x3
.long 0x40000000, 0x40000000, 0x24d90, 0x3, 0x40000000, 0x40000000, 0x24d98, 0x3
.long 0x40000000, 0x40000000, 0x24aa0, 0x2, 0x40000000, 0x40000000, 0x24b00, 0x2
.long 0x40000000, 0x40000000, 0x24b60, 0x2, 0x40000000, 0x40000000, 0x24bc0, 0x2
.long 0x40000000, 0x560, 0x24c20, 0x2, 0x40000000, 0x570, 0x24c80, 0x2
.long 0x40000000, 0x580, 0x24ce0, 0x2, 0x40000000, 0x590, 0x24d40, 0x2
.long 0x40000000, 0x5a0, 0x24da0, 0x1, 0x40000000, 0x5b0, 0x24e00, 0x2
.long 0x40000000, 0x5c0, 0x24aa8, 0x3, 0x40000000, 0x5d0, 0x24b08, 0x3
.long 0x490, 0x40000000, 0x24b68, 0x3, 0x40000000, 0x5e0, 0x24bc8, 0x3
.long 0x40000000, 0x40000000, 0x24c28, 0x3, 0x40000000, 0x40000000, 0x24c88, 0x3
.long 0x40000000, 0x40000000, 0x24ce8, 0x3, 0x40000000, 0x40000000, 0x24d48, 0x3
.long 0x40000000, 0x40000000, 0x24e08, 0x3, 0x40000000, 0x40000000, 0x24ab0, 0x3
.long 0x40000000, 0x5f0, 0x24b10, 0x3, 0x40000000, 0x600, 0x24b70, 0x3
.long 0x40000000, 0x610, 0x24bd0, 0x3, 0x40000000, 0x620, 0x24c30, 0x3
.long 0x40000000, 0x630, 0x24c90, 0x3, 0x40000000, 0x640, 0x24cf0, 0x3
.long 0x40000000, 0x650, 0x24d50, 0x3, 0x40000000, 0x660, 0x24e10, 0x3
.long 0x4a0, 0x40000000, 0x24ab8, 0x3, 0x40000000, 0x670, 0x24b18, 0x3
.long 0x40000000, 0x40000000, 0x24b78, 0x3, 0x40000000, 0x40000000, 0x24bd8, 0x3
.long 0x40000000, 0x40000000, 0x24c38, 0x3, 0x40000000, 0x40000000, 0x24c98, 0x3
.long 0x40000000, 0x40000000, 0x24cf8, 0x3, 0x40000000, 0x40000000, 0x24d58, 0x3
.long 0x40000000, 0x680, 0x24e18, 0x3, 0x40000000, 0x690, 0x24020, 0x1
.long 0x40000000, 0x6a0, 0x24080, 0x1, 0x40000000, 0x6b0, 0x240e0, 0x1
.long 0x40000000, 0x6c0, 0x24140, 0x1, 0x40000000, 0x6d0, 0x241a0, 0x1
.long 0x40000000, 0x6e0, 0x24200, 0x1, 0x40000000, 0x6f0, 0x24260, 0x1
.long 0x4b0, 0x40000000, 0x242c0, 0x1, 0x40000000, 0x700, 0x24320, 0x1
.long 0x40000000, 0x40000000, 0x24380, 0x1, 0x40000000, 0x40000000, 0x243e0, 0x1
.long 0x40000000, 0x40000000, 0x24440, 0x1, 0x40000000, 0x40000000, 0x244a0, 0x1
.long 0x40000000, 0x40000000, 0x24500, 0x1, 0x40000000, 0x40000000, 0x24560, 0x1
.long 0x40000000, 0x7d0, 0x245c0, 0x1, 0x40000000, 0x7e0, 0x24620, 0x1
.long 0x40000000, 0x7f0, 0x24680, 0x1, 0x40000000, 0x800, 0x246e0, 0x2
.long 0x710, 0x810, 0x24740, 0x2, 0x720, 0x820, 0x247a0, 0x2
.long 0x730, 0x830, 0x24800, 0x2, 0x740, 0x840, 0x24860, 0x2
.long 0x750, 0x850, 0x248c0, 0x2, 0x760, 0x860, 0x24920, 0x2
.long 0x770, 0x870, 0x24980, 0x2, 0x780, 0x880, 0x249e0, 0x2
.long 0x790, 0x890, 0x24a40, 0x2, 0x7a0, 0x8a0, 0x246e8, 0x3
.long 0x7b0, 0x8b0, 0x24748, 0x3, 0x7c0, 0x8c0, 0x247a8, 0x3
.long 0x40000000, 0x40000000, 0x24808, 0x3, 0x40000000, 0x40000000, 0x24868, 0x3
.long 0x40000000, 0x40000000, 0x248c8, 0x3, 0x40000000, 0x40000000, 0x24928, 0x3
.long 0x40000000, 0x40000000, 0x24988, 0x3, 0x40000000, 0x40000000, 0x249e8, 0x3
.long 0x40000000, 0x8d0, 0x24a48, 0x3, 0x40000000, 0x8e0, 0x246f0, 0x3
.long 0x40000000, 0x8f0, 0x24750, 0x3, 0x40000000, 0x900, 0x247b0, 0x3
.long 0x40000000, 0x910, 0x24810, 0x3, 0x40000000, 0x920, 0x24870, 0x3
.long 0x40000000, 0x930, 0x248d0, 0x3, 0x40000000, 0x940, 0x24930, 0x3
.long 0x40000000, 0x950, 0x24990, 0x3, 0x40000000, 0x960, 0x249f0, 0x3
.long 0x40000000, 0x40000000, 0x24a50, 0x3, 0x40000000, 0x40000000, 0x246f8, 0x3
.long 0x40000000, 0x40000000, 0x24758, 0x3, 0x40000000, 0x40000000, 0x247b8, 0x3
.long 0x40000000, 0x40000000, 0x24818, 0x3, 0x40000000, 0x40000000, 0x24878, 0x3
.long 0x40000000, 0x970, 0x248d8, 0x3, 0x40000000, 0x980, 0x24938, 0x3
.long 0x40000000, 0x990, 0x24998, 0x3, 0x40000000, 0x9a0, 0x249f8, 0x3
.long 0x40000000, 0x9b0, 0x24a58, 0x3, 0x40000000, 0x9c0, 0x24700, 0x3
.long 0x40000000, 0x9d0, 0x24760, 0x3, 0x40000000, 0x9e0, 0x247c0, 0x3
.long 0x40000000, 0x9f0, 0x24820, 0x3, 0x40000000, 0xa00, 0x24880, 0x3
.long 0x40000000, 0x40000000, 0x248e0, 0x3, 0x40000000, 0x40000000, 0x24940, 0x3
.long 0x40000000, 0x40000000, 0x249a0, 0x3, 0x40000000, 0x40000000, 0x24a00, 0x3
.long 0x40000000, 0x40000000, 0x24a60, 0x3, 0x40000000, 0x40000000, 0x24ac0, 0x3
.long 0x40000000, 0xa10, 0x24b20, 0x3, 0x40000000, 0xa20, 0x24b80, 0x3
.long 0x40000000, 0xa30, 0x24be0, 0x3, 0x40000000, 0xa40, 0x24c40, 0x3
.long 0x40000000, 0xa50, 0x24ca0, 0x3, 0x40000000, 0xa60, 0x24d00, 0x3
.long 0x40000000, 0xa70, 0x24d60, 0x3, 0x40000000, 0xa80, 0x24e20, 0x3
.long 0x40000000, 0xa90, 0x25200, 0x0, 0x40000000, 0xaa0, 0x25208, 0x0
.long 0x40000000, 0xb50, 0x25210, 0x0, 0x40000000, 0xb60, 0x25218, 0x0
.long 0x40000000, 0xb70, 0x25220, 0x0, 0x40000000, 0xb80, 0x25228, 0x0
.long 0x40000000, 0xb90, 0x25230, 0x0, 0x40000000, 0xba0, 0x25238, 0x0
.long 0xab0, 0xbb0, 0x25240, 0x0, 0xac0, 0xbc0, 0x25248, 0x0
.long 0xad0, 0x40000000, 0x25250, 0x0, 0xae0, 0xbd0, 0x25258, 0x0
.long 0xaf0, 0x40000000, 0x25260, 0x0, 0xb00, 0x40000000, 0x25268, 0x0
.long 0xb10, 0x40000000, 0x25270, 0x0, 0xb20, 0x40000000, 0x25278, 0x0
.long 0xb30, 0x40000000, 0x25280, 0x0, 0xb40, 0x40000000, 0x25288, 0x0
.long 0x40000000, 0x40000000, 0x25290, 0x0, 0x40000000, 0x40000000, 0x25298, 0x0
.long 0x40000000, 0x40000000, 0x252a0, 0x0, 0x40000000, 0x40000000, 0x252a8, 0x0
.long 0x40000000, 0x40000000, 0x252b0, 0x0, 0x40000000, 0x40000000, 0x252b8, 0x0
.long 0x40000000, 0x40000000, 0x252c0, 0x0, 0x40000000, 0x40000000, 0x252c8, 0x0
.long 0x40000000, 0x40000000, 0x252d0, 0x0, 0x40000000, 0x40000000, 0x252d8, 0x0
.long 0x40000000, 0x40000000, 0x252e0, 0x0, 0x40000000, 0x40000000, 0x252e8, 0x0
.long 0x40000000, 0x40000000, 0x252f0, 0x0, 0x40000000, 0x40000000, 0x252f8, 0x0
.long 0x40000000, 0x40000000, 0x25300, 0x0, 0x40000000, 0x40000000, 0x25308, 0x0
.long 0x40000000, 0x40000000, 0x25310, 0x0, 0x40000000, 0x40000000, 0x25318, 0x0
.long 0x40000000, 0x40000000, 0x25320, 0x0, 0x40000000, 0x40000000, 0x25328, 0x0
.long 0x40000000, 0x40000000, 0x25330, 0x0, 0x40000000, 0x40000000, 0x25338, 0x0
.long 0x40000000, 0x40000000, 0x25340, 0x0, 0x40000000, 0x40000000, 0x25348, 0x0
.long 0x40000000, 0x40000000, 0x25350, 0x0, 0x40000000, 0x40000000, 0x25358, 0x0
.long 0x40000000, 0x40000000, 0x25360, 0x0, 0x40000000, 0x40000000, 0x25368, 0x0
.long 0x40000000, 0x40000000, 0x25370, 0x0, 0x40000000, 0x40000000, 0x25378, 0x0
.long 0x40000000, 0x40000000, 0x25380, 0x0, 0x40000000, 0x40000000, 0x25388, 0x0
.long 0x40000000, 0x40000000, 0x25390, 0x0, 0x40000000, 0x40000000, 0x25398, 0x0
.long 0x40000000, 0x40000000, 0x253a0, 0x0, 0x40000000, 0x40000000, 0x253a8, 0x0
.long 0x40000000, 0x40000000, 0x253b0, 0x0, 0x40000000, 0x40000000, 0x253b8, 0x0
.long 0x40000000, 0x40000000, 0x253c0, 0x0, 0x40000000, 0x40000000, 0x253c8, 0x0
.long 0x40000000, 0x40000000, 0x253d0, 0x0, 0x40000000, 0x40000000, 0x253d8, 0x0
.long 0x40000000, 0x40000000, 0x253e0, 0x0, 0x40000000, 0x40000000, 0x253e8, 0x0
.long 0x40000000, 0x40000000, 0x253f0, 0x0, 0x40000000, 0x40000000, 0x253f8, 0x0
.long 0x40000000, 0x40000000, 0x25400, 0x0, 0x40000000, 0x40000000, 0x25408, 0x0
.size L_TABB, 4096
.p2align 7
.type L_TABA,@object
L_TABA:
.long 0x0, 0x0, 0x0, 0x0, 0x210, 0x0, 0x0, 0x0
.long 0x420, 0x0, 0x0, 0x0, 0x630, 0x0, 0x0, 0x0
.long 0x840, 0x0, 0x0, 0x0, 0xa50, 0x0, 0x0, 0x0
.long 0xc60, 0x0, 0x0, 0x0, 0xe70, 0x0, 0x0, 0x0
.long 0x840, 0x0, 0x0, 0x0, 0x1290, 0x0, 0x0, 0x0
.long 0x14a0, 0x0, 0x0, 0x0, 0x16b0, 0x0, 0x0, 0x0
.long 0x1080, 0x0, 0x0, 0x0, 0x16b0, 0x0, 0x0, 0x0
.long 0x18c0, 0x0, 0x0, 0x0, 0x1ad0, 0x0, 0x0, 0x0
.long 0x1ce0, 0x0, 0x0, 0x0, 0x1ef0, 0x0, 0x0, 0x0
.long 0x2520, 0x0, 0x0, 0x0, 0x2730, 0x0, 0x0, 0x0
.long 0x2100, 0x0, 0x0, 0x0, 0x2310, 0x0, 0x0, 0x0
.long 0x2940, 0x0, 0x0, 0x0, 0x2b50, 0x0, 0x0, 0x0
.long 0x0, 0x0, 0x0, 0x0, 0x0, 0x0, 0x0, 0x0
.long 0x0, 0x0, 0x0, 0x0, 0x0, 0x0, 0x0, 0x0
.long 0x0, 0x0, 0x0, 0x0, 0x0, 0x0, 0x0, 0x0
.long 0x0, 0x0, 0x0, 0x0, 0x0, 0x0, 0x0, 0x0
.long 0x10, 0x0, 0x0, 0x0, 0x220, 0x0, 0x0, 0x0
.long 0x430, 0x0, 0x0, 0x0, 0x640, 0x0, 0x0, 0x0
.long 0x850, 0x0, 0x0, 0x0, 0xa60, 0x0, 0x0, 0x0
.long 0xc70, 0x0, 0x0, 0x0, 0xe80, 0x0, 0x0, 0x0
.long 0x850, 0x0, 0x0, 0x0, 0x12a0, 0x0, 0x0, 0x0
.long 0x14b0, 0x0, 0x0, 0x0, 0x16c0, 0x0, 0x0, 0x0
.long 0x1090, 0x0, 0x0, 0x0, 0x16c0, 0x0, 0x0, 0x0
.long 0x18d0, 0x0, 0x0, 0x0, 0x1ae0, 0x0, 0x0, 0x0
.long 0x1cf0, 0x0, 0x0, 0x0, 0x1f00, 0x0, 0x0, 0x0
.long 0x2530, 0x0, 0x0, 0x0, 0x2740, 0x0, 0x0, 0x0
.long 0x2110, 0x0, 0x0, 0x0, 0x2320, 0x0, 0x0, 0x0
.long 0x2950, 0x0, 0x0, 0x0, 0x2b60, 0x0, 0x0, 0x0
.long 0x10, 0x0, 0x0, 0x0, 0x10, 0x0, 0x0, 0x0
.long 0x10, 0x0, 0x0, 0x0, 0x10, 0x0, 0x0, 0x0
.long 0x10, 0x0, 0x0, 0x0, 0x10, 0x0, 0x0, 0x0
.long 0x10, 0x0, 0x0, 0x0, 0x10, 0x0, 0x0, 0x0
.long 0x0, 0x0, 0x0, 0x0, 0x0, 0x0, 0x0, 0x0
.long 0x0, 0x0, 0x0, 0x0, 0x0, 0x0, 0x0, 0x0
.long 0x0, 0x0, 0x0, 0x0, 0x0, 0x0, 0x0, 0x0
.long 0x0, 0x0, 0x0, 0x0, 0x0, 0x0, 0x0, 0x0
.long 0x0, 0x0, 0x0, 0x0, 0x0, 0x0, 0x0, 0x0
.long 0x0, 0x0, 0x0, 0x0, 0x0, 0x0, 0x0, 0x0
.long 0x0, 0x0, 0x0, 0x0, 0x0, 0x0, 0x0, 0x0
.long 0x0, 0x0, 0x0, 0x0, 0x0, 0x0, 0x0, 0x0
.long 0x0, 0x0, 0xffffffff, 0x0, 0x0, 0x0, 0xffff0000, 0xffff
.long 0x0, 0x0, 0x0, 0xffffffff, 0x0, 0x0, 0x0, 0xffff0000
.long 0x0, 0x0, 0x0, 0x0, 0x0, 0x0, 0x0, 0x0
.long 0x0, 0x0, 0x0, 0x0, 0x0, 0x0, 0x0, 0x0
.long 0x0, 0x0, 0x0, 0x0, 0x0, 0x0, 0x0, 0x0
.long 0x0, 0x0, 0x0, 0x0, 0x0, 0x0, 0x0, 0x0
.long 0x0, 0x0, 0x0, 0x0, 0x0, 0x0, 0x0, 0x0
.long 0x0, 0x0, 0x0, 0x0, 0x0, 0x0, 0x0, 0x0
.long 0x0, 0x0, 0x0, 0x0, 0x0, 0x0, 0x0, 0x0
.long 0x0, 0x0, 0x0, 0x0, 0xffff, 0x0, 0x0, 0x0
.long 0xffffffff, 0x0, 0x0, 0x0, 0xffff0000, 0xffff, 0x0, 0x0
.long 0x0, 0xffffffff, 0x0, 0x0, 0x0, 0xffff0000, 0xffff, 0x0
.long 0x0, 0x0, 0xffffffff, 0x0, 0x0, 0x0, 0xffff0000, 0xffff
.long 0x0, 0x0, 0x0, 0xffffffff, 0x0, 0x0, 0x0, 0xffff0000
.long 0x0, 0x0, 0x0, 0x0, 0x0, 0x0, 0x0, 0x0
.long 0x0, 0x0, 0x0, 0x0, 0x0, 0x0, 0x0, 0x0
.long 0x0, 0x0, 0x0, 0x0, 0x0, 0x0, 0x0, 0x0
.long 0x0, 0x0, 0x0, 0x0, 0x0, 0x0, 0x0, 0x0
.long 0x0, 0x0, 0x0, 0x0, 0x0, 0x0, 0x0, 0x0
.long 0x0, 0x0, 0x0, 0x0, 0x0, 0x0, 0x0, 0x0
.long 0x0, 0x0, 0x0, 0x0, 0x0, 0x0, 0x0, 0x0
.long 0x0, 0x0, 0x0, 0x0, 0xffff, 0x0, 0x0, 0x0
.long 0xffffffff, 0x0, 0x0, 0x0, 0xffff0000, 0xffff, 0x0, 0x0
.long 0x0, 0xffffffff, 0x0, 0x0, 0x0, 0xffff0000, 0xffff, 0x0
.long 0x0, 0x0, 0x0, 0x3f803f80, 0x0, 0x0, 0x0, 0x3f800000
.long 0x0, 0x0, 0x0, 0x0, 0x0, 0x0, 0x0, 0x0
.long 0x0, 0x0, 0x0, 0x0, 0x0, 0x0, 0x0, 0x0
.long 0x0, 0x0, 0x0, 0x0, 0x0, 0x0, 0x0, 0x0
.long 0x0, 0x0, 0x0, 0x0, 0x0, 0x0, 0x0, 0x0
.long 0x0, 0x0, 0x0, 0x0, 0x0, 0x0, 0x0, 0x0
.long 0x0, 0x0, 0x0, 0x0, 0x0, 0x0, 0x0, 0x0
.long 0x0, 0x0, 0x0, 0x0, 0x0, 0x0, 0x0, 0x0
.long 0x3f803f80, 0x3f80, 0x0, 0x0, 0x3f803f80, 0x3f803f80, 0x0, 0x0
.long 0x3f803f80, 0x3f803f80, 0x3f80, 0x0, 0x3f800000, 0x3f803f80, 0x3f803f80, 0x0
.long 0x0, 0x3f803f80, 0x3f803f80, 0x3f80, 0x0, 0x3f800000, 0x3f803f80, 0x3f803f80
.long 0x0, 0x0, 0x3f803f80, 0x3f803f80, 0x0, 0x0, 0x3f800000, 0x3f803f80
.long 0x0, 0x0, 0x0, 0x3f803f80, 0x0, 0x0, 0x0, 0x3f800000
.long 0x0, 0x0, 0x0, 0x0, 0x0, 0x0, 0x0, 0x0
.long 0x0, 0x0, 0x0, 0x0, 0x0, 0x0, 0x0, 0x0
.long 0x0, 0x0, 0x0, 0x0, 0x0, 0x0, 0x0, 0x0
.long 0x0, 0x0, 0x0, 0x0, 0x0, 0x0, 0x0, 0x0
.long 0x0, 0x0, 0x0, 0x0, 0x0, 0x0, 0x0, 0x0
.long 0x0, 0x0, 0x0, 0x0, 0x0, 0x0, 0x0, 0x0
.long 0x3f80, 0x0, 0x0, 0x0, 0x3f803f80, 0x0, 0x0, 0x0
.long 0x3f803f80, 0x3f80, 0x0, 0x0, 0x3f803f80, 0x3f803f80, 0x0, 0x0
.long 0x3f803f80, 0x3f803f80, 0x3f80, 0x0, 0x3f800000, 0x3f803f80, 0x3f803f80, 0x0
.long 0x0, 0x3f803f80, 0x3f803f80, 0x3f80, 0x0, 0x3f800000, 0x3f803f80, 0x3f803f80
.long 0x0, 0x0, 0x3f803f80, 0x3f803f80, 0x0, 0x0, 0x3f800000, 0x3f803f80
.long 0x0, 0x0, 0x0, 0x0, 0x0, 0x0, 0x0, 0x0
.long 0x0, 0x0, 0x0, 0x0, 0x0, 0x0, 0x0, 0x0
.long 0x0, 0x0, 0x0, 0x0, 0x0, 0x0, 0x0, 0x0
.long 0x0, 0x0, 0x0, 0x0, 0x0, 0x0, 0x0, 0x0
.long 0x0, 0x0, 0x0, 0x0, 0x0, 0x0, 0x0, 0x0
.long 0x0, 0x0, 0x0, 0x0, 0x0, 0x0, 0x0, 0x0
.long 0x0, 0x0, 0x0, 0x0, 0x0, 0x0, 0x0, 0x0
.long 0x3f80, 0x0, 0x0, 0x0, 0x3f803f80, 0x0, 0x0, 0x0
.long 0x0, 0x0, 0x0, 0x0, 0x0, 0x0, 0x0, 0x0
.long 0x0, 0x0, 0x0, 0x0, 0x0, 0x0, 0x0, 0x0
.long 0x0, 0x0, 0x0, 0x0, 0x0, 0x0, 0x0, 0x0
.long 0x0, 0x0, 0x0, 0x0, 0x0, 0x0, 0x0, 0x0
.long 0x0, 0x0, 0x0, 0x0, 0x0, 0x0, 0x0, 0x0
.long 0x0, 0x0, 0x0, 0x0, 0x0, 0x0, 0x0, 0x0
.long 0x0, 0x0, 0x0, 0x0, 0x0, 0x0, 0x0, 0x0
.long 0x0, 0x0, 0x0, 0x0, 0x0, 0x0, 0x0, 0x0
.long 0x0, 0x3f800000, 0x3f803f80, 0x0, 0x0, 0x0, 0x3f803f80, 0x3f80
.long 0x0, 0x0, 0x3f800000, 0x3f803f80, 0x0, 0x0, 0x0, 0x3f803f80
.long 0x0, 0x0, 0x0, 0x3f800000, 0x0, 0x0, 0x0, 0x0
.long 0x0, 0x0, 0x0, 0x0, 0x0, 0x0, 0x0, 0x0
.long 0x0, 0x0, 0x0, 0x0, 0x0, 0x0, 0x0, 0x0
.long 0x0, 0x0, 0x0, 0x0, 0x0, 0x0, 0x0, 0x0
.long 0x0, 0x0, 0x0, 0x0, 0x0, 0x0, 0x0, 0x0
.long 0x0, 0x0, 0x0, 0x0, 0x0, 0x0, 0x0, 0x0
.long 0x0, 0x0, 0x0, 0x0, 0x0, 0x0, 0x0, 0x0
.long 0x0, 0x0, 0x0, 0x0, 0x3f80, 0x0, 0x0, 0x0
.long 0x3f803f80, 0x0, 0x0, 0x0, 0x3f803f80, 0x3f80, 0x0, 0x0
.long 0x3f800000, 0x3f803f80, 0x0, 0x0, 0x0, 0x3f803f80, 0x3f80, 0x0
.long 0x0, 0x3f800000, 0x3f803f80, 0x0, 0x0, 0x0, 0x3f803f80, 0x3f80
.long 0x0, 0x0, 0x3f800000, 0x3f803f80, 0x0, 0x0, 0x0, 0x3f803f80
.long 0x0, 0x0, 0x0, 0x3f800000, 0x0, 0x0, 0x0, 0x0
.long 0x0, 0x0, 0x0, 0x0, 0x0, 0x0, 0x0, 0x0
.long 0x0, 0x0, 0x0, 0x0, 0x0, 0x0, 0x0, 0x0
.long 0x0, 0x0, 0x0, 0x0, 0x0, 0x0, 0x0, 0x0
.long 0x0, 0x0, 0x0, 0x0, 0x0, 0x0, 0x0, 0x0
.long 0x0, 0x0, 0x0, 0x0, 0x0, 0x0, 0x0, 0x0
.long 0x0, 0x0, 0x0, 0x0, 0x0, 0x0, 0x0, 0x0
.long 0x0, 0x0, 0x0, 0x0, 0x3f80, 0x0, 0x0, 0x0
.long 0x3f803f80, 0x0, 0x0, 0x0, 0x3f803f80, 0x3f80, 0x0, 0x0
.long 0x3f800000, 0x3f803f80, 0x0, 0x0, 0x0, 0x3f803f80, 0x3f80, 0x0
.long 0x0, 0x0, 0x3f803f80, 0x3f803f80, 0x0, 0x0, 0x3f800000, 0x3f803f80
.long 0x0, 0x0, 0x0, 0x3f803f80, 0x0, 0x0, 0x0, 0x3f800000
.long 0x0, 0x0, 0x0, 0x0, 0x0, 0x0, 0x0, 0x0
.long 0x0, 0x0, 0x0, 0x0, 0x0, 0x0, 0x0, 0x0
.long 0x0, 0x0, 0x0, 0x0, 0x0, 0x0, 0x0, 0x0
.long 0x0, 0x0, 0x0, 0x0, 0x0, 0x0, 0x0, 0x0
.long 0x0, 0x0, 0x0, 0x0, 0x0, 0x0, 0x0, 0x0
.long 0x0, 0x0, 0x0, 0x0, 0x0, 0x0, 0x0, 0x0
.long 0x3f803f80, 0x3f803f80, 0x3f80, 0x0, 0x3f803f80, 0x3f803f80, 0x3f803f80, 0x0
.long 0x3f803f80, 0x3f803f80, 0x3f803f80, 0x3f80, 0x3f803f80, 0x3f803f80, 0x3f803f80, 0x3f803f80
.long 0x3f803f80, 0x3f803f80, 0x3f803f80, 0x3f803f80, 0x3f800000, 0x3f803f80, 0x3f803f80, 0x3f803f80
.long 0x0, 0x3f803f80, 0x3f803f80, 0x3f803f80, 0x0, 0x3f800000, 0x3f803f80, 0x3f803f80
.long 0x0, 0x0, 0x3f803f80, 0x3f803f80, 0x0, 0x0, 0x3f800000, 0x3f803f80
.long 0x0, 0x0, 0x0, 0x3f803f80, 0x0, 0x0, 0x0, 0x3f800000
.long 0x0, 0x0, 0x0, 0x0, 0x0, 0x0, 0x0, 0x0
.long 0x0, 0x0, 0x0, 0x0, 0x0, 0x0, 0x0, 0x0
.long 0x0, 0x0, 0x0, 0x0, 0x0, 0x0, 0x0, 0x0
.long 0x0, 0x0, 0x0, 0x0, 0x0, 0x0, 0x0, 0x0
.long 0x3f80, 0x0, 0x0, 0x0, 0x3f803f80, 0x0, 0x0, 0x0
.long 0x3f803f80, 0x3f80, 0x0, 0x0, 0x3f803f80, 0x3f803f80, 0x0, 0x0
.long 0x3f803f80, 0x3f803f80, 0x3f80, 0x0, 0x3f803f80, 0x3f803f80, 0x3f803f80, 0x0
.long 0x3f803f80, 0x3f803f80, 0x3f803f80, 0x3f80, 0x3f803f80, 0x3f803f80, 0x3f803f80, 0x3f803f80
.long 0x3f803f80, 0x3f803f80, 0x3f803f80, 0x3f803f80, 0x3f800000, 0x3f803f80, 0x3f803f80, 0x3f803f80
.long 0x0, 0x3f803f80, 0x3f803f80, 0x3f803f80, 0x0, 0x3f800000, 0x3f803f80, 0x3f803f80
.long 0x0, 0x0, 0x0, 0x0, 0x0, 0x0, 0x0, 0x0
.long 0x0, 0x0, 0x0, 0x0, 0x0, 0x0, 0x0, 0x0
.long 0x0, 0x0, 0x0, 0x0, 0x0, 0x0, 0x0, 0x0
.long 0x0, 0x0, 0x0, 0x0, 0x0, 0x0, 0x0, 0x0
.long 0x0, 0x0, 0x0, 0x0, 0x0, 0x0, 0x0, 0x0
.long 0x0, 0x0, 0x0, 0x0, 0x0, 0x0, 0x0, 0x0
.long 0x3f80, 0x0, 0x0, 0x0, 0x3f803f80, 0x0, 0x0, 0x0
.long 0x3f803f80, 0x3f80, 0x0, 0x0, 0x3f803f80, 0x3f803f80, 0x0, 0x0
.long 0x0, 0x0, 0x3f800000, 0x3f803f80, 0x0, 0x0, 0x0, 0x3f803f80
.long 0x0, 0x0, 0x0, 0x3f800000, 0x0, 0x0, 0x0, 0x0
.long 0x0, 0x0, 0x0, 0x0, 0x0, 0x0, 0x0, 0x0
.long 0x0, 0x0, 0x0, 0x0, 0x0, 0x0, 0x0, 0x0
.long 0x0, 0x0, 0x0, 0x0, 0x0, 0x0, 0x0, 0x0
.long 0x0, 0x0, 0x0, 0x0, 0x0, 0x0, 0x0, 0x0
.long 0x0, 0x0, 0x0, 0x0, 0x0, 0x0, 0x0, 0x0
.long 0x0, 0x0, 0x0, 0x0, 0x0, 0x0, 0x0, 0x0
.long 0x3f803f80, 0x3f803f80, 0x0, 0x0, 0x3f803f80, 0x3f803f80, 0x3f80, 0x0
.long 0x3f803f80, 0x3f803f80, 0x3f803f80, 0x0, 0x3f803f80, 0x3f803f80, 0x3f803f80, 0x3f80
.long 0x3f800000, 0x3f803f80, 0x3f803f80, 0x3f803f80, 0x0, 0x3f803f80, 0x3f803f80, 0x3f803f80
.long 0x0, 0x3f800000, 0x3f803f80, 0x3f803f80, 0x0, 0x0, 0x3f803f80, 0x3f803f80
.long 0x0, 0x0, 0x3f800000, 0x3f803f80, 0x0, 0x0, 0x0, 0x3f803f80
.long 0x0, 0x0, 0x0, 0x3f800000, 0x0, 0x0, 0x0, 0x0
.long 0x0, 0x0, 0x0, 0x0, 0x0, 0x0, 0x0, 0x0
.long 0x0, 0x0, 0x0, 0x0, 0x0, 0x0, 0x0, 0x0
.long 0x0, 0x0, 0x0, 0x0, 0x0, 0x0, 0x0, 0x0
.long 0x0, 0x0, 0x0, 0x0, 0x0, 0x0, 0x0, 0x0
.long 0x0, 0x0, 0x0, 0x0, 0x3f80, 0x0, 0x0, 0x0
.long 0x3f803f80, 0x0, 0x0, 0x0, 0x3f803f80, 0x3f80, 0x0, 0x0
.long 0x3f803f80, 0x3f803f80, 0x0, 0x0, 0x3f803f80, 0x3f803f80, 0x3f80, 0x0
.long 0x3f803f80, 0x3f803f80, 0x3f803f80, 0x0, 0x3f803f80, 0x3f803f80, 0x3f803f80, 0x3f80
.long 0x3f800000, 0x3f803f80, 0x3f803f80, 0x3f803f80, 0x0, 0x3f803f80, 0x3f803f80, 0x3f803f80
.long 0x0, 0x3f800000, 0x3f803f80, 0x3f803f80, 0x0, 0x0, 0x3f803f80, 0x3f803f80
.long 0x0, 0x0, 0x0, 0x0, 0x0, 0x0, 0x0, 0x0
.long 0x0, 0x0, 0x0, 0x0, 0x0, 0x0, 0x0, 0x0
.long 0x0, 0x0, 0x0, 0x0, 0x0, 0x0, 0x0, 0x0
.long 0x0, 0x0, 0x0, 0x0, 0x0, 0x0, 0x0, 0x0
.long 0x0, 0x0, 0x0, 0x0, 0x0, 0x0, 0x0, 0x0
.long 0x0, 0x0, 0x0, 0x0, 0x0, 0x0, 0x0, 0x0
.long 0x0, 0x0, 0x0, 0x0, 0x3f80, 0x0, 0x0, 0x0
.long 0x3f803f80, 0x0, 0x0, 0x0, 0x3f803f80, 0x3f80, 0x0, 0x0
.size L_TABA, 6144
.type L_LAST,@object
L_LAST:
.long 0
.size L_LAST, 4
.section .rodata,"a"
.p2align 6
.amdhsa_kernel concat_heads__ssm_conv_s4__linear_attn_block__prompt_kernel
  .amdhsa_next_free_vgpr 512
  .amdhsa_next_free_sgpr 102
  .amdhsa_accum_offset 256
  .amdhsa_group_segment_fixed_size 0
  .amdhsa_kernarg_size 120
  .amdhsa_user_sgpr_count 2
  .amdhsa_user_sgpr_kernarg_segment_ptr 1
  .amdhsa_system_sgpr_workgroup_id_x 1
.end_amdhsa_kernel
```
